```python
import torch

def _softmax(x, axis=-1):
    return torch.softmax(x, dim=axis)
def _gelu(x):
    return torch.nn.functional.gelu(x, approximate="tanh")
def _silu(x):
    return torch.nn.functional.silu(x)
def _sigmoid(x):
    return torch.sigmoid(x)
def _layernorm(x, axis=-1, eps=1e-5):
    m = x.mean(dim=axis, keepdim=True)
    v = x.var(dim=axis, keepdim=True, unbiased=False)
    return (x - m) / torch.sqrt(v + eps)
def _scatter_add(tgt, idx, src, axis=0):
    return tgt.clone().index_add_(axis, idx, src)
def _segment_sum(src, seg, n):
    out = torch.zeros((n,) + src.shape[1:], dtype=src.dtype)
    return out.index_add_(0, seg, src)
def _pad(x, pw):
    flat = tuple(v for pair in reversed(pw) for v in pair)
    return torch.nn.functional.pad(x, flat)

kernel_name = 'gated_mix__ssm_conv_s5__glu_gated_swiglu__prompt'

def setup_inputs():

    _w = (lambda a: (lambda t: t.to(torch.bfloat16) if t.is_floating_point() else t)(torch.as_tensor(a)))
    def _A_setup():
        B, S, D = 1, 2048, 640
        P = D
        Lambda_re = -0.5 * (lambda _x: torch.exp(torch.as_tensor(_x)))((lambda *s: torch.randn(*s, dtype=torch.bfloat16) * 0.2)(P))
        Lambda_im = (lambda *s: torch.randn(*s, dtype=torch.bfloat16) * 0.4)(P) * 1.0
        B_re = (lambda *s: torch.randn(*s, dtype=torch.bfloat16) * 0.2)(P, D) * (D ** -0.5)
        B_im = (lambda *s: torch.randn(*s, dtype=torch.bfloat16) * 0.2)(P, D) * (D ** -0.5)
        C_re = (lambda *s: torch.randn(*s, dtype=torch.bfloat16) * 0.2)(D, P) * (P ** -0.5)
        C_im = (lambda *s: torch.randn(*s, dtype=torch.bfloat16) * 0.2)(D, P) * (P ** -0.5)
        log_dt = (lambda *s: torch.randn(*s, dtype=torch.bfloat16) * 0.2)(P) * 0.3 - 2.0
        Dskip = (lambda *s: torch.randn(*s, dtype=torch.bfloat16) * 0.05)(D)
        return {
            "x": _w((lambda *s: torch.randn(*s, dtype=torch.bfloat16) * 0.05)(B, S, D)),
            "Lambda_re": _w(Lambda_re),
            "Lambda_im": _w(Lambda_im),
            "B_re": _w(B_re),
            "B_im": _w(B_im),
            "C_re": _w(C_re),
            "C_im": _w(C_im),
            "log_dt": _w(log_dt),
            "Dskip": _w(Dskip),
        }
    _A_in = _A_setup()

    def _B_setup():
        B, S, D, F = 1, 2048, 640, 1728
        return {
            "x": _w((lambda *s: torch.randn(*s, dtype=torch.bfloat16) * 0.05)(B, S, D)),
            "w1": _w((lambda *s: torch.randn(*s, dtype=torch.bfloat16) * 0.8)(D, F) * (2.0 / D) ** 0.5),
            "w3": _w((lambda *s: torch.randn(*s, dtype=torch.bfloat16) * 0.8)(D, F) * (2.0 / D) ** 0.5),
            "w2": _w((lambda *s: torch.randn(*s, dtype=torch.bfloat16) * 0.8)(F, D) * (2.0 / F) ** 0.5),
        }
    _B_in = _B_setup()

    return {
        "A_x": _A_in["x"],
        "A_Lambda_re": _A_in["Lambda_re"],
        "A_Lambda_im": _A_in["Lambda_im"],
        "A_B_re": _A_in["B_re"],
        "A_B_im": _A_in["B_im"],
        "A_C_re": _A_in["C_re"],
        "A_C_im": _A_in["C_im"],
        "A_log_dt": _A_in["log_dt"],
        "A_Dskip": _A_in["Dskip"],
        "B_x": _B_in["x"],
        "B_w1": _B_in["w1"],
        "B_w3": _B_in["w3"],
        "B_w2": _B_in["w2"],
        "gate_w": _w((lambda *s: torch.randn(*s, dtype=torch.bfloat16) * 0.05)(640) * 16.0),
    }

def reference(A_x, A_Lambda_re, A_Lambda_im, A_B_re, A_B_im, A_C_re, A_C_im, A_log_dt, A_Dskip, B_x, B_w1, B_w3, B_w2, gate_w):
    def _A_ref(x, Lambda_re, Lambda_im, B_re, B_im, C_re, C_im, log_dt, Dskip):
        Bsz, L, H = x.shape
        Lam = Lambda_re + 1j * Lambda_im
        Bmat = B_re + 1j * B_im
        Cmat = C_re + 1j * C_im
        dt = torch.exp(log_dt)
        Lam_bar = torch.exp(dt * Lam)
        B_bar = ((Lam_bar - 1.0) / Lam)[:, None] * Bmat
        Bu = torch.einsum("bld,pd->blp", x + 0j, B_bar)
        h = torch.zeros_like(Bu[:, 0, :])
        hs = []
        for t in range(L):
            h = Lam_bar[None, :] * h + Bu[:, t, :]
            hs.append(h)
        hseq = torch.stack(hs, 1)
        y = 2.0 * torch.einsum("blp,dp->bld", hseq, Cmat).real + x * Dskip[None, None, :]
        return y

    def _B_ref(x, w1, w3, w2):
        gate = torch.einsum("bsd,df->bsf", x, w1)
        up = torch.einsum("bsd,df->bsf", x, w3)
        h = _silu(gate) * up
        out = torch.einsum("bsf,fd->bsd", h, w2)
        return out

    x = A_x
    g = _sigmoid((x * gate_w).sum(-1, keepdims=True))
    a = _A_ref(x, A_Lambda_re, A_Lambda_im, A_B_re, A_B_im, A_C_re, A_C_im, A_log_dt, A_Dskip)
    b = _B_ref(x, B_w1, B_w3, B_w2)
    return g * a + (1 - g) * b
```

```asm
; @launch grid=(256,1,1) block=(512,1,1) lds=163840
.amdgcn_target "amdgcn-amd-amdhsa--gfx950"
.text
.globl gated_mix__ssm_conv_s5__glu_gated_swiglu__prompt_kernel
.p2align 8
.type gated_mix__ssm_conv_s5__glu_gated_swiglu__prompt_kernel,@function
gated_mix__ssm_conv_s5__glu_gated_swiglu__prompt_kernel:
    s_cmp_ge_u32 s2, 256
    s_cbranch_scc1 L_end
    s_nop 0
    s_load_dwordx16 s[4:19], s[0:1], 0
    s_load_dwordx16 s[20:35], s[0:1], 64
    s_load_dwordx2 s[36:37], s[0:1], 128
    v_lshrrev_b32 v1, 6, v0
    v_and_b32_e64 v0, 63, v0
    v_readfirstlane_b32 s38, v1
    s_bfe_u32 s44, s2, 0x20003
    s_and_b32 s39, s2, 1
    s_lshl2_add_u32 s39, s39, s44
    s_lshr_b32 s49, s2, 5
    s_and_b32 s48, s2, 6
    s_lshl_b32 s48, s48, 2
    s_bfe_u32 s44, s2, 0x10002
    s_add_u32 s44, s44, s49
    s_cmp_ge_u32 s44, 6
    s_cselect_b32 s41, 1, 0
    s_mov_b32 s45, 0x17120c06
    s_cselect_b32 s45, 0x08050200, s45
    s_mov_b32 s3, 0x26048260
    s_cselect_b32 s3, 0x4826048, s3
    s_lshr_b32 s45, s45, s48
    s_and_b32 s45, s45, 0xff
    s_add_u32 s40, s45, s49
    s_sub_u32 s40, s40, 6
    s_lshl_b32 s44, s2, 2
    s_lshr_b32 s3, s3, s44
    s_and_b32 s3, s3, 15
    s_and_b32 s90, s38, 3
    s_cmp_lt_u32 s38, 4
    s_cbranch_scc1 L_compute
L_loader:
    s_cmp_ge_u32 s90, 2
    s_cbranch_scc1 L_helper
    v_lshrrev_b32 v1, 3, v0
    v_and_b32 v2, 7, v0
    v_mul_u32_u24 v3, 1280, v1
    v_lshrrev_b32 v18, 1, v1
    v_xor_b32 v18, v18, v2
    v_lshlrev_b32 v18, 4, v18
    v_add_u32 v4, v18, v3
    v_xor_b32 v19, 64, v4
    s_lshl_b32 s47, s41, 6
    v_xor_b32 v2, s47, v4
    v_xor_b32_e64 v3, s47, v19
    v_add_u32 v5, 9216, v19
    v_add_u32 v6, 18432, v4
    v_add_u32 v7, 27648, v19
    v_add_u32 v8, 40960, v2
    v_add_u32 v9, 50176, v3
    v_add_u32 v10, 59392, v2
    v_add_u32 v11, 68608, v3
    s_and_b32 s44, s40, 1
    s_lshl1_add_u32 s46, s90, s44
    s_lshl_b32 s75, s46, 13
    s_lshl2_add_u32 s46, s39, s46
    s_mul_i32 s85, s46, 81920
    s_lshl_b32 s47, s3, 7
    s_add_u32 s85, s85, s47
    s_add_u32 m0, s75, 65536
    s_waitcnt lgkmcnt(0)
    s_mov_b32 s48, s4
    s_mov_b32 s49, s5
    s_nop 0
    s_mov_b32 s50, 0x280000
    s_mov_b32 s51, 0x20000
    buffer_load_dwordx4 v4, s[48:51], s85 offen offset:0 lds
    buffer_load_dwordx4 v5, s[48:51], s85 offen offset:1024 lds
    buffer_load_dwordx4 v6, s[48:51], s85 offen offset:2048 lds
    buffer_load_dwordx4 v7, s[48:51], s85 offen offset:3072 lds
    s_xor_b32 m0, m0, 4096
    s_nop 0
    s_nop 0
    buffer_load_dwordx4 v8, s[48:51], s85 offen offset:0 lds
    buffer_load_dwordx4 v9, s[48:51], s85 offen offset:1024 lds
    buffer_load_dwordx4 v10, s[48:51], s85 offen offset:2048 lds
    buffer_load_dwordx4 v11, s[48:51], s85 offen offset:3072 lds
    s_xor_b32 s46, s46, 1
    s_mul_i32 s86, s46, 81920
    s_add_u32 s86, s86, s47
    s_xor_b32 s76, s75, 8192
    s_and_b32 s45, s39, 1
    s_cmp_eq_u32 s41, 1
    s_cbranch_scc1 Ll_ssm
    s_mov_b32 s81, 20736
    s_mov_b32 s82, 41472
    s_xor_b32 s47, s45, 1
    s_movk_i32 s46, 3296
    v_mul_u32_u24 v1, 6554, v0
    v_lshlrev_b32 v2, 4, v0
    s_mov_b32 s88, 419456
    v_lshrrev_b32 v3, 16, v1
    v_mad_u32_u24 v12, v3, s46, v2
    v_add_u32 v1, s88, v1
    v_lshrrev_b32 v3, 16, v1
    v_mad_u32_u24 v13, v3, s46, v2
    v_add_u32 v1, s88, v1
    v_lshrrev_b32 v3, 16, v1
    v_mad_u32_u24 v14, v3, s46, v2
    v_add_u32 v1, s88, v1
    v_lshrrev_b32 v3, 16, v1
    v_mad_u32_u24 v15, v3, s46, v2
    v_add_u32 v1, s88, v1
    v_lshrrev_b32_e64 v3, 16, v1
    v_add_u32 v2, 4096, v2
    v_mad_u32_u24 v16, v3, s46, v2
    s_mul_i32 s46, s40, 160
    s_mul_i32 s66, s45, 110592
    s_mul_i32 s67, s47, 110592
    s_add_u32 s66, s66, s46
    s_add_u32 s67, s67, s46
    s_mul_i32 s46, s90, 10368
    s_add_u32 s46, s46, 98304
    s_mul_i32 s77, s45, 5120
    s_mul_i32 s78, s47, 5120
    s_add_u32 s77, s77, s46
    s_add_u32 s78, s78, s46
    s_add_u32 s79, s77, 4096
    s_add_u32 s80, s78, 4096
    s_mov_b32 s83, s81
    s_mov_b32 s87, s82
    s_mov_b32 s84, 221184
    s_cmp_eq_u32 s90, 0
    s_cselect_b32 s52, s24, s26
    s_cselect_b32 s53, s25, s27
    s_mov_b32 s54, 2211840
    s_branch Ll_go
Ll_ssm:
    s_mov_b32 s81, 16384
    s_mov_b32 s82, 32768
    s_xor_b32 s47, s45, 1
    v_mov_b32 v12, v4
    v_mov_b32 v13, v5
    v_mov_b32 v14, v6
    v_mov_b32 v15, v7
    v_mov_b32 v16, 0x40000000
    s_mul_i32 s46, s40, 81920
    s_mul_i32 s66, s45, 40960
    s_mul_i32 s67, s47, 40960
    s_add_u32 s66, s66, s46
    s_add_u32 s67, s67, s46
    s_lshl_b32 s46, s90, 13
    s_lshl_b32 s77, s45, 12
    s_add_u32 s77, s77, s46
    s_nop 0
    s_xor_b32 s78, s77, 4096
    s_add_u32 s77, s77, 98304
    s_add_u32 s78, s78, 98304
    s_lshl_b32 s79, s90, 10
    s_add_u32 s79, s79, 147456
    s_mov_b32 s80, s79
    s_mov_b32 s83, 0
    s_mov_b32 s87, 0
    s_movk_i32 s84, 128
    s_cmp_eq_u32 s90, 0
    s_cselect_b32 s52, s10, s12
    s_cselect_b32 s53, s11, s13
    s_mov_b32 s54, 819200
Ll_go:
    s_mov_b32 s55, 0x20000
    s_mul_i32 s44, s3, s84
    s_add_u32 s66, s66, s44
    s_add_u32 s67, s67, s44
    s_mul_i32 s73, s84, -9
    s_mov_b32 s71, s3
    s_mov_b32 s72, s3
    s_movk_i32 s74, 128
    s_add_u32 m0, s77, s82
    s_add_u32 s71, s71, 1
    s_nop 0
    buffer_load_dwordx4 v12, s[52:55], s66 offen offset:0 lds
    buffer_load_dwordx4 v13, s[52:55], s66 offen offset:1024 lds
    buffer_load_dwordx4 v14, s[52:55], s66 offen offset:2048 lds
    buffer_load_dwordx4 v15, s[52:55], s66 offen offset:3072 lds
    s_add_u32 m0, s79, s87
    s_nop 0
    buffer_load_dwordx4 v16, s[52:55], s66 offen lds
    s_cmp_eq_u32 s71, 10
    s_cselect_b32 s44, 0xfffffb80, s74
    s_cselect_b32 s45, s73, s84
    s_add_u32 s85, s85, s44
    s_add_u32 s66, s66, s45
    s_add_u32 m0, s76, 65536
    s_nop 0
    s_nop 0
    buffer_load_dwordx4 v4, s[48:51], s86 offen offset:0 lds
    buffer_load_dwordx4 v5, s[48:51], s86 offen offset:1024 lds
    buffer_load_dwordx4 v6, s[48:51], s86 offen offset:2048 lds
    buffer_load_dwordx4 v7, s[48:51], s86 offen offset:3072 lds
    s_xor_b32 m0, m0, 4096
    s_nop 0
    s_nop 0
    buffer_load_dwordx4 v8, s[48:51], s86 offen offset:0 lds
    buffer_load_dwordx4 v9, s[48:51], s86 offen offset:1024 lds
    buffer_load_dwordx4 v10, s[48:51], s86 offen offset:2048 lds
    buffer_load_dwordx4 v11, s[48:51], s86 offen offset:3072 lds
    s_add_u32 m0, s78, s82
    s_add_u32 s72, s72, 1
    buffer_load_dwordx4 v12, s[52:55], s67 offen offset:0 lds
    buffer_load_dwordx4 v13, s[52:55], s67 offen offset:1024 lds
    buffer_load_dwordx4 v14, s[52:55], s67 offen offset:2048 lds
    buffer_load_dwordx4 v15, s[52:55], s67 offen offset:3072 lds
    s_add_u32 m0, s80, s87
    s_nop 0
    buffer_load_dwordx4 v16, s[52:55], s67 offen lds
    s_cmp_eq_u32 s72, 10
    s_cselect_b32 s44, 0xfffffb80, s74
    s_cselect_b32 s45, s73, s84
    s_add_u32 s86, s86, s44
    s_add_u32 s67, s67, s45
    s_add_u32 m0, s75, 0
    s_nop 0
    buffer_load_dwordx4 v4, s[48:51], s85 offen offset:0 lds
    buffer_load_dwordx4 v5, s[48:51], s85 offen offset:1024 lds
    buffer_load_dwordx4 v6, s[48:51], s85 offen offset:2048 lds
    buffer_load_dwordx4 v7, s[48:51], s85 offen offset:3072 lds
    s_xor_b32 m0, m0, 4096
    s_nop 0
    s_nop 0
    buffer_load_dwordx4 v8, s[48:51], s85 offen offset:0 lds
    buffer_load_dwordx4 v9, s[48:51], s85 offen offset:1024 lds
    buffer_load_dwordx4 v10, s[48:51], s85 offen offset:2048 lds
    buffer_load_dwordx4 v11, s[48:51], s85 offen offset:3072 lds
    s_mov_b32 m0, s77
    s_add_u32 s71, s71, 1
    buffer_load_dwordx4 v12, s[52:55], s66 offen offset:0 lds
    buffer_load_dwordx4 v13, s[52:55], s66 offen offset:1024 lds
    buffer_load_dwordx4 v14, s[52:55], s66 offen offset:2048 lds
    buffer_load_dwordx4 v15, s[52:55], s66 offen offset:3072 lds
    s_mov_b32 m0, s79
    s_nop 0
    buffer_load_dwordx4 v16, s[52:55], s66 offen lds
    s_cmp_eq_u32 s71, 10
    s_cselect_b32 s44, 0xfffffb80, s74
    s_cselect_b32 s45, s73, s84
    s_add_u32 s85, s85, s44
    s_add_u32 s66, s66, s45
    s_and_b32 s42, s2, 6
    s_bfe_u32 s43, s2, 0x30003
    s_lshl2_add_u32 s42, s42, s43
    s_and_b32 s43, s2, 1
    s_lshr_b32 s101, s2, 6
    s_lshl2_add_u32 s43, s43, s101
    s_mov_b32 s101, 0
    s_waitcnt vmcnt(13)
    s_barrier
    s_add_u32 m0, s76, 0
    s_nop 0
    buffer_load_dwordx4 v4, s[48:51], s86 offen offset:0 lds
    buffer_load_dwordx4 v5, s[48:51], s86 offen offset:1024 lds
    buffer_load_dwordx4 v6, s[48:51], s86 offen offset:2048 lds
    buffer_load_dwordx4 v7, s[48:51], s86 offen offset:3072 lds
    s_xor_b32 m0, m0, 4096
    s_nop 0
    s_nop 0
    buffer_load_dwordx4 v8, s[48:51], s86 offen offset:0 lds
    buffer_load_dwordx4 v9, s[48:51], s86 offen offset:1024 lds
    buffer_load_dwordx4 v10, s[48:51], s86 offen offset:2048 lds
    buffer_load_dwordx4 v11, s[48:51], s86 offen offset:3072 lds
    s_mov_b32 m0, s78
    s_add_u32 s72, s72, 1
    buffer_load_dwordx4 v12, s[52:55], s67 offen offset:0 lds
    buffer_load_dwordx4 v13, s[52:55], s67 offen offset:1024 lds
    buffer_load_dwordx4 v14, s[52:55], s67 offen offset:2048 lds
    buffer_load_dwordx4 v15, s[52:55], s67 offen offset:3072 lds
    s_mov_b32 m0, s80
    s_nop 0
    buffer_load_dwordx4 v16, s[52:55], s67 offen lds
    s_cmp_eq_u32 s72, 10
    s_cselect_b32 s44, 0xfffffb80, s74
    s_cselect_b32 s45, s73, s84
    s_add_u32 s86, s86, s44
    s_add_u32 s67, s67, s45
    s_add_u32 m0, s75, 32768
    s_nop 0
    s_nop 0
    buffer_load_dwordx4 v4, s[48:51], s85 offen offset:0 lds
    buffer_load_dwordx4 v5, s[48:51], s85 offen offset:1024 lds
    buffer_load_dwordx4 v6, s[48:51], s85 offen offset:2048 lds
    buffer_load_dwordx4 v7, s[48:51], s85 offen offset:3072 lds
    s_xor_b32 m0, m0, 4096
    s_nop 0
    s_nop 0
    buffer_load_dwordx4 v8, s[48:51], s85 offen offset:0 lds
    buffer_load_dwordx4 v9, s[48:51], s85 offen offset:1024 lds
    buffer_load_dwordx4 v10, s[48:51], s85 offen offset:2048 lds
    buffer_load_dwordx4 v11, s[48:51], s85 offen offset:3072 lds
    s_add_u32 m0, s77, s81
    s_add_u32 s71, s71, 1
    buffer_load_dwordx4 v12, s[52:55], s66 offen offset:0 lds
    buffer_load_dwordx4 v13, s[52:55], s66 offen offset:1024 lds
    buffer_load_dwordx4 v14, s[52:55], s66 offen offset:2048 lds
    buffer_load_dwordx4 v15, s[52:55], s66 offen offset:3072 lds
    s_add_u32 m0, s79, s83
    s_nop 0
    buffer_load_dwordx4 v16, s[52:55], s66 offen lds
    s_cmp_eq_u32 s71, 10
    s_cselect_b32 s44, 0xfffffb80, s74
    s_cselect_b32 s45, s73, s84
    s_add_u32 s85, s85, s44
    s_add_u32 s66, s66, s45
    s_waitcnt vmcnt(13)
    s_barrier
    s_add_u32 m0, s76, 32768
    s_nop 0
    s_nop 0
    buffer_load_dwordx4 v4, s[48:51], s86 offen offset:0 lds
    buffer_load_dwordx4 v5, s[48:51], s86 offen offset:1024 lds
    buffer_load_dwordx4 v6, s[48:51], s86 offen offset:2048 lds
    buffer_load_dwordx4 v7, s[48:51], s86 offen offset:3072 lds
    s_xor_b32 m0, m0, 4096
    s_nop 0
    s_nop 0
    buffer_load_dwordx4 v8, s[48:51], s86 offen offset:0 lds
    buffer_load_dwordx4 v9, s[48:51], s86 offen offset:1024 lds
    buffer_load_dwordx4 v10, s[48:51], s86 offen offset:2048 lds
    buffer_load_dwordx4 v11, s[48:51], s86 offen offset:3072 lds
    s_add_u32 m0, s78, s81
    s_add_u32 s72, s72, 1
    buffer_load_dwordx4 v12, s[52:55], s67 offen offset:0 lds
    buffer_load_dwordx4 v13, s[52:55], s67 offen offset:1024 lds
    buffer_load_dwordx4 v14, s[52:55], s67 offen offset:2048 lds
    buffer_load_dwordx4 v15, s[52:55], s67 offen offset:3072 lds
    s_add_u32 m0, s80, s83
    s_nop 0
    buffer_load_dwordx4 v16, s[52:55], s67 offen lds
    s_cmp_eq_u32 s72, 10
    s_cselect_b32 s44, 0xfffffb80, s74
    s_cselect_b32 s45, s73, s84
    s_add_u32 s86, s86, s44
    s_add_u32 s67, s67, s45
    s_add_u32 m0, s75, 65536
    s_nop 0
    s_nop 0
    buffer_load_dwordx4 v4, s[48:51], s85 offen offset:0 lds
    buffer_load_dwordx4 v5, s[48:51], s85 offen offset:1024 lds
    buffer_load_dwordx4 v6, s[48:51], s85 offen offset:2048 lds
    buffer_load_dwordx4 v7, s[48:51], s85 offen offset:3072 lds
    s_xor_b32 m0, m0, 4096
    s_nop 0
    s_nop 0
    buffer_load_dwordx4 v8, s[48:51], s85 offen offset:0 lds
    buffer_load_dwordx4 v9, s[48:51], s85 offen offset:1024 lds
    buffer_load_dwordx4 v10, s[48:51], s85 offen offset:2048 lds
    buffer_load_dwordx4 v11, s[48:51], s85 offen offset:3072 lds
    s_add_u32 m0, s77, s82
    s_add_u32 s71, s71, 1
    buffer_load_dwordx4 v12, s[52:55], s66 offen offset:0 lds
    buffer_load_dwordx4 v13, s[52:55], s66 offen offset:1024 lds
    buffer_load_dwordx4 v14, s[52:55], s66 offen offset:2048 lds
    buffer_load_dwordx4 v15, s[52:55], s66 offen offset:3072 lds
    s_add_u32 m0, s79, s87
    s_nop 0
    buffer_load_dwordx4 v16, s[52:55], s66 offen lds
    s_cmp_eq_u32 s71, 10
    s_cselect_b32 s44, 0xfffffb80, s74
    s_cselect_b32 s45, s73, s84
    s_add_u32 s85, s85, s44
    s_add_u32 s66, s66, s45
    s_waitcnt vmcnt(13)
    s_barrier
    s_add_u32 m0, s76, 65536
    s_nop 0
    s_nop 0
    buffer_load_dwordx4 v4, s[48:51], s86 offen offset:0 lds
    buffer_load_dwordx4 v5, s[48:51], s86 offen offset:1024 lds
    buffer_load_dwordx4 v6, s[48:51], s86 offen offset:2048 lds
    buffer_load_dwordx4 v7, s[48:51], s86 offen offset:3072 lds
    s_xor_b32 m0, m0, 4096
    s_nop 0
    s_nop 0
    buffer_load_dwordx4 v8, s[48:51], s86 offen offset:0 lds
    buffer_load_dwordx4 v9, s[48:51], s86 offen offset:1024 lds
    buffer_load_dwordx4 v10, s[48:51], s86 offen offset:2048 lds
    buffer_load_dwordx4 v11, s[48:51], s86 offen offset:3072 lds
    s_add_u32 m0, s78, s82
    s_add_u32 s72, s72, 1
    buffer_load_dwordx4 v12, s[52:55], s67 offen offset:0 lds
    buffer_load_dwordx4 v13, s[52:55], s67 offen offset:1024 lds
    buffer_load_dwordx4 v14, s[52:55], s67 offen offset:2048 lds
    buffer_load_dwordx4 v15, s[52:55], s67 offen offset:3072 lds
    s_add_u32 m0, s80, s87
    s_nop 0
    buffer_load_dwordx4 v16, s[52:55], s67 offen lds
    s_cmp_eq_u32 s72, 10
    s_cselect_b32 s44, 0xfffffb80, s74
    s_cselect_b32 s45, s73, s84
    s_add_u32 s86, s86, s44
    s_add_u32 s67, s67, s45
    s_add_u32 m0, s75, 0
    s_nop 0
    buffer_load_dwordx4 v4, s[48:51], s85 offen offset:0 lds
    buffer_load_dwordx4 v5, s[48:51], s85 offen offset:1024 lds
    buffer_load_dwordx4 v6, s[48:51], s85 offen offset:2048 lds
    buffer_load_dwordx4 v7, s[48:51], s85 offen offset:3072 lds
    s_xor_b32 m0, m0, 4096
    s_nop 0
    s_nop 0
    buffer_load_dwordx4 v8, s[48:51], s85 offen offset:0 lds
    buffer_load_dwordx4 v9, s[48:51], s85 offen offset:1024 lds
    buffer_load_dwordx4 v10, s[48:51], s85 offen offset:2048 lds
    buffer_load_dwordx4 v11, s[48:51], s85 offen offset:3072 lds
    s_mov_b32 m0, s77
    s_add_u32 s71, s71, 1
    buffer_load_dwordx4 v12, s[52:55], s66 offen offset:0 lds
    buffer_load_dwordx4 v13, s[52:55], s66 offen offset:1024 lds
    buffer_load_dwordx4 v14, s[52:55], s66 offen offset:2048 lds
    buffer_load_dwordx4 v15, s[52:55], s66 offen offset:3072 lds
    s_mov_b32 m0, s79
    s_nop 0
    buffer_load_dwordx4 v16, s[52:55], s66 offen lds
    s_cmp_eq_u32 s71, 10
    s_cselect_b32 s44, 0xfffffb80, s74
    s_cselect_b32 s45, s73, s84
    s_add_u32 s85, s85, s44
    s_add_u32 s66, s66, s45
    s_waitcnt vmcnt(13)
    s_barrier
    s_add_u32 m0, s76, 0
    s_nop 0
    buffer_load_dwordx4 v4, s[48:51], s86 offen offset:0 lds
    buffer_load_dwordx4 v5, s[48:51], s86 offen offset:1024 lds
    buffer_load_dwordx4 v6, s[48:51], s86 offen offset:2048 lds
    buffer_load_dwordx4 v7, s[48:51], s86 offen offset:3072 lds
    s_xor_b32 m0, m0, 4096
    s_nop 0
    s_nop 0
    buffer_load_dwordx4 v8, s[48:51], s86 offen offset:0 lds
    buffer_load_dwordx4 v9, s[48:51], s86 offen offset:1024 lds
    buffer_load_dwordx4 v10, s[48:51], s86 offen offset:2048 lds
    buffer_load_dwordx4 v11, s[48:51], s86 offen offset:3072 lds
    s_mov_b32 m0, s78
    s_add_u32 s72, s72, 1
    buffer_load_dwordx4 v12, s[52:55], s67 offen offset:0 lds
    buffer_load_dwordx4 v13, s[52:55], s67 offen offset:1024 lds
    buffer_load_dwordx4 v14, s[52:55], s67 offen offset:2048 lds
    buffer_load_dwordx4 v15, s[52:55], s67 offen offset:3072 lds
    s_mov_b32 m0, s80
    s_nop 0
    buffer_load_dwordx4 v16, s[52:55], s67 offen lds
    s_cmp_eq_u32 s72, 10
    s_cselect_b32 s44, 0xfffffb80, s74
    s_cselect_b32 s45, s73, s84
    s_add_u32 s86, s86, s44
    s_add_u32 s67, s67, s45
    s_add_u32 m0, s75, 32768
    s_nop 0
    s_nop 0
    buffer_load_dwordx4 v4, s[48:51], s85 offen offset:0 lds
    buffer_load_dwordx4 v5, s[48:51], s85 offen offset:1024 lds
    buffer_load_dwordx4 v6, s[48:51], s85 offen offset:2048 lds
    buffer_load_dwordx4 v7, s[48:51], s85 offen offset:3072 lds
    s_xor_b32 m0, m0, 4096
    s_nop 0
    s_nop 0
    buffer_load_dwordx4 v8, s[48:51], s85 offen offset:0 lds
    buffer_load_dwordx4 v9, s[48:51], s85 offen offset:1024 lds
    buffer_load_dwordx4 v10, s[48:51], s85 offen offset:2048 lds
    buffer_load_dwordx4 v11, s[48:51], s85 offen offset:3072 lds
    s_add_u32 m0, s77, s81
    s_add_u32 s71, s71, 1
    buffer_load_dwordx4 v12, s[52:55], s66 offen offset:0 lds
    buffer_load_dwordx4 v13, s[52:55], s66 offen offset:1024 lds
    buffer_load_dwordx4 v14, s[52:55], s66 offen offset:2048 lds
    buffer_load_dwordx4 v15, s[52:55], s66 offen offset:3072 lds
    s_add_u32 m0, s79, s83
    s_nop 0
    buffer_load_dwordx4 v16, s[52:55], s66 offen lds
    s_cmp_eq_u32 s71, 10
    s_cselect_b32 s44, 0xfffffb80, s74
    s_cselect_b32 s45, s73, s84
    s_add_u32 s85, s85, s44
    s_add_u32 s66, s66, s45
    s_add_u32 m0, s76, 32768
    s_nop 0
    s_nop 0
    buffer_load_dwordx4 v4, s[48:51], s86 offen offset:0 lds
    buffer_load_dwordx4 v5, s[48:51], s86 offen offset:1024 lds
    buffer_load_dwordx4 v6, s[48:51], s86 offen offset:2048 lds
    buffer_load_dwordx4 v7, s[48:51], s86 offen offset:3072 lds
    s_xor_b32 m0, m0, 4096
    s_nop 0
    s_nop 0
    buffer_load_dwordx4 v8, s[48:51], s86 offen offset:0 lds
    buffer_load_dwordx4 v9, s[48:51], s86 offen offset:1024 lds
    buffer_load_dwordx4 v10, s[48:51], s86 offen offset:2048 lds
    buffer_load_dwordx4 v11, s[48:51], s86 offen offset:3072 lds
    s_add_u32 m0, s78, s81
    s_add_u32 s72, s72, 1
    buffer_load_dwordx4 v12, s[52:55], s67 offen offset:0 lds
    buffer_load_dwordx4 v13, s[52:55], s67 offen offset:1024 lds
    buffer_load_dwordx4 v14, s[52:55], s67 offen offset:2048 lds
    buffer_load_dwordx4 v15, s[52:55], s67 offen offset:3072 lds
    s_add_u32 m0, s80, s83
    s_nop 0
    buffer_load_dwordx4 v16, s[52:55], s67 offen lds
    s_cmp_eq_u32 s72, 10
    s_cselect_b32 s44, 0xfffffb80, s74
    s_cselect_b32 s45, s73, s84
    s_add_u32 s86, s86, s44
    s_add_u32 s67, s67, s45
    s_waitcnt vmcnt(26)
    s_barrier
    s_add_u32 m0, s75, 65536
    s_nop 0
    s_nop 0
    buffer_load_dwordx4 v4, s[48:51], s85 offen offset:0 lds
    buffer_load_dwordx4 v5, s[48:51], s85 offen offset:1024 lds
    buffer_load_dwordx4 v6, s[48:51], s85 offen offset:2048 lds
    buffer_load_dwordx4 v7, s[48:51], s85 offen offset:3072 lds
    s_xor_b32 m0, m0, 4096
    s_nop 0
    s_nop 0
    buffer_load_dwordx4 v8, s[48:51], s85 offen offset:0 lds
    buffer_load_dwordx4 v9, s[48:51], s85 offen offset:1024 lds
    buffer_load_dwordx4 v10, s[48:51], s85 offen offset:2048 lds
    buffer_load_dwordx4 v11, s[48:51], s85 offen offset:3072 lds
    s_add_u32 m0, s77, s82
    s_add_u32 s71, s71, 1
    buffer_load_dwordx4 v12, s[52:55], s66 offen offset:0 lds
    buffer_load_dwordx4 v13, s[52:55], s66 offen offset:1024 lds
    buffer_load_dwordx4 v14, s[52:55], s66 offen offset:2048 lds
    buffer_load_dwordx4 v15, s[52:55], s66 offen offset:3072 lds
    s_add_u32 m0, s79, s87
    s_nop 0
    buffer_load_dwordx4 v16, s[52:55], s66 offen lds
    s_cmp_eq_u32 s71, 10
    s_cselect_b32 s44, 0xfffffb80, s74
    s_cselect_b32 s45, s73, s84
    s_add_u32 s85, s85, s44
    s_add_u32 s66, s66, s45
    s_add_u32 m0, s76, 65536
    s_nop 0
    s_nop 0
    buffer_load_dwordx4 v4, s[48:51], s86 offen offset:0 lds
    buffer_load_dwordx4 v5, s[48:51], s86 offen offset:1024 lds
    buffer_load_dwordx4 v6, s[48:51], s86 offen offset:2048 lds
    buffer_load_dwordx4 v7, s[48:51], s86 offen offset:3072 lds
    s_xor_b32 m0, m0, 4096
    s_nop 0
    s_nop 0
    buffer_load_dwordx4 v8, s[48:51], s86 offen offset:0 lds
    buffer_load_dwordx4 v9, s[48:51], s86 offen offset:1024 lds
    buffer_load_dwordx4 v10, s[48:51], s86 offen offset:2048 lds
    buffer_load_dwordx4 v11, s[48:51], s86 offen offset:3072 lds
    s_add_u32 m0, s78, s82
    s_add_u32 s72, s72, 1
    buffer_load_dwordx4 v12, s[52:55], s67 offen offset:0 lds
    buffer_load_dwordx4 v13, s[52:55], s67 offen offset:1024 lds
    buffer_load_dwordx4 v14, s[52:55], s67 offen offset:2048 lds
    buffer_load_dwordx4 v15, s[52:55], s67 offen offset:3072 lds
    s_add_u32 m0, s80, s87
    s_nop 0
    buffer_load_dwordx4 v16, s[52:55], s67 offen lds
    s_cmp_eq_u32 s72, 10
    s_cselect_b32 s44, 0xfffffb80, s74
    s_cselect_b32 s45, s73, s84
    s_add_u32 s86, s86, s44
    s_add_u32 s67, s67, s45
    s_waitcnt vmcnt(26)
    s_barrier
    s_add_u32 m0, s75, 0
    s_nop 0
    buffer_load_dwordx4 v4, s[48:51], s85 offen offset:0 lds
    buffer_load_dwordx4 v5, s[48:51], s85 offen offset:1024 lds
    buffer_load_dwordx4 v6, s[48:51], s85 offen offset:2048 lds
    buffer_load_dwordx4 v7, s[48:51], s85 offen offset:3072 lds
    s_xor_b32 m0, m0, 4096
    s_nop 0
    s_nop 0
    buffer_load_dwordx4 v8, s[48:51], s85 offen offset:0 lds
    buffer_load_dwordx4 v9, s[48:51], s85 offen offset:1024 lds
    buffer_load_dwordx4 v10, s[48:51], s85 offen offset:2048 lds
    buffer_load_dwordx4 v11, s[48:51], s85 offen offset:3072 lds
    s_mov_b32 m0, s77
    s_add_u32 s71, s71, 1
    buffer_load_dwordx4 v12, s[52:55], s66 offen offset:0 lds
    buffer_load_dwordx4 v13, s[52:55], s66 offen offset:1024 lds
    buffer_load_dwordx4 v14, s[52:55], s66 offen offset:2048 lds
    buffer_load_dwordx4 v15, s[52:55], s66 offen offset:3072 lds
    s_mov_b32 m0, s79
    s_nop 0
    buffer_load_dwordx4 v16, s[52:55], s66 offen lds
    s_cmp_eq_u32 s71, 10
    s_cselect_b32 s44, 0xfffffb80, s74
    s_cselect_b32 s45, s73, s84
    s_add_u32 s85, s85, s44
    s_add_u32 s66, s66, s45
    s_add_u32 m0, s76, 0
    s_nop 0
    buffer_load_dwordx4 v4, s[48:51], s86 offen offset:0 lds
    buffer_load_dwordx4 v5, s[48:51], s86 offen offset:1024 lds
    buffer_load_dwordx4 v6, s[48:51], s86 offen offset:2048 lds
    buffer_load_dwordx4 v7, s[48:51], s86 offen offset:3072 lds
    s_xor_b32 m0, m0, 4096
    s_nop 0
    s_nop 0
    buffer_load_dwordx4 v8, s[48:51], s86 offen offset:0 lds
    buffer_load_dwordx4 v9, s[48:51], s86 offen offset:1024 lds
    buffer_load_dwordx4 v10, s[48:51], s86 offen offset:2048 lds
    buffer_load_dwordx4 v11, s[48:51], s86 offen offset:3072 lds
    s_mov_b32 m0, s78
    s_add_u32 s72, s72, 1
    buffer_load_dwordx4 v12, s[52:55], s67 offen offset:0 lds
    buffer_load_dwordx4 v13, s[52:55], s67 offen offset:1024 lds
    buffer_load_dwordx4 v14, s[52:55], s67 offen offset:2048 lds
    buffer_load_dwordx4 v15, s[52:55], s67 offen offset:3072 lds
    s_mov_b32 m0, s80
    s_nop 0
    buffer_load_dwordx4 v16, s[52:55], s67 offen lds
    s_cmp_eq_u32 s72, 10
    s_cselect_b32 s44, 0xfffffb80, s74
    s_cselect_b32 s45, s73, s84
    s_add_u32 s86, s86, s44
    s_add_u32 s67, s67, s45
    s_waitcnt vmcnt(26)
    s_barrier
    s_add_u32 m0, s75, 32768
    s_nop 0
    s_nop 0
    buffer_load_dwordx4 v4, s[48:51], s85 offen offset:0 lds
    buffer_load_dwordx4 v5, s[48:51], s85 offen offset:1024 lds
    buffer_load_dwordx4 v6, s[48:51], s85 offen offset:2048 lds
    buffer_load_dwordx4 v7, s[48:51], s85 offen offset:3072 lds
    s_xor_b32 m0, m0, 4096
    s_nop 0
    s_nop 0
    buffer_load_dwordx4 v8, s[48:51], s85 offen offset:0 lds
    buffer_load_dwordx4 v9, s[48:51], s85 offen offset:1024 lds
    buffer_load_dwordx4 v10, s[48:51], s85 offen offset:2048 lds
    buffer_load_dwordx4 v11, s[48:51], s85 offen offset:3072 lds
    s_add_u32 m0, s77, s81
    s_add_u32 s71, s71, 1
    buffer_load_dwordx4 v12, s[52:55], s66 offen offset:0 lds
    buffer_load_dwordx4 v13, s[52:55], s66 offen offset:1024 lds
    buffer_load_dwordx4 v14, s[52:55], s66 offen offset:2048 lds
    buffer_load_dwordx4 v15, s[52:55], s66 offen offset:3072 lds
    s_add_u32 m0, s79, s83
    s_nop 0
    buffer_load_dwordx4 v16, s[52:55], s66 offen lds
    s_cmp_eq_u32 s71, 10
    s_cselect_b32 s44, 0xfffffb80, s74
    s_cselect_b32 s45, s73, s84
    s_add_u32 s85, s85, s44
    s_add_u32 s66, s66, s45
    s_add_u32 m0, s76, 32768
    s_nop 0
    s_nop 0
    buffer_load_dwordx4 v4, s[48:51], s86 offen offset:0 lds
    buffer_load_dwordx4 v5, s[48:51], s86 offen offset:1024 lds
    buffer_load_dwordx4 v6, s[48:51], s86 offen offset:2048 lds
    buffer_load_dwordx4 v7, s[48:51], s86 offen offset:3072 lds
    s_xor_b32 m0, m0, 4096
    s_nop 0
    s_nop 0
    buffer_load_dwordx4 v8, s[48:51], s86 offen offset:0 lds
    buffer_load_dwordx4 v9, s[48:51], s86 offen offset:1024 lds
    buffer_load_dwordx4 v10, s[48:51], s86 offen offset:2048 lds
    buffer_load_dwordx4 v11, s[48:51], s86 offen offset:3072 lds
    s_add_u32 m0, s78, s81
    s_add_u32 s72, s72, 1
    buffer_load_dwordx4 v12, s[52:55], s67 offen offset:0 lds
    buffer_load_dwordx4 v13, s[52:55], s67 offen offset:1024 lds
    buffer_load_dwordx4 v14, s[52:55], s67 offen offset:2048 lds
    buffer_load_dwordx4 v15, s[52:55], s67 offen offset:3072 lds
    s_add_u32 m0, s80, s83
    s_nop 0
    buffer_load_dwordx4 v16, s[52:55], s67 offen lds
    s_cmp_eq_u32 s72, 10
    s_cselect_b32 s44, 0xfffffb80, s74
    s_cselect_b32 s45, s73, s84
    s_add_u32 s86, s86, s44
    s_add_u32 s67, s67, s45
    s_waitcnt vmcnt(26)
    s_barrier
    s_add_u32 m0, s75, 65536
    s_nop 0
    s_nop 0
    buffer_load_dwordx4 v4, s[48:51], s85 offen offset:0 lds
    buffer_load_dwordx4 v5, s[48:51], s85 offen offset:1024 lds
    buffer_load_dwordx4 v6, s[48:51], s85 offen offset:2048 lds
    buffer_load_dwordx4 v7, s[48:51], s85 offen offset:3072 lds
    s_xor_b32 m0, m0, 4096
    s_nop 0
    s_nop 0
    buffer_load_dwordx4 v8, s[48:51], s85 offen offset:0 lds
    buffer_load_dwordx4 v9, s[48:51], s85 offen offset:1024 lds
    buffer_load_dwordx4 v10, s[48:51], s85 offen offset:2048 lds
    buffer_load_dwordx4 v11, s[48:51], s85 offen offset:3072 lds
    s_add_u32 m0, s77, s82
    s_add_u32 s71, s71, 1
    buffer_load_dwordx4 v12, s[52:55], s66 offen offset:0 lds
    buffer_load_dwordx4 v13, s[52:55], s66 offen offset:1024 lds
    buffer_load_dwordx4 v14, s[52:55], s66 offen offset:2048 lds
    buffer_load_dwordx4 v15, s[52:55], s66 offen offset:3072 lds
    s_add_u32 m0, s79, s87
    s_nop 0
    buffer_load_dwordx4 v16, s[52:55], s66 offen lds
    s_cmp_eq_u32 s71, 10
    s_cselect_b32 s44, 0xfffffb80, s74
    s_cselect_b32 s45, s73, s84
    s_add_u32 s85, s85, s44
    s_add_u32 s66, s66, s45
    s_add_u32 m0, s76, 65536
    s_nop 0
    s_nop 0
    buffer_load_dwordx4 v4, s[48:51], s86 offen offset:0 lds
    buffer_load_dwordx4 v5, s[48:51], s86 offen offset:1024 lds
    buffer_load_dwordx4 v6, s[48:51], s86 offen offset:2048 lds
    buffer_load_dwordx4 v7, s[48:51], s86 offen offset:3072 lds
    s_xor_b32 m0, m0, 4096
    s_nop 0
    s_nop 0
    buffer_load_dwordx4 v8, s[48:51], s86 offen offset:0 lds
    buffer_load_dwordx4 v9, s[48:51], s86 offen offset:1024 lds
    buffer_load_dwordx4 v10, s[48:51], s86 offen offset:2048 lds
    buffer_load_dwordx4 v11, s[48:51], s86 offen offset:3072 lds
    s_add_u32 m0, s78, s82
    s_add_u32 s72, s72, 1
    buffer_load_dwordx4 v12, s[52:55], s67 offen offset:0 lds
    buffer_load_dwordx4 v13, s[52:55], s67 offen offset:1024 lds
    buffer_load_dwordx4 v14, s[52:55], s67 offen offset:2048 lds
    buffer_load_dwordx4 v15, s[52:55], s67 offen offset:3072 lds
    s_add_u32 m0, s80, s87
    s_nop 0
    buffer_load_dwordx4 v16, s[52:55], s67 offen lds
    s_cmp_eq_u32 s72, 10
    s_cselect_b32 s44, 0xfffffb80, s74
    s_cselect_b32 s45, s73, s84
    s_add_u32 s86, s86, s44
    s_add_u32 s67, s67, s45
    s_waitcnt vmcnt(26)
    v_mov_b32 v2, 163832
    ds_read_b32 v2, v2
    s_mov_b32 s48, s36
    s_mov_b32 s49, s37
    s_nop 0
    s_mov_b32 s50, 0xbc0000
    s_mov_b32 s51, 0x20000
    s_add_u32 s52, s36, 0xc00000
    s_addc_u32 s53, s37, 0
    s_mov_b32 s54, 0x3ac000
    s_mov_b32 s55, 0x20000
    s_mul_i32 s74, s90, 14
    s_min_u32 s74, s74, 40
    s_nop 0
    s_mul_i32 s66, s42, 385024
    s_add_u32 s66, s66, 163840
    s_mul_i32 s67, s43, 481280
    s_add_u32 s67, s67, 204800
    s_cmp_lt_u32 s90, 3
    s_cselect_b32 s50, s66, s50
    s_cselect_b32 s54, s67, s54
    s_add_u32 s56, s36, 0xc00000
    s_addc_u32 s57, s37, 0
    s_mov_b32 s58, 0x3ac000
    s_mov_b32 s59, 0x20000
    s_waitcnt lgkmcnt(0)
    v_readfirstlane_b32 s64, v2
    v_lshlrev_b32 v1, 4, v0
    s_mul_i32 s76, s74, 5120
    s_mul_i32 s66, s43, 481280
    s_add_u32 s76, s76, s66
    s_mul_i32 s77, s101, 35840
    s_add_u32 s76, s76, s77
    s_add_u32 s77, s76, 4096
    s_mul_i32 s75, s101, 5
    s_add_u32 s60, s36, 0x1080000
    s_addc_u32 s61, s37, 0
    s_nop 0
    s_mov_b32 s62, 0x8000
    s_mov_b32 s63, 0x20000
    s_mul_i32 s44, s43, 80
    s_add_u32 s45, s44, 79
    s_lshr_b32 s44, s44, 7
    s_lshr_b32 s45, s45, 7
    s_mul_i32 s44, s44, 47
    s_mul_i32 s45, s45, 47
    s_add_u32 s45, s45, 46
    v_add_u32 v26, s44, v0
    v_add_u32 v27, 64, v26
    v_min_u32 v26, s45, v26
    v_min_u32 v27, s45, v27
    v_lshlrev_b32 v26, 7, v26
    v_lshlrev_b32 v27, 7, v27
    v_mov_b32 v28, 163824
    s_barrier
    ds_read_b32 v29, v28
    s_waitcnt vmcnt(0) lgkmcnt(0)
    v_cmp_ne_u32 vcc, s64, v29
    s_cmp_eq_u64 vcc, 0
    s_cbranch_scc0 Lp_late1
    s_cmp_eq_u32 s41, 1
    s_cbranch_scc1 Lp_essm1
    buffer_load_dwordx4 v[134:137], v1, s[52:55], s76 offen offset:0 sc1
    buffer_load_dwordx4 v[138:141], v1, s[52:55], s76 offen offset:1024 sc1
    buffer_load_dwordx4 v[142:145], v1, s[52:55], s76 offen offset:2048 sc1
    buffer_load_dwordx4 v[146:149], v1, s[52:55], s76 offen offset:3072 sc1
    buffer_load_dwordx4 v[150:153], v1, s[52:55], s77 offen offset:0 sc1
    s_add_u32 s76, s76, 5120
    s_add_u32 s77, s77, 5120
    buffer_load_dwordx4 v[154:157], v1, s[52:55], s76 offen offset:0 sc1
    buffer_load_dwordx4 v[158:161], v1, s[52:55], s76 offen offset:1024 sc1
    buffer_load_dwordx4 v[162:165], v1, s[52:55], s76 offen offset:2048 sc1
    buffer_load_dwordx4 v[166:169], v1, s[52:55], s76 offen offset:3072 sc1
    buffer_load_dwordx4 v[170:173], v1, s[52:55], s77 offen offset:0 sc1
    s_add_u32 s76, s76, 5120
    s_add_u32 s77, s77, 5120
    buffer_load_dwordx4 v[174:177], v1, s[52:55], s76 offen offset:0 sc1
    buffer_load_dwordx4 v[178:181], v1, s[52:55], s76 offen offset:1024 sc1
    s_barrier
    s_nop 0
    buffer_load_dwordx4 v[182:185], v1, s[52:55], s76 offen offset:2048 sc1
    buffer_load_dwordx4 v[186:189], v1, s[52:55], s76 offen offset:3072 sc1
    buffer_load_dwordx4 v[190:193], v1, s[52:55], s77 offen offset:0 sc1
    s_add_u32 s76, s76, 5120
    s_add_u32 s77, s77, 5120
    buffer_load_dwordx4 v[194:197], v1, s[52:55], s76 offen offset:0 sc1
    buffer_load_dwordx4 v[198:201], v1, s[52:55], s76 offen offset:1024 sc1
    buffer_load_dwordx4 v[202:205], v1, s[52:55], s76 offen offset:2048 sc1
    buffer_load_dwordx4 v[206:209], v1, s[52:55], s76 offen offset:3072 sc1
    buffer_load_dwordx4 v[210:213], v1, s[52:55], s77 offen offset:0 sc1
    s_add_u32 s76, s76, 5120
    s_add_u32 s77, s77, 5120
    buffer_load_dwordx4 v[214:217], v1, s[52:55], s76 offen offset:0 sc1
    buffer_load_dwordx4 v[218:221], v1, s[52:55], s76 offen offset:1024 sc1
    s_barrier
    s_setprio 0
    buffer_load_dwordx4 v[222:225], v1, s[52:55], s76 offen offset:2048 sc1
    buffer_load_dwordx4 v[226:229], v1, s[52:55], s76 offen offset:3072 sc1
    buffer_load_dwordx4 v[230:233], v1, s[52:55], s77 offen offset:0 sc1
    s_add_u32 s76, s76, 5120
    s_add_u32 s77, s77, 5120
    buffer_load_dwordx4 v[234:237], v1, s[52:55], s76 offen offset:0 sc1
    buffer_load_dwordx4 v[238:241], v1, s[52:55], s76 offen offset:1024 sc1
    buffer_load_dwordx4 v[242:245], v1, s[52:55], s76 offen offset:2048 sc1
    buffer_load_dwordx4 v[246:249], v1, s[52:55], s76 offen offset:3072 sc1
    buffer_load_dwordx4 v[250:253], v1, s[52:55], s77 offen offset:0 sc1
    s_add_u32 s76, s76, 5120
    s_add_u32 s77, s77, 5120
    s_add_u32 s69, s90, 0
    s_mul_i32 s68, s69, 43
    s_lshr_b32 s68, s68, 8
    s_mul_i32 s70, s68, 6
    s_sub_u32 s70, s69, s70
    s_add_u32 s70, s70, s75
    s_cmp_ge_u32 s70, 8
    s_cselect_b32 s71, 46, 56
    s_add_u32 s70, s70, s71
    s_mul_i32 s68, s68, 10
    s_add_u32 s68, s68, s70
    s_mul_i32 s68, s68, 5120
    s_add_u32 s68, s68, s66
    s_mul_i32 m0, s69, 5120
    s_add_u32 s70, s68, 4096
    buffer_load_dwordx4 v1, s[56:59], s68 offen offset:0 sc1 lds
    buffer_load_dwordx4 v1, s[56:59], s68 offen offset:1024 sc1 lds
    buffer_load_dwordx4 v1, s[56:59], s68 offen offset:2048 sc1 lds
    buffer_load_dwordx4 v1, s[56:59], s68 offen offset:3072 sc1 lds
    s_add_u32 m0, m0, 4096
    s_nop 0
    buffer_load_dwordx4 v1, s[56:59], s70 offen offset:0 sc1 lds
    s_add_u32 s69, s90, 4
    s_mul_i32 s68, s69, 43
    s_lshr_b32 s68, s68, 8
    s_mul_i32 s70, s68, 6
    s_sub_u32 s70, s69, s70
    s_add_u32 s70, s70, s75
    s_cmp_ge_u32 s70, 8
    s_cselect_b32 s71, 46, 56
    s_add_u32 s70, s70, s71
    s_mul_i32 s68, s68, 10
    s_add_u32 s68, s68, s70
    s_mul_i32 s68, s68, 5120
    s_add_u32 s68, s68, s66
    s_nop 0
    s_mul_i32 m0, s69, 5120
    s_add_u32 s70, s68, 4096
    buffer_load_dwordx4 v1, s[56:59], s68 offen offset:0 sc1 lds
    buffer_load_dwordx4 v1, s[56:59], s68 offen offset:1024 sc1 lds
    buffer_load_dwordx4 v1, s[56:59], s68 offen offset:2048 sc1 lds
    buffer_load_dwordx4 v1, s[56:59], s68 offen offset:3072 sc1 lds
    s_add_u32 m0, m0, 4096
    s_nop 0
    buffer_load_dwordx4 v1, s[56:59], s70 offen offset:0 sc1 lds
    s_add_u32 s69, s90, 8
    s_mul_i32 s68, s69, 43
    s_lshr_b32 s68, s68, 8
    s_mul_i32 s70, s68, 6
    s_sub_u32 s70, s69, s70
    s_add_u32 s70, s70, s75
    s_cmp_ge_u32 s70, 8
    s_cselect_b32 s71, 46, 56
    s_add_u32 s70, s70, s71
    s_mul_i32 s68, s68, 10
    s_add_u32 s68, s68, s70
    s_mul_i32 s68, s68, 5120
    s_add_u32 s68, s68, s66
    s_nop 0
    s_mul_i32 m0, s69, 5120
    s_add_u32 s70, s68, 4096
    buffer_load_dwordx4 v1, s[56:59], s68 offen offset:0 sc1 lds
    buffer_load_dwordx4 v1, s[56:59], s68 offen offset:1024 sc1 lds
    s_barrier
    s_setprio 0
    s_lshl_b32 s67, s90, 2
    s_add_u32 s67, s67, 160512
    v_mov_b32 v2, s67
    v_mov_b32 v3, s64
    ds_write_b32 v2, v3 offset:144
    s_waitcnt vmcnt(5)
    buffer_load_dwordx4 v1, s[56:59], s68 offen offset:2048 sc1 lds
    s_waitcnt vmcnt(5)
    buffer_load_dwordx4 v1, s[56:59], s68 offen offset:3072 sc1 lds
    s_add_u32 m0, m0, 4096
    s_nop 0
    s_waitcnt vmcnt(5)
    buffer_load_dwordx4 v1, s[56:59], s70 offen offset:0 sc1 lds
    s_add_u32 s69, s90, 12
    s_mul_i32 s68, s69, 43
    s_lshr_b32 s68, s68, 8
    s_mul_i32 s70, s68, 6
    s_sub_u32 s70, s69, s70
    s_add_u32 s70, s70, s75
    s_cmp_ge_u32 s70, 8
    s_cselect_b32 s71, 46, 56
    s_add_u32 s70, s70, s71
    s_mul_i32 s68, s68, 10
    s_add_u32 s68, s68, s70
    s_mul_i32 s68, s68, 5120
    s_add_u32 s68, s68, s66
    s_mul_i32 m0, s69, 5120
    s_add_u32 s70, s68, 4096
    s_waitcnt vmcnt(5)
    buffer_load_dwordx4 v1, s[56:59], s68 offen offset:0 sc1 lds
    s_waitcnt vmcnt(5)
    buffer_load_dwordx4 v1, s[56:59], s68 offen offset:1024 sc1 lds
    s_waitcnt vmcnt(5)
    buffer_load_dwordx4 v1, s[56:59], s68 offen offset:2048 sc1 lds
    s_waitcnt vmcnt(5)
    buffer_load_dwordx4 v1, s[56:59], s68 offen offset:3072 sc1 lds
    s_add_u32 m0, m0, 4096
    s_nop 0
    s_waitcnt vmcnt(5)
    buffer_load_dwordx4 v1, s[56:59], s70 offen offset:0 sc1 lds
    s_add_u32 s69, s90, 16
    s_mul_i32 s68, s69, 43
    s_lshr_b32 s68, s68, 8
    s_mul_i32 s70, s68, 6
    s_sub_u32 s70, s69, s70
    s_add_u32 s70, s70, s75
    s_cmp_ge_u32 s70, 8
    s_cselect_b32 s71, 46, 56
    s_add_u32 s70, s70, s71
    s_mul_i32 s68, s68, 10
    s_add_u32 s68, s68, s70
    s_mul_i32 s68, s68, 5120
    s_add_u32 s68, s68, s66
    s_mul_i32 m0, s69, 5120
    s_add_u32 s70, s68, 4096
    s_waitcnt vmcnt(5)
    buffer_load_dwordx4 v1, s[56:59], s68 offen offset:0 sc1 lds
    s_waitcnt vmcnt(5)
    buffer_load_dwordx4 v1, s[56:59], s68 offen offset:1024 sc1 lds
    s_waitcnt vmcnt(5)
    buffer_load_dwordx4 v1, s[56:59], s68 offen offset:2048 sc1 lds
    s_waitcnt vmcnt(5)
    buffer_load_dwordx4 v1, s[56:59], s68 offen offset:3072 sc1 lds
    s_add_u32 m0, m0, 4096
    s_nop 0
    s_waitcnt vmcnt(5)
    buffer_load_dwordx4 v1, s[56:59], s70 offen offset:0 sc1 lds
    s_add_u32 s69, s90, 20
    s_mul_i32 s68, s69, 43
    s_lshr_b32 s68, s68, 8
    s_mul_i32 s70, s68, 6
    s_sub_u32 s70, s69, s70
    s_add_u32 s70, s70, s75
    s_cmp_ge_u32 s70, 8
    s_cselect_b32 s71, 46, 56
    s_add_u32 s70, s70, s71
    s_mul_i32 s68, s68, 10
    s_add_u32 s68, s68, s70
    s_mul_i32 s68, s68, 5120
    s_add_u32 s68, s68, s66
    s_mul_i32 m0, s69, 5120
    s_add_u32 s70, s68, 4096
    s_waitcnt vmcnt(5)
    buffer_load_dwordx4 v1, s[56:59], s68 offen offset:0 sc1 lds
    s_waitcnt vmcnt(5)
    buffer_load_dwordx4 v1, s[56:59], s68 offen offset:1024 sc1 lds
    s_waitcnt vmcnt(5)
    buffer_load_dwordx4 v1, s[56:59], s68 offen offset:2048 sc1 lds
    s_waitcnt vmcnt(5)
    buffer_load_dwordx4 v1, s[56:59], s68 offen offset:3072 sc1 lds
    s_add_u32 m0, m0, 4096
    s_nop 0
    s_waitcnt vmcnt(5)
    buffer_load_dwordx4 v1, s[56:59], s70 offen offset:0 sc1 lds
    s_branch Lp_done1
Lp_essm1:
    buffer_load_dwordx4 v[134:137], v1, s[52:55], s76 offen offset:0 sc1
    buffer_load_dwordx4 v[138:141], v1, s[52:55], s76 offen offset:1024 sc1
    buffer_load_dwordx4 v[142:145], v1, s[52:55], s76 offen offset:2048 sc1
    buffer_load_dwordx4 v[146:149], v1, s[52:55], s76 offen offset:3072 sc1
    buffer_load_dwordx4 v[150:153], v1, s[52:55], s77 offen offset:0 sc1
    s_add_u32 s76, s76, 5120
    s_add_u32 s77, s77, 5120
    buffer_load_dwordx4 v[154:157], v1, s[52:55], s76 offen offset:0 sc1
    buffer_load_dwordx4 v[158:161], v1, s[52:55], s76 offen offset:1024 sc1
    buffer_load_dwordx4 v[162:165], v1, s[52:55], s76 offen offset:2048 sc1
    buffer_load_dwordx4 v[166:169], v1, s[52:55], s76 offen offset:3072 sc1
    buffer_load_dwordx4 v[170:173], v1, s[52:55], s77 offen offset:0 sc1
    s_add_u32 s76, s76, 5120
    s_add_u32 s77, s77, 5120
    buffer_load_dwordx4 v[174:177], v1, s[52:55], s76 offen offset:0 sc1
    buffer_load_dwordx4 v[178:181], v1, s[52:55], s76 offen offset:1024 sc1
    buffer_load_dwordx4 v[182:185], v1, s[52:55], s76 offen offset:2048 sc1
    buffer_load_dwordx4 v[186:189], v1, s[52:55], s76 offen offset:3072 sc1
    buffer_load_dwordx4 v[190:193], v1, s[52:55], s77 offen offset:0 sc1
    s_add_u32 s76, s76, 5120
    s_add_u32 s77, s77, 5120
    buffer_load_dwordx4 v[194:197], v1, s[52:55], s76 offen offset:0 sc1
    s_barrier
    s_nop 0
    buffer_load_dwordx4 v[198:201], v1, s[52:55], s76 offen offset:1024 sc1
    buffer_load_dwordx4 v[202:205], v1, s[52:55], s76 offen offset:2048 sc1
    buffer_load_dwordx4 v[206:209], v1, s[52:55], s76 offen offset:3072 sc1
    buffer_load_dwordx4 v[210:213], v1, s[52:55], s77 offen offset:0 sc1
    s_add_u32 s76, s76, 5120
    s_add_u32 s77, s77, 5120
    buffer_load_dwordx4 v[214:217], v1, s[52:55], s76 offen offset:0 sc1
    buffer_load_dwordx4 v[218:221], v1, s[52:55], s76 offen offset:1024 sc1
    buffer_load_dwordx4 v[222:225], v1, s[52:55], s76 offen offset:2048 sc1
    buffer_load_dwordx4 v[226:229], v1, s[52:55], s76 offen offset:3072 sc1
    buffer_load_dwordx4 v[230:233], v1, s[52:55], s77 offen offset:0 sc1
    s_add_u32 s76, s76, 5120
    s_add_u32 s77, s77, 5120
    buffer_load_dwordx4 v[234:237], v1, s[52:55], s76 offen offset:0 sc1
    buffer_load_dwordx4 v[238:241], v1, s[52:55], s76 offen offset:1024 sc1
    buffer_load_dwordx4 v[242:245], v1, s[52:55], s76 offen offset:2048 sc1
    buffer_load_dwordx4 v[246:249], v1, s[52:55], s76 offen offset:3072 sc1
    buffer_load_dwordx4 v[250:253], v1, s[52:55], s77 offen offset:0 sc1
    s_add_u32 s76, s76, 5120
    s_add_u32 s77, s77, 5120
    s_add_u32 s69, s90, 0
    s_mul_i32 s68, s69, 43
    s_lshr_b32 s68, s68, 8
    s_mul_i32 s70, s68, 6
    s_sub_u32 s70, s69, s70
    s_add_u32 s70, s70, s75
    s_cmp_ge_u32 s70, 8
    s_cselect_b32 s71, 46, 56
    s_add_u32 s70, s70, s71
    s_mul_i32 s68, s68, 10
    s_add_u32 s68, s68, s70
    s_mul_i32 s68, s68, 5120
    s_add_u32 s68, s68, s66
    s_mul_i32 m0, s69, 5120
    s_add_u32 s70, s68, 4096
    buffer_load_dwordx4 v1, s[56:59], s68 offen offset:0 sc1 lds
    buffer_load_dwordx4 v1, s[56:59], s68 offen offset:1024 sc1 lds
    buffer_load_dwordx4 v1, s[56:59], s68 offen offset:2048 sc1 lds
    buffer_load_dwordx4 v1, s[56:59], s68 offen offset:3072 sc1 lds
    s_barrier
    s_setprio 0
    s_lshl_b32 s67, s90, 2
    s_add_u32 s67, s67, 160512
    v_mov_b32 v2, s67
    v_mov_b32 v3, s64
    ds_write_b32 v2, v3 offset:144
    s_add_u32 m0, m0, 4096
    s_nop 0
    s_waitcnt vmcnt(5)
    buffer_load_dwordx4 v1, s[56:59], s70 offen offset:0 sc1 lds
    s_add_u32 s69, s90, 4
    s_mul_i32 s68, s69, 43
    s_lshr_b32 s68, s68, 8
    s_mul_i32 s70, s68, 6
    s_sub_u32 s70, s69, s70
    s_add_u32 s70, s70, s75
    s_cmp_ge_u32 s70, 8
    s_cselect_b32 s71, 46, 56
    s_add_u32 s70, s70, s71
    s_mul_i32 s68, s68, 10
    s_add_u32 s68, s68, s70
    s_mul_i32 s68, s68, 5120
    s_add_u32 s68, s68, s66
    s_mul_i32 m0, s69, 5120
    s_add_u32 s70, s68, 4096
    s_waitcnt vmcnt(5)
    buffer_load_dwordx4 v1, s[56:59], s68 offen offset:0 sc1 lds
    s_waitcnt vmcnt(5)
    buffer_load_dwordx4 v1, s[56:59], s68 offen offset:1024 sc1 lds
    s_waitcnt vmcnt(5)
    buffer_load_dwordx4 v1, s[56:59], s68 offen offset:2048 sc1 lds
    s_waitcnt vmcnt(5)
    buffer_load_dwordx4 v1, s[56:59], s68 offen offset:3072 sc1 lds
    s_add_u32 m0, m0, 4096
    s_nop 0
    s_waitcnt vmcnt(5)
    buffer_load_dwordx4 v1, s[56:59], s70 offen offset:0 sc1 lds
    s_add_u32 s69, s90, 8
    s_mul_i32 s68, s69, 43
    s_lshr_b32 s68, s68, 8
    s_mul_i32 s70, s68, 6
    s_sub_u32 s70, s69, s70
    s_add_u32 s70, s70, s75
    s_cmp_ge_u32 s70, 8
    s_cselect_b32 s71, 46, 56
    s_add_u32 s70, s70, s71
    s_mul_i32 s68, s68, 10
    s_add_u32 s68, s68, s70
    s_mul_i32 s68, s68, 5120
    s_add_u32 s68, s68, s66
    s_mul_i32 m0, s69, 5120
    s_add_u32 s70, s68, 4096
    s_waitcnt vmcnt(5)
    buffer_load_dwordx4 v1, s[56:59], s68 offen offset:0 sc1 lds
    s_waitcnt vmcnt(5)
    buffer_load_dwordx4 v1, s[56:59], s68 offen offset:1024 sc1 lds
    s_waitcnt vmcnt(5)
    buffer_load_dwordx4 v1, s[56:59], s68 offen offset:2048 sc1 lds
    s_waitcnt vmcnt(5)
    buffer_load_dwordx4 v1, s[56:59], s68 offen offset:3072 sc1 lds
    s_add_u32 m0, m0, 4096
    s_nop 0
    s_waitcnt vmcnt(5)
    buffer_load_dwordx4 v1, s[56:59], s70 offen offset:0 sc1 lds
    s_add_u32 s69, s90, 12
    s_mul_i32 s68, s69, 43
    s_lshr_b32 s68, s68, 8
    s_mul_i32 s70, s68, 6
    s_sub_u32 s70, s69, s70
    s_add_u32 s70, s70, s75
    s_cmp_ge_u32 s70, 8
    s_cselect_b32 s71, 46, 56
    s_add_u32 s70, s70, s71
    s_mul_i32 s68, s68, 10
    s_add_u32 s68, s68, s70
    s_mul_i32 s68, s68, 5120
    s_add_u32 s68, s68, s66
    s_mul_i32 m0, s69, 5120
    s_add_u32 s70, s68, 4096
    s_waitcnt vmcnt(5)
    buffer_load_dwordx4 v1, s[56:59], s68 offen offset:0 sc1 lds
    s_waitcnt vmcnt(5)
    buffer_load_dwordx4 v1, s[56:59], s68 offen offset:1024 sc1 lds
    s_waitcnt vmcnt(5)
    buffer_load_dwordx4 v1, s[56:59], s68 offen offset:2048 sc1 lds
    s_waitcnt vmcnt(5)
    buffer_load_dwordx4 v1, s[56:59], s68 offen offset:3072 sc1 lds
    s_add_u32 m0, m0, 4096
    s_nop 0
    s_waitcnt vmcnt(5)
    buffer_load_dwordx4 v1, s[56:59], s70 offen offset:0 sc1 lds
    s_add_u32 s69, s90, 16
    s_mul_i32 s68, s69, 43
    s_lshr_b32 s68, s68, 8
    s_mul_i32 s70, s68, 6
    s_sub_u32 s70, s69, s70
    s_add_u32 s70, s70, s75
    s_cmp_ge_u32 s70, 8
    s_cselect_b32 s71, 46, 56
    s_add_u32 s70, s70, s71
    s_mul_i32 s68, s68, 10
    s_add_u32 s68, s68, s70
    s_mul_i32 s68, s68, 5120
    s_add_u32 s68, s68, s66
    s_mul_i32 m0, s69, 5120
    s_add_u32 s70, s68, 4096
    s_waitcnt vmcnt(5)
    buffer_load_dwordx4 v1, s[56:59], s68 offen offset:0 sc1 lds
    s_waitcnt vmcnt(5)
    buffer_load_dwordx4 v1, s[56:59], s68 offen offset:1024 sc1 lds
    s_waitcnt vmcnt(5)
    buffer_load_dwordx4 v1, s[56:59], s68 offen offset:2048 sc1 lds
    s_waitcnt vmcnt(5)
    buffer_load_dwordx4 v1, s[56:59], s68 offen offset:3072 sc1 lds
    s_add_u32 m0, m0, 4096
    s_nop 0
    s_waitcnt vmcnt(5)
    buffer_load_dwordx4 v1, s[56:59], s70 offen offset:0 sc1 lds
    s_add_u32 s69, s90, 20
    s_mul_i32 s68, s69, 43
    s_lshr_b32 s68, s68, 8
    s_mul_i32 s70, s68, 6
    s_sub_u32 s70, s69, s70
    s_add_u32 s70, s70, s75
    s_cmp_ge_u32 s70, 8
    s_cselect_b32 s71, 46, 56
    s_add_u32 s70, s70, s71
    s_mul_i32 s68, s68, 10
    s_add_u32 s68, s68, s70
    s_mul_i32 s68, s68, 5120
    s_add_u32 s68, s68, s66
    s_mul_i32 m0, s69, 5120
    s_add_u32 s70, s68, 4096
    s_waitcnt vmcnt(5)
    buffer_load_dwordx4 v1, s[56:59], s68 offen offset:0 sc1 lds
    s_waitcnt vmcnt(5)
    buffer_load_dwordx4 v1, s[56:59], s68 offen offset:1024 sc1 lds
    s_waitcnt vmcnt(5)
    buffer_load_dwordx4 v1, s[56:59], s68 offen offset:2048 sc1 lds
    s_waitcnt vmcnt(5)
    buffer_load_dwordx4 v1, s[56:59], s68 offen offset:3072 sc1 lds
    s_add_u32 m0, m0, 4096
    s_nop 0
    s_waitcnt vmcnt(5)
    buffer_load_dwordx4 v1, s[56:59], s70 offen offset:0 sc1 lds
    s_branch Lp_done1
Lp_late1:
    s_barrier
    s_cmp_eq_u32 s41, 1
    s_cbranch_scc1 Lp_no9b1
    s_barrier
Lp_no9b1:
    s_barrier
    s_mov_b32 s72, 0
Lfw_poll1:
    buffer_load_dword v24, v26, s[60:63], 0 offen sc1
    buffer_load_dword v25, v27, s[60:63], 0 offen sc1
    s_waitcnt vmcnt(0)
    v_xor_b32 v24, s64, v24
    v_xor_b32 v25, s64, v25
    v_or_b32 v24, v24, v25
    v_cmp_ne_u32 vcc, 0, v24
    s_cmp_eq_u64 vcc, 0
    s_cbranch_scc1 Lfw_got1
    s_sleep 12
    s_add_u32 s72, s72, 1
    s_cmp_lt_u32 s72, 0x40000
    s_cbranch_scc1 Lfw_poll1
Lfw_got1:
    s_setprio 0
    s_lshl_b32 s67, s90, 2
    s_add_u32 s67, s67, 160512
    v_mov_b32 v2, s67
    v_mov_b32_e64 v3, s64
    ds_write_b32 v2, v3 offset:144
    s_waitcnt vmcnt(7)
    buffer_load_dwordx4 v[134:137], v1, s[52:55], s76 offen offset:0 sc1
    s_waitcnt vmcnt(7)
    buffer_load_dwordx4 v[138:141], v1, s[52:55], s76 offen offset:1024 sc1
    s_waitcnt vmcnt(7)
    buffer_load_dwordx4 v[142:145], v1, s[52:55], s76 offen offset:2048 sc1
    s_waitcnt vmcnt(7)
    buffer_load_dwordx4 v[146:149], v1, s[52:55], s76 offen offset:3072 sc1
    s_waitcnt vmcnt(7)
    buffer_load_dwordx4 v[150:153], v1, s[52:55], s77 offen offset:0 sc1
    s_add_u32 s76, s76, 5120
    s_add_u32 s77, s77, 5120
    s_waitcnt vmcnt(7)
    buffer_load_dwordx4 v[154:157], v1, s[52:55], s76 offen offset:0 sc1
    s_waitcnt vmcnt(7)
    buffer_load_dwordx4 v[158:161], v1, s[52:55], s76 offen offset:1024 sc1
    s_waitcnt vmcnt(7)
    buffer_load_dwordx4 v[162:165], v1, s[52:55], s76 offen offset:2048 sc1
    s_waitcnt vmcnt(7)
    buffer_load_dwordx4 v[166:169], v1, s[52:55], s76 offen offset:3072 sc1
    s_waitcnt vmcnt(7)
    s_nop 0
    buffer_load_dwordx4 v[170:173], v1, s[52:55], s77 offen offset:0 sc1
    s_add_u32 s76, s76, 5120
    s_add_u32 s77, s77, 5120
    s_waitcnt vmcnt(7)
    buffer_load_dwordx4 v[174:177], v1, s[52:55], s76 offen offset:0 sc1
    s_waitcnt vmcnt(7)
    buffer_load_dwordx4 v[178:181], v1, s[52:55], s76 offen offset:1024 sc1
    s_waitcnt vmcnt(7)
    buffer_load_dwordx4 v[182:185], v1, s[52:55], s76 offen offset:2048 sc1
    s_waitcnt vmcnt(7)
    buffer_load_dwordx4 v[186:189], v1, s[52:55], s76 offen offset:3072 sc1
    s_waitcnt vmcnt(7)
    s_nop 0
    buffer_load_dwordx4 v[190:193], v1, s[52:55], s77 offen offset:0 sc1
    s_add_u32 s76, s76, 5120
    s_add_u32 s77, s77, 5120
    s_waitcnt vmcnt(7)
    buffer_load_dwordx4 v[194:197], v1, s[52:55], s76 offen offset:0 sc1
    s_waitcnt vmcnt(7)
    buffer_load_dwordx4 v[198:201], v1, s[52:55], s76 offen offset:1024 sc1
    s_waitcnt vmcnt(7)
    buffer_load_dwordx4 v[202:205], v1, s[52:55], s76 offen offset:2048 sc1
    s_waitcnt vmcnt(7)
    buffer_load_dwordx4 v[206:209], v1, s[52:55], s76 offen offset:3072 sc1
    s_waitcnt vmcnt(7)
    s_nop 0
    buffer_load_dwordx4 v[210:213], v1, s[52:55], s77 offen offset:0 sc1
    s_add_u32 s76, s76, 5120
    s_add_u32 s77, s77, 5120
    s_waitcnt vmcnt(7)
    buffer_load_dwordx4 v[214:217], v1, s[52:55], s76 offen offset:0 sc1
    s_waitcnt vmcnt(7)
    buffer_load_dwordx4 v[218:221], v1, s[52:55], s76 offen offset:1024 sc1
    s_waitcnt vmcnt(7)
    buffer_load_dwordx4 v[222:225], v1, s[52:55], s76 offen offset:2048 sc1
    s_waitcnt vmcnt(7)
    buffer_load_dwordx4 v[226:229], v1, s[52:55], s76 offen offset:3072 sc1
    s_waitcnt vmcnt(7)
    s_nop 0
    buffer_load_dwordx4 v[230:233], v1, s[52:55], s77 offen offset:0 sc1
    s_add_u32 s76, s76, 5120
    s_add_u32 s77, s77, 5120
    s_waitcnt vmcnt(7)
    buffer_load_dwordx4 v[234:237], v1, s[52:55], s76 offen offset:0 sc1
    s_waitcnt vmcnt(7)
    buffer_load_dwordx4 v[238:241], v1, s[52:55], s76 offen offset:1024 sc1
    s_waitcnt vmcnt(7)
    buffer_load_dwordx4 v[242:245], v1, s[52:55], s76 offen offset:2048 sc1
    s_waitcnt vmcnt(7)
    buffer_load_dwordx4 v[246:249], v1, s[52:55], s76 offen offset:3072 sc1
    s_waitcnt vmcnt(7)
    s_nop 0
    buffer_load_dwordx4 v[250:253], v1, s[52:55], s77 offen offset:0 sc1
    s_add_u32 s76, s76, 5120
    s_add_u32 s77, s77, 5120
    s_add_u32 s69, s90, 0
    s_mul_i32 s68, s69, 43
    s_lshr_b32 s68, s68, 8
    s_mul_i32 s70, s68, 6
    s_sub_u32 s70, s69, s70
    s_add_u32 s70, s70, s75
    s_cmp_ge_u32 s70, 8
    s_cselect_b32 s71, 46, 56
    s_add_u32 s70, s70, s71
    s_mul_i32 s68, s68, 10
    s_add_u32 s68, s68, s70
    s_mul_i32 s68, s68, 5120
    s_add_u32 s68, s68, s66
    s_mul_i32 m0, s69, 5120
    s_add_u32 s70, s68, 4096
    s_waitcnt vmcnt(7)
    buffer_load_dwordx4 v1, s[56:59], s68 offen offset:0 sc1 lds
    s_waitcnt vmcnt(7)
    buffer_load_dwordx4 v1, s[56:59], s68 offen offset:1024 sc1 lds
    s_waitcnt vmcnt(7)
    buffer_load_dwordx4 v1, s[56:59], s68 offen offset:2048 sc1 lds
    s_waitcnt vmcnt(7)
    buffer_load_dwordx4 v1, s[56:59], s68 offen offset:3072 sc1 lds
    s_add_u32 m0, m0, 4096
    s_nop 0
    s_waitcnt vmcnt(7)
    buffer_load_dwordx4 v1, s[56:59], s70 offen offset:0 sc1 lds
    s_add_u32 s69, s90, 4
    s_mul_i32 s68, s69, 43
    s_lshr_b32 s68, s68, 8
    s_mul_i32 s70, s68, 6
    s_sub_u32 s70, s69, s70
    s_add_u32 s70, s70, s75
    s_cmp_ge_u32 s70, 8
    s_cselect_b32 s71, 46, 56
    s_add_u32 s70, s70, s71
    s_mul_i32 s68, s68, 10
    s_add_u32 s68, s68, s70
    s_mul_i32 s68, s68, 5120
    s_add_u32 s68, s68, s66
    s_mul_i32 m0, s69, 5120
    s_add_u32 s70, s68, 4096
    s_waitcnt vmcnt(7)
    buffer_load_dwordx4 v1, s[56:59], s68 offen offset:0 sc1 lds
    s_waitcnt vmcnt(7)
    buffer_load_dwordx4 v1, s[56:59], s68 offen offset:1024 sc1 lds
    s_waitcnt vmcnt(7)
    buffer_load_dwordx4 v1, s[56:59], s68 offen offset:2048 sc1 lds
    s_waitcnt vmcnt(7)
    buffer_load_dwordx4 v1, s[56:59], s68 offen offset:3072 sc1 lds
    s_add_u32 m0, m0, 4096
    s_nop 0
    s_waitcnt vmcnt(7)
    buffer_load_dwordx4 v1, s[56:59], s70 offen offset:0 sc1 lds
    s_add_u32 s69, s90, 8
    s_mul_i32 s68, s69, 43
    s_lshr_b32 s68, s68, 8
    s_mul_i32 s70, s68, 6
    s_sub_u32 s70, s69, s70
    s_add_u32 s70, s70, s75
    s_cmp_ge_u32 s70, 8
    s_cselect_b32 s71, 46, 56
    s_add_u32 s70, s70, s71
    s_mul_i32 s68, s68, 10
    s_add_u32 s68, s68, s70
    s_mul_i32 s68, s68, 5120
    s_add_u32 s68, s68, s66
    s_mul_i32 m0, s69, 5120
    s_add_u32 s70, s68, 4096
    s_waitcnt vmcnt(7)
    buffer_load_dwordx4 v1, s[56:59], s68 offen offset:0 sc1 lds
    s_waitcnt vmcnt(7)
    buffer_load_dwordx4 v1, s[56:59], s68 offen offset:1024 sc1 lds
    s_waitcnt vmcnt(7)
    buffer_load_dwordx4 v1, s[56:59], s68 offen offset:2048 sc1 lds
    s_waitcnt vmcnt(7)
    buffer_load_dwordx4 v1, s[56:59], s68 offen offset:3072 sc1 lds
    s_add_u32 m0, m0, 4096
    s_nop 0
    s_waitcnt vmcnt(7)
    buffer_load_dwordx4 v1, s[56:59], s70 offen offset:0 sc1 lds
    s_add_u32 s69, s90, 12
    s_mul_i32 s68, s69, 43
    s_lshr_b32 s68, s68, 8
    s_mul_i32 s70, s68, 6
    s_sub_u32 s70, s69, s70
    s_add_u32 s70, s70, s75
    s_cmp_ge_u32 s70, 8
    s_cselect_b32 s71, 46, 56
    s_add_u32 s70, s70, s71
    s_mul_i32 s68, s68, 10
    s_add_u32 s68, s68, s70
    s_mul_i32 s68, s68, 5120
    s_add_u32 s68, s68, s66
    s_mul_i32 m0, s69, 5120
    s_add_u32 s70, s68, 4096
    s_waitcnt vmcnt(7)
    buffer_load_dwordx4 v1, s[56:59], s68 offen offset:0 sc1 lds
    s_waitcnt vmcnt(7)
    buffer_load_dwordx4 v1, s[56:59], s68 offen offset:1024 sc1 lds
    s_waitcnt vmcnt(7)
    buffer_load_dwordx4 v1, s[56:59], s68 offen offset:2048 sc1 lds
    s_waitcnt vmcnt(7)
    buffer_load_dwordx4 v1, s[56:59], s68 offen offset:3072 sc1 lds
    s_add_u32 m0, m0, 4096
    s_nop 0
    s_waitcnt vmcnt(7)
    buffer_load_dwordx4 v1, s[56:59], s70 offen offset:0 sc1 lds
    s_add_u32 s69, s90, 16
    s_mul_i32 s68, s69, 43
    s_lshr_b32 s68, s68, 8
    s_mul_i32 s70, s68, 6
    s_sub_u32 s70, s69, s70
    s_add_u32 s70, s70, s75
    s_cmp_ge_u32 s70, 8
    s_cselect_b32 s71, 46, 56
    s_add_u32 s70, s70, s71
    s_mul_i32 s68, s68, 10
    s_add_u32 s68, s68, s70
    s_mul_i32 s68, s68, 5120
    s_add_u32 s68, s68, s66
    s_mul_i32 m0, s69, 5120
    s_add_u32 s70, s68, 4096
    s_waitcnt vmcnt(7)
    buffer_load_dwordx4 v1, s[56:59], s68 offen offset:0 sc1 lds
    s_waitcnt vmcnt(7)
    buffer_load_dwordx4 v1, s[56:59], s68 offen offset:1024 sc1 lds
    s_waitcnt vmcnt(7)
    buffer_load_dwordx4 v1, s[56:59], s68 offen offset:2048 sc1 lds
    s_waitcnt vmcnt(7)
    buffer_load_dwordx4 v1, s[56:59], s68 offen offset:3072 sc1 lds
    s_add_u32 m0, m0, 4096
    s_nop 0
    s_waitcnt vmcnt(7)
    buffer_load_dwordx4 v1, s[56:59], s70 offen offset:0 sc1 lds
    s_add_u32 s69, s90, 20
    s_mul_i32 s68, s69, 43
    s_lshr_b32 s68, s68, 8
    s_mul_i32 s70, s68, 6
    s_sub_u32 s70, s69, s70
    s_add_u32 s70, s70, s75
    s_cmp_ge_u32 s70, 8
    s_cselect_b32 s71, 46, 56
    s_add_u32 s70, s70, s71
    s_mul_i32 s68, s68, 10
    s_add_u32 s68, s68, s70
    s_mul_i32 s68, s68, 5120
    s_add_u32 s68, s68, s66
    s_mul_i32 m0, s69, 5120
    s_add_u32 s70, s68, 4096
    s_waitcnt vmcnt(7)
    buffer_load_dwordx4 v1, s[56:59], s68 offen offset:0 sc1 lds
    s_waitcnt vmcnt(7)
    buffer_load_dwordx4 v1, s[56:59], s68 offen offset:1024 sc1 lds
    s_waitcnt vmcnt(7)
    buffer_load_dwordx4 v1, s[56:59], s68 offen offset:2048 sc1 lds
    s_waitcnt vmcnt(7)
    buffer_load_dwordx4 v1, s[56:59], s68 offen offset:3072 sc1 lds
    s_add_u32 m0, m0, 4096
    s_nop 0
    s_waitcnt vmcnt(7)
    buffer_load_dwordx4 v1, s[56:59], s70 offen offset:0 sc1 lds
Lp_done1:
    s_waitcnt vmcnt(0)
    s_lshl_b32 s66, s90, 2
    s_add_u32 s66, s66, 160512
    v_mov_b32 v2, s66
    v_mov_b32 v3, s64
    ds_write_b32 v2, v3
    s_branch L_p2l
L_helper:
    s_setprio 2
    s_and_b32 s42, s2, 6
    s_bfe_u32 s43, s2, 0x30003
    s_lshl2_add_u32 s42, s42, s43
    s_and_b32 s43, s2, 1
    s_lshr_b32 s101, s2, 6
    s_lshl2_add_u32 s43, s43, s101
    s_mov_b32 s101, 0
    s_waitcnt lgkmcnt(0)
    s_getpc_b64 s[56:57]
Lpc:
    s_sub_u32 s56, s56, Lpc-gated_mix__ssm_conv_s5__glu_gated_swiglu__prompt_kernel
    s_subb_u32 s57, s57, 0
    s_mov_b32 s58, L_codeend-gated_mix__ssm_conv_s5__glu_gated_swiglu__prompt_kernel
    s_mov_b32 s59, 0x20000
    s_lshr_b32 s66, s2, 3
    s_lshl_b32 s66, s66, 1
    s_add_u32 s66, s66, s90
    s_sub_u32 s66, s66, 2
    s_lshl_b32 s66, s66, 10
    v_lshlrev_b32 v21, 4, v0
    buffer_load_dwordx4 v[24:27], v21, s[56:59], s66 offen
    s_mov_b32 s60, s34
    s_mov_b32 s61, s35
    s_mov_b32 s62, 0x100
    s_mov_b32 s63, 0x20000
    v_mov_b32 v19, 0
    s_lshl_b32 s65, s2, 2
    s_lshl_b32 s66, s90, 1
    s_add_u32 s65, s65, s66
    s_sub_u32 s65, s65, 4
    s_cmp_lg_u32 s65, 0
    s_cbranch_scc1 Lh_nononce
    s_memrealtime s[66:67]
    s_waitcnt lgkmcnt(0)
    s_or_b32 s66, s66, 1
    v_mov_b32 v20, s66
    s_mov_b64 exec, 1
    buffer_store_dword v20, v19, s[60:63], 0 offen sc1
    s_mov_b64 exec, -1
Lh_nononce:
    s_mov_b32 s52, s30
    s_mov_b32 s53, s31
    s_mov_b32 s54, 0x500
    s_mov_b32 s55, 0x20000
    v_lshlrev_b32 v21, 4, v0
    v_lshrrev_b32 v6, 4, v0
    v_and_b32 v7, 15, v0
    v_lshlrev_b32 v5, 4, v6
    s_lshl_b32 s66, s41, 4
    s_add_u32 s66, s66, s40
    s_cmp_eq_u32 s90, 3
    s_cselect_b32 s73, s66, 16
    s_cmp_ge_u32 s73, 16
    s_cbranch_scc1 Lh_nogw
    s_lshl_b32 s66, s3, 7
    buffer_load_dwordx4 v[40:43], v5, s[52:55], s66 offen offset:0
    buffer_load_dwordx4 v[44:47], v5, s[52:55], s66 offen offset:64
    s_add_u32 s66, s66, 128
    s_cmp_eq_u32 s66, 1280
    s_cselect_b32 s66, 0, s66
    s_nop 0
    buffer_load_dwordx4 v[48:51], v5, s[52:55], s66 offen offset:0
    buffer_load_dwordx4 v[52:55], v5, s[52:55], s66 offen offset:64
    s_add_u32 s66, s66, 128
    s_cmp_eq_u32 s66, 1280
    s_cselect_b32 s66, 0, s66
    s_nop 0
    buffer_load_dwordx4 v[56:59], v5, s[52:55], s66 offen offset:0
    buffer_load_dwordx4 v[60:63], v5, s[52:55], s66 offen offset:64
    s_add_u32 s66, s66, 128
    s_cmp_eq_u32 s66, 1280
    s_cselect_b32 s66, 0, s66
    s_nop 0
    buffer_load_dwordx4 v[64:67], v5, s[52:55], s66 offen offset:0
    buffer_load_dwordx4 v[68:71], v5, s[52:55], s66 offen offset:64
    s_add_u32 s66, s66, 128
    s_cmp_eq_u32 s66, 1280
    s_cselect_b32 s66, 0, s66
    s_nop 0
    buffer_load_dwordx4 v[72:75], v5, s[52:55], s66 offen offset:0
    buffer_load_dwordx4 v[76:79], v5, s[52:55], s66 offen offset:64
    s_add_u32 s66, s66, 128
    s_cmp_eq_u32 s66, 1280
    s_cselect_b32 s66, 0, s66
    s_nop 0
    buffer_load_dwordx4 v[80:83], v5, s[52:55], s66 offen offset:0
    buffer_load_dwordx4 v[84:87], v5, s[52:55], s66 offen offset:64
    s_add_u32 s66, s66, 128
    s_cmp_eq_u32 s66, 1280
    s_cselect_b32 s66, 0, s66
    s_nop 0
    buffer_load_dwordx4 v[88:91], v5, s[52:55], s66 offen offset:0
    buffer_load_dwordx4 v[92:95], v5, s[52:55], s66 offen offset:64
    s_add_u32 s66, s66, 128
    s_cmp_eq_u32 s66, 1280
    s_cselect_b32 s66, 0, s66
    s_nop 0
    buffer_load_dwordx4 v[96:99], v5, s[52:55], s66 offen offset:0
    buffer_load_dwordx4 v[100:103], v5, s[52:55], s66 offen offset:64
    s_add_u32 s66, s66, 128
    s_cmp_eq_u32 s66, 1280
    s_cselect_b32 s66, 0, s66
    s_nop 0
    buffer_load_dwordx4 v[104:107], v5, s[52:55], s66 offen offset:0
    buffer_load_dwordx4 v[108:111], v5, s[52:55], s66 offen offset:64
    s_add_u32 s66, s66, 128
    s_cmp_eq_u32 s66, 1280
    s_cselect_b32 s66, 0, s66
    s_nop 0
    buffer_load_dwordx4 v[112:115], v5, s[52:55], s66 offen offset:0
    buffer_load_dwordx4 v[116:119], v5, s[52:55], s66 offen offset:64
    s_add_u32 s66, s66, 128
    s_cmp_eq_u32 s66, 1280
    s_cselect_b32 s66, 0, s66
Lh_nogw:
    v_lshrrev_b32 v8, 3, v0
    v_mul_u32_u24 v8, 10240, v8
    v_and_b32_e64 v10, 7, v0
    v_lshl_add_u32 v8, v10, 4, v8
    v_mul_u32_u24 v9, 10240, v6
    v_lshl_add_u32 v9, v7, 4, v9
    v_bfe_u32 v10, v0, 1, 3
    v_xor_b32 v10, v10, v6
    v_lshlrev_b32 v10, 4, v10
    v_lshl_add_u32 v10, v7, 7, v10
    s_and_b32 s66, s40, 15
    s_lshl_b32 s66, s66, 11
    v_add_u32 v10, s66, v10
    v_add_u32 v12, 0, v10
    v_xor_b32 v13, 64, v12
    v_add_u32 v14, 32768, v10
    v_xor_b32 v15, 64, v14
    v_add_u32 v16, 65536, v10
    v_xor_b32 v17, 64, v16
    v_mov_b32 v128, 0
    v_mov_b32 v129, 0
    v_mov_b32 v130, 0
    v_mov_b32 v131, 0
    s_lshr_b32 s65, s65, 1
    s_mul_i32 s70, s65, 698
    s_lshr_b32 s70, s70, 16
    s_mul_i32 s69, s70, 94
    s_sub_u32 s69, s65, s69
    s_sub_u32 s66, s69, 54
    s_and_b32 s67, s66, 1
    s_lshl_b32 s68, s70, 1
    s_add_u32 s67, s67, s68
    s_bfe_u32 s84, s66, 0x10001
    s_lshr_b32 s66, s66, 2
    s_lshl_b32 s85, s66, 7
    s_mul_i32 s68, s67, 81920
    s_add_u32 s85, s85, s68
    s_lshl_b32 s66, s66, 2
    s_add_u32 s66, s66, s84
    s_lshl_b32 s67, s67, 2
    s_mul_i32 s86, s69, 40960
    s_lshl_b32 s68, s70, 8
    s_add_u32 s86, s86, s68
    s_lshl_b32 s70, s70, 3
    s_cmp_lt_u32 s69, 54
    s_cselect_b32 s88, 1, 0
    s_add_u32 s69, s69, 40
    s_cmp_eq_u32 s88, 1
    s_cselect_b32 s66, s69, s66
    s_cselect_b32 s67, s70, s67
    s_cselect_b32 s85, s86, s85
    s_cselect_b64 vcc, -1, 0
    s_add_u32 s86, s85, 5120
    v_cndmask_b32 v8, v8, v9, vcc
    s_mul_i32 s87, s66, 5120
    s_cmp_ge_u32 s65, 470
    s_cselect_b32 s87, 0x40000000, s87
    s_cmp_eq_u32 s88, 1
    s_movk_i32 s68, 0
    s_cselect_b32 s68, 0, s68
    s_or_b32 s69, s68, 0
    s_add_u32 s76, s69, s87
    s_cmp_eq_u32 s88, 1
    s_movk_i32 s68, 256
    s_cselect_b32 s68, 128, s68
    s_or_b32 s69, s68, 0
    s_add_u32 s77, s69, s87
    s_cmp_eq_u32 s88, 1
    s_movk_i32 s68, 512
    s_cselect_b32 s68, 0, s68
    s_or_b32 s69, s68, 0
    s_add_u32 s78, s69, s87
    s_cmp_eq_u32 s88, 1
    s_movk_i32 s68, 768
    s_cselect_b32 s68, 128, s68
    s_or_b32 s69, s68, 0
    s_add_u32 s79, s69, s87
    s_cmp_eq_u32 s88, 1
    s_movk_i32 s68, 10240
    s_cselect_b32 s68, 0, s68
    s_or_b32 s69, s68, 0
    s_add_u32 s80, s69, s87
    s_cmp_eq_u32 s88, 1
    s_movk_i32 s68, 10496
    s_cselect_b32 s68, 128, s68
    s_or_b32 s69, s68, 0
    s_add_u32 s81, s69, s87
    s_cmp_eq_u32 s88, 1
    s_movk_i32 s68, 10752
    s_cselect_b32 s68, 0, s68
    s_or_b32 s69, s68, 0
    s_add_u32 s82, s69, s87
    s_cmp_eq_u32 s88, 1
    s_movk_i32 s68, 11008
    s_cselect_b32 s68, 128, s68
    s_or_b32 s69, s68, 0
    s_add_u32 s83, s69, s87
    s_cmp_eq_u32 s88, 1
    v_bfe_u32 v9, v0, 3, 1
    v_lshlrev_b32 v9, 2, v9
    v_lshlrev_b32 v18, 8, v6
    v_and_b32 v20, 7, v0
    v_lshl_add_u32 v18, v20, 4, v18
    v_lshlrev_b32 v20, 4, v7
    v_cndmask_b32 v18, v20, v18, vcc
    v_add_u32 v20, 0, v9
    v_cndmask_b32 v20, v6, v20, vcc
    v_add_u32 v20, s67, v20
    v_mul_u32_u24 v22, 52, v20
    v_lshrrev_b32 v22, 8, v22
    v_mul_u32_u24 v22, 476160, v22
    v_lshl_add_u32 v22, v20, 10, v22
    v_add_u32 v32, v22, v18
    v_add_u32 v20, 1, v9
    v_cndmask_b32 v20, v6, v20, vcc
    v_add_u32 v20, s67, v20
    v_mul_u32_u24 v22, 52, v20
    v_lshrrev_b32 v22, 8, v22
    v_mul_u32_u24 v22, 476160, v22
    v_lshl_add_u32 v22, v20, 10, v22
    v_add_u32 v33, v22, v18
    v_add_u32 v20, 2, v9
    v_cndmask_b32 v20, v6, v20, vcc
    v_add_u32 v20, s67, v20
    v_mul_u32_u24 v22, 52, v20
    v_lshrrev_b32 v22, 8, v22
    v_mul_u32_u24 v22, 476160, v22
    v_lshl_add_u32 v22, v20, 10, v22
    v_add_u32 v34, v22, v18
    v_add_u32 v20, 3, v9
    v_cndmask_b32 v20, v6, v20, vcc
    v_add_u32 v20, s67, v20
    v_mul_u32_u24 v22, 52, v20
    v_lshrrev_b32 v22, 8, v22
    v_mul_u32_u24 v22, 476160, v22
    v_lshl_add_u32 v22, v20, 10, v22
    v_add_u32 v35, v22, v18
    s_barrier
    s_waitcnt vmcnt(0)
    ds_read_b128 v[120:123], v16
    ds_read_b128 v[124:127], v17
    s_waitcnt lgkmcnt(0)
    v_mfma_f32_16x16x32_bf16 v[128:131], v[40:43], v[120:123], v[128:131]
    v_mfma_f32_16x16x32_bf16 v[128:131], v[44:47], v[124:127], v[128:131]
    s_cmp_eq_u32 s84, 0
    s_cselect_b32 s56, s14, s16
    s_cselect_b32 s57, s15, s17
    s_mov_b32 s58, 819200
    s_cmp_eq_u32 s88, 1
    s_cselect_b32 s56, s28, s56
    s_cselect_b32 s57, s29, s57
    s_cselect_b32 s58, 2211840, s58
    s_mov_b32 s59, 0x20000
    buffer_load_dwordx4 v[134:137], v8, s[56:59], s85 offen offset:0
    buffer_load_dwordx4 v[138:141], v8, s[56:59], s85 offen offset:1280
    buffer_load_dwordx4 v[142:145], v8, s[56:59], s85 offen offset:2560
    buffer_load_dwordx4 v[146:149], v8, s[56:59], s85 offen offset:3840
    buffer_load_dwordx4 v[150:153], v8, s[56:59], s86 offen offset:0
    buffer_load_dwordx4 v[154:157], v8, s[56:59], s86 offen offset:1280
    buffer_load_dwordx4 v[158:161], v8, s[56:59], s86 offen offset:2560
    buffer_load_dwordx4 v[162:165], v8, s[56:59], s86 offen offset:3840
    s_barrier
    ds_read_b128 v[120:123], v12
    ds_read_b128 v[124:127], v13
    s_waitcnt lgkmcnt(0)
    v_mfma_f32_16x16x32_bf16 v[128:131], v[48:51], v[120:123], v[128:131]
    v_mfma_f32_16x16x32_bf16 v[128:131], v[52:55], v[124:127], v[128:131]
    s_add_u32 s56, s36, 0xc00000
    s_addc_u32 s57, s37, 0
    s_nop 0
    s_mov_b32 s58, 0x3ac000
    s_mov_b32 s59, 0x20000
    s_mov_b32 s70, 0x05040100
    s_mov_b32 s71, 0x07060302
    s_waitcnt vmcnt(0)
    s_cmp_eq_u32 s88, 0
    s_cbranch_scc1 Lh_noperm
    s_nop 0
    v_perm_b32 v166, v138, v134, s70
    v_perm_b32 v167, v146, v142, s70
    v_perm_b32 v168, v154, v150, s70
    v_perm_b32 v169, v162, v158, s70
    v_perm_b32 v170, v138, v134, s71
    v_perm_b32 v171, v146, v142, s71
    v_perm_b32 v172, v154, v150, s71
    v_perm_b32 v173, v162, v158, s71
    v_perm_b32 v174, v139, v135, s70
    v_perm_b32 v175, v147, v143, s70
    v_perm_b32 v176, v155, v151, s70
    v_perm_b32 v177, v163, v159, s70
    v_perm_b32 v178, v139, v135, s71
    v_perm_b32 v179, v147, v143, s71
    v_perm_b32 v180, v155, v151, s71
    v_perm_b32 v181, v163, v159, s71
    v_perm_b32 v182, v140, v136, s70
    v_perm_b32 v183, v148, v144, s70
    v_perm_b32 v184, v156, v152, s70
    v_perm_b32 v185, v164, v160, s70
    v_perm_b32 v186, v140, v136, s71
    v_perm_b32 v187, v148, v144, s71
    v_perm_b32 v188, v156, v152, s71
    v_perm_b32 v189, v164, v160, s71
    v_perm_b32 v190, v141, v137, s70
    v_perm_b32 v191, v149, v145, s70
    v_perm_b32 v192, v157, v153, s70
    v_perm_b32 v193, v165, v161, s70
    v_perm_b32 v194, v141, v137, s71
    v_perm_b32 v195, v149, v145, s71
    v_perm_b32 v196, v157, v153, s71
    v_perm_b32 v197, v165, v161, s71
    s_branch Lh_tr
Lh_noperm:
    s_nop 0
    v_pk_mov_b32 v[166:167], v[134:135], v[134:135] op_sel:[0,1]
    v_pk_mov_b32 v[168:169], v[136:137], v[136:137] op_sel:[0,1]
    v_pk_mov_b32 v[170:171], v[138:139], v[138:139] op_sel:[0,1]
    v_pk_mov_b32 v[172:173], v[140:141], v[140:141] op_sel:[0,1]
    v_pk_mov_b32 v[174:175], v[142:143], v[142:143] op_sel:[0,1]
    v_pk_mov_b32 v[176:177], v[144:145], v[144:145] op_sel:[0,1]
    v_pk_mov_b32 v[178:179], v[146:147], v[146:147] op_sel:[0,1]
    v_pk_mov_b32 v[180:181], v[148:149], v[148:149] op_sel:[0,1]
    v_pk_mov_b32 v[182:183], v[150:151], v[150:151] op_sel:[0,1]
    v_pk_mov_b32 v[184:185], v[152:153], v[152:153] op_sel:[0,1]
    v_pk_mov_b32 v[186:187], v[154:155], v[154:155] op_sel:[0,1]
    v_pk_mov_b32 v[188:189], v[156:157], v[156:157] op_sel:[0,1]
    v_pk_mov_b32 v[190:191], v[158:159], v[158:159] op_sel:[0,1]
    v_pk_mov_b32 v[192:193], v[160:161], v[160:161] op_sel:[0,1]
    v_pk_mov_b32 v[194:195], v[162:163], v[162:163] op_sel:[0,1]
    v_pk_mov_b32 v[196:197], v[164:165], v[164:165] op_sel:[0,1]
Lh_tr:
    s_mov_b32 vcc_lo, 0xaaaaaaaa
    s_mov_b32 vcc_hi, 0xaaaaaaaa
    s_nop 1
    s_nop 0
    v_cndmask_b32_dpp v202, v166, v170, vcc quad_perm:[1,0,3,2] row_mask:0xf bank_mask:0xf bound_ctrl:0
    v_cndmask_b32_dpp v203, v167, v171, vcc quad_perm:[1,0,3,2] row_mask:0xf bank_mask:0xf bound_ctrl:0
    v_cndmask_b32_dpp v204, v168, v172, vcc quad_perm:[1,0,3,2] row_mask:0xf bank_mask:0xf bound_ctrl:0
    v_cndmask_b32_dpp v205, v169, v173, vcc quad_perm:[1,0,3,2] row_mask:0xf bank_mask:0xf bound_ctrl:0
    v_cndmask_b32_dpp v210, v174, v178, vcc quad_perm:[1,0,3,2] row_mask:0xf bank_mask:0xf bound_ctrl:0
    v_cndmask_b32_dpp v211, v175, v179, vcc quad_perm:[1,0,3,2] row_mask:0xf bank_mask:0xf bound_ctrl:0
    v_cndmask_b32_dpp v212, v176, v180, vcc quad_perm:[1,0,3,2] row_mask:0xf bank_mask:0xf bound_ctrl:0
    v_cndmask_b32_dpp v213, v177, v181, vcc quad_perm:[1,0,3,2] row_mask:0xf bank_mask:0xf bound_ctrl:0
    v_cndmask_b32_dpp v218, v182, v186, vcc quad_perm:[1,0,3,2] row_mask:0xf bank_mask:0xf bound_ctrl:0
    v_cndmask_b32_dpp v219, v183, v187, vcc quad_perm:[1,0,3,2] row_mask:0xf bank_mask:0xf bound_ctrl:0
    v_cndmask_b32_dpp v220, v184, v188, vcc quad_perm:[1,0,3,2] row_mask:0xf bank_mask:0xf bound_ctrl:0
    v_cndmask_b32_dpp v221, v185, v189, vcc quad_perm:[1,0,3,2] row_mask:0xf bank_mask:0xf bound_ctrl:0
    v_cndmask_b32_dpp v226, v190, v194, vcc quad_perm:[1,0,3,2] row_mask:0xf bank_mask:0xf bound_ctrl:0
    v_cndmask_b32_dpp v227, v191, v195, vcc quad_perm:[1,0,3,2] row_mask:0xf bank_mask:0xf bound_ctrl:0
    v_cndmask_b32_dpp v228, v192, v196, vcc quad_perm:[1,0,3,2] row_mask:0xf bank_mask:0xf bound_ctrl:0
    v_cndmask_b32_dpp v229, v193, v197, vcc quad_perm:[1,0,3,2] row_mask:0xf bank_mask:0xf bound_ctrl:0
    s_mov_b32 vcc_lo, 0x55555555
    s_mov_b32 vcc_hi, 0x55555555
    s_nop 1
    s_nop 0
    v_cndmask_b32_dpp v198, v170, v166, vcc quad_perm:[1,0,3,2] row_mask:0xf bank_mask:0xf bound_ctrl:0
    v_cndmask_b32_dpp v199, v171, v167, vcc quad_perm:[1,0,3,2] row_mask:0xf bank_mask:0xf bound_ctrl:0
    v_cndmask_b32_dpp v200, v172, v168, vcc quad_perm:[1,0,3,2] row_mask:0xf bank_mask:0xf bound_ctrl:0
    v_cndmask_b32_dpp v201, v173, v169, vcc quad_perm:[1,0,3,2] row_mask:0xf bank_mask:0xf bound_ctrl:0
    v_cndmask_b32_dpp v206, v178, v174, vcc quad_perm:[1,0,3,2] row_mask:0xf bank_mask:0xf bound_ctrl:0
    v_cndmask_b32_dpp v207, v179, v175, vcc quad_perm:[1,0,3,2] row_mask:0xf bank_mask:0xf bound_ctrl:0
    v_cndmask_b32_dpp v208, v180, v176, vcc quad_perm:[1,0,3,2] row_mask:0xf bank_mask:0xf bound_ctrl:0
    v_cndmask_b32_dpp v209, v181, v177, vcc quad_perm:[1,0,3,2] row_mask:0xf bank_mask:0xf bound_ctrl:0
    v_cndmask_b32_dpp v214, v186, v182, vcc quad_perm:[1,0,3,2] row_mask:0xf bank_mask:0xf bound_ctrl:0
    v_cndmask_b32_dpp v215, v187, v183, vcc quad_perm:[1,0,3,2] row_mask:0xf bank_mask:0xf bound_ctrl:0
    v_cndmask_b32_dpp v216, v188, v184, vcc quad_perm:[1,0,3,2] row_mask:0xf bank_mask:0xf bound_ctrl:0
    v_cndmask_b32_dpp v217, v189, v185, vcc quad_perm:[1,0,3,2] row_mask:0xf bank_mask:0xf bound_ctrl:0
    v_cndmask_b32_dpp v222, v194, v190, vcc quad_perm:[1,0,3,2] row_mask:0xf bank_mask:0xf bound_ctrl:0
    v_cndmask_b32_dpp v223, v195, v191, vcc quad_perm:[1,0,3,2] row_mask:0xf bank_mask:0xf bound_ctrl:0
    v_cndmask_b32_dpp v224, v196, v192, vcc quad_perm:[1,0,3,2] row_mask:0xf bank_mask:0xf bound_ctrl:0
    v_cndmask_b32_dpp v225, v197, v193, vcc quad_perm:[1,0,3,2] row_mask:0xf bank_mask:0xf bound_ctrl:0
    s_mov_b32 vcc_lo, 0xcccccccc
    s_mov_b32 vcc_hi, 0xcccccccc
    s_nop 1
    s_nop 0
    v_cndmask_b32_dpp v174, v198, v206, vcc quad_perm:[2,3,0,1] row_mask:0xf bank_mask:0xf bound_ctrl:0
    v_cndmask_b32_dpp v175, v199, v207, vcc quad_perm:[2,3,0,1] row_mask:0xf bank_mask:0xf bound_ctrl:0
    v_cndmask_b32_dpp v176, v200, v208, vcc quad_perm:[2,3,0,1] row_mask:0xf bank_mask:0xf bound_ctrl:0
    v_cndmask_b32_dpp v177, v201, v209, vcc quad_perm:[2,3,0,1] row_mask:0xf bank_mask:0xf bound_ctrl:0
    v_cndmask_b32_dpp v178, v202, v210, vcc quad_perm:[2,3,0,1] row_mask:0xf bank_mask:0xf bound_ctrl:0
    v_cndmask_b32_dpp v179, v203, v211, vcc quad_perm:[2,3,0,1] row_mask:0xf bank_mask:0xf bound_ctrl:0
    v_cndmask_b32_dpp v180, v204, v212, vcc quad_perm:[2,3,0,1] row_mask:0xf bank_mask:0xf bound_ctrl:0
    v_cndmask_b32_dpp v181, v205, v213, vcc quad_perm:[2,3,0,1] row_mask:0xf bank_mask:0xf bound_ctrl:0
    v_cndmask_b32_dpp v190, v214, v222, vcc quad_perm:[2,3,0,1] row_mask:0xf bank_mask:0xf bound_ctrl:0
    v_cndmask_b32_dpp v191, v215, v223, vcc quad_perm:[2,3,0,1] row_mask:0xf bank_mask:0xf bound_ctrl:0
    v_cndmask_b32_dpp v192, v216, v224, vcc quad_perm:[2,3,0,1] row_mask:0xf bank_mask:0xf bound_ctrl:0
    v_cndmask_b32_dpp v193, v217, v225, vcc quad_perm:[2,3,0,1] row_mask:0xf bank_mask:0xf bound_ctrl:0
    v_cndmask_b32_dpp v194, v218, v226, vcc quad_perm:[2,3,0,1] row_mask:0xf bank_mask:0xf bound_ctrl:0
    v_cndmask_b32_dpp v195, v219, v227, vcc quad_perm:[2,3,0,1] row_mask:0xf bank_mask:0xf bound_ctrl:0
    v_cndmask_b32_dpp v196, v220, v228, vcc quad_perm:[2,3,0,1] row_mask:0xf bank_mask:0xf bound_ctrl:0
    v_cndmask_b32_dpp v197, v221, v229, vcc quad_perm:[2,3,0,1] row_mask:0xf bank_mask:0xf bound_ctrl:0
    s_mov_b32 vcc_lo, 0x33333333
    s_mov_b32 vcc_hi, 0x33333333
    s_nop 1
    s_nop 0
    v_cndmask_b32_dpp v166, v206, v198, vcc quad_perm:[2,3,0,1] row_mask:0xf bank_mask:0xf bound_ctrl:0
    v_cndmask_b32_dpp v167, v207, v199, vcc quad_perm:[2,3,0,1] row_mask:0xf bank_mask:0xf bound_ctrl:0
    v_cndmask_b32_dpp v168, v208, v200, vcc quad_perm:[2,3,0,1] row_mask:0xf bank_mask:0xf bound_ctrl:0
    v_cndmask_b32_dpp v169, v209, v201, vcc quad_perm:[2,3,0,1] row_mask:0xf bank_mask:0xf bound_ctrl:0
    v_cndmask_b32_dpp v170, v210, v202, vcc quad_perm:[2,3,0,1] row_mask:0xf bank_mask:0xf bound_ctrl:0
    v_cndmask_b32_dpp v171, v211, v203, vcc quad_perm:[2,3,0,1] row_mask:0xf bank_mask:0xf bound_ctrl:0
    v_cndmask_b32_dpp v172, v212, v204, vcc quad_perm:[2,3,0,1] row_mask:0xf bank_mask:0xf bound_ctrl:0
    v_cndmask_b32_dpp v173, v213, v205, vcc quad_perm:[2,3,0,1] row_mask:0xf bank_mask:0xf bound_ctrl:0
    v_cndmask_b32_dpp v182, v222, v214, vcc quad_perm:[2,3,0,1] row_mask:0xf bank_mask:0xf bound_ctrl:0
    v_cndmask_b32_dpp v183, v223, v215, vcc quad_perm:[2,3,0,1] row_mask:0xf bank_mask:0xf bound_ctrl:0
    v_cndmask_b32_dpp v184, v224, v216, vcc quad_perm:[2,3,0,1] row_mask:0xf bank_mask:0xf bound_ctrl:0
    v_cndmask_b32_dpp v185, v225, v217, vcc quad_perm:[2,3,0,1] row_mask:0xf bank_mask:0xf bound_ctrl:0
    v_cndmask_b32_dpp v186, v226, v218, vcc quad_perm:[2,3,0,1] row_mask:0xf bank_mask:0xf bound_ctrl:0
    v_cndmask_b32_dpp v187, v227, v219, vcc quad_perm:[2,3,0,1] row_mask:0xf bank_mask:0xf bound_ctrl:0
    v_cndmask_b32_dpp v188, v228, v220, vcc quad_perm:[2,3,0,1] row_mask:0xf bank_mask:0xf bound_ctrl:0
    v_cndmask_b32_dpp v189, v229, v221, vcc quad_perm:[2,3,0,1] row_mask:0xf bank_mask:0xf bound_ctrl:0
    s_mov_b32 vcc_lo, 0xf0f0f0f0
    s_mov_b32 vcc_hi, 0xf0f0f0f0
    s_nop 1
    s_nop 0
    v_cndmask_b32_dpp v214, v166, v182, vcc row_shl:4 row_mask:0xf bank_mask:0xf bound_ctrl:0
    v_cndmask_b32_dpp v215, v167, v183, vcc row_shl:4 row_mask:0xf bank_mask:0xf bound_ctrl:0
    v_cndmask_b32_dpp v216, v168, v184, vcc row_shl:4 row_mask:0xf bank_mask:0xf bound_ctrl:0
    v_cndmask_b32_dpp v217, v169, v185, vcc row_shl:4 row_mask:0xf bank_mask:0xf bound_ctrl:0
    v_cndmask_b32_dpp v218, v170, v186, vcc row_shl:4 row_mask:0xf bank_mask:0xf bound_ctrl:0
    v_cndmask_b32_dpp v219, v171, v187, vcc row_shl:4 row_mask:0xf bank_mask:0xf bound_ctrl:0
    v_cndmask_b32_dpp v220, v172, v188, vcc row_shl:4 row_mask:0xf bank_mask:0xf bound_ctrl:0
    v_cndmask_b32_dpp v221, v173, v189, vcc row_shl:4 row_mask:0xf bank_mask:0xf bound_ctrl:0
    v_cndmask_b32_dpp v222, v174, v190, vcc row_shl:4 row_mask:0xf bank_mask:0xf bound_ctrl:0
    v_cndmask_b32_dpp v223, v175, v191, vcc row_shl:4 row_mask:0xf bank_mask:0xf bound_ctrl:0
    v_cndmask_b32_dpp v224, v176, v192, vcc row_shl:4 row_mask:0xf bank_mask:0xf bound_ctrl:0
    v_cndmask_b32_dpp v225, v177, v193, vcc row_shl:4 row_mask:0xf bank_mask:0xf bound_ctrl:0
    v_cndmask_b32_dpp v226, v178, v194, vcc row_shl:4 row_mask:0xf bank_mask:0xf bound_ctrl:0
    v_cndmask_b32_dpp v227, v179, v195, vcc row_shl:4 row_mask:0xf bank_mask:0xf bound_ctrl:0
    v_cndmask_b32_dpp v228, v180, v196, vcc row_shl:4 row_mask:0xf bank_mask:0xf bound_ctrl:0
    v_cndmask_b32_dpp v229, v181, v197, vcc row_shl:4 row_mask:0xf bank_mask:0xf bound_ctrl:0
    s_mov_b32 vcc_lo, 0xf0f0f0f
    s_mov_b32 vcc_hi, 0xf0f0f0f
    s_nop 1
    s_nop 0
    v_cndmask_b32_dpp v198, v182, v166, vcc row_shr:4 row_mask:0xf bank_mask:0xf bound_ctrl:0
    v_cndmask_b32_dpp v199, v183, v167, vcc row_shr:4 row_mask:0xf bank_mask:0xf bound_ctrl:0
    v_cndmask_b32_dpp v200, v184, v168, vcc row_shr:4 row_mask:0xf bank_mask:0xf bound_ctrl:0
    v_cndmask_b32_dpp v201, v185, v169, vcc row_shr:4 row_mask:0xf bank_mask:0xf bound_ctrl:0
    v_cndmask_b32_dpp v202, v186, v170, vcc row_shr:4 row_mask:0xf bank_mask:0xf bound_ctrl:0
    v_cndmask_b32_dpp v203, v187, v171, vcc row_shr:4 row_mask:0xf bank_mask:0xf bound_ctrl:0
    v_cndmask_b32_dpp v204, v188, v172, vcc row_shr:4 row_mask:0xf bank_mask:0xf bound_ctrl:0
    v_cndmask_b32_dpp v205, v189, v173, vcc row_shr:4 row_mask:0xf bank_mask:0xf bound_ctrl:0
    v_cndmask_b32_dpp v206, v190, v174, vcc row_shr:4 row_mask:0xf bank_mask:0xf bound_ctrl:0
    v_cndmask_b32_dpp v207, v191, v175, vcc row_shr:4 row_mask:0xf bank_mask:0xf bound_ctrl:0
    v_cndmask_b32_dpp v208, v192, v176, vcc row_shr:4 row_mask:0xf bank_mask:0xf bound_ctrl:0
    v_cndmask_b32_dpp v209, v193, v177, vcc row_shr:4 row_mask:0xf bank_mask:0xf bound_ctrl:0
    v_cndmask_b32_dpp v210, v194, v178, vcc row_shr:4 row_mask:0xf bank_mask:0xf bound_ctrl:0
    v_cndmask_b32_dpp v211, v195, v179, vcc row_shr:4 row_mask:0xf bank_mask:0xf bound_ctrl:0
    v_cndmask_b32_dpp v212, v196, v180, vcc row_shr:4 row_mask:0xf bank_mask:0xf bound_ctrl:0
    v_cndmask_b32_dpp v213, v197, v181, vcc row_shr:4 row_mask:0xf bank_mask:0xf bound_ctrl:0
    buffer_store_dwordx4 v[198:201], v32, s[56:59], s76 offen sc1
    buffer_store_dwordx4 v[202:205], v32, s[56:59], s77 offen sc1
    buffer_store_dwordx4 v[206:209], v33, s[56:59], s78 offen sc1
    buffer_store_dwordx4 v[210:213], v33, s[56:59], s79 offen sc1
    buffer_store_dwordx4 v[214:217], v34, s[56:59], s80 offen sc1
    buffer_store_dwordx4 v[218:221], v34, s[56:59], s81 offen sc1
    buffer_store_dwordx4 v[222:225], v35, s[56:59], s82 offen sc1
    buffer_store_dwordx4 v[226:229], v35, s[56:59], s83 offen sc1
    s_barrier
    ds_read_b128 v[120:123], v14
    ds_read_b128 v[124:127], v15
    s_waitcnt lgkmcnt(0)
    v_mfma_f32_16x16x32_bf16 v[128:131], v[56:59], v[120:123], v[128:131]
    v_mfma_f32_16x16x32_bf16 v[128:131], v[60:63], v[124:127], v[128:131]
    buffer_load_dword v23, v19, s[60:63], 0 offen sc1
    s_barrier
    ds_read_b128 v[120:123], v16
    ds_read_b128 v[124:127], v17
    s_waitcnt lgkmcnt(0)
    v_mfma_f32_16x16x32_bf16 v[128:131], v[64:67], v[120:123], v[128:131]
    v_mfma_f32_16x16x32_bf16 v[128:131], v[68:71], v[124:127], v[128:131]
    s_mov_b32 s72, 0
Lh_npoll:
    s_waitcnt vmcnt(0)
    v_readfirstlane_b32 s64, v23
    s_add_u32 s72, s72, 1
    s_cmp_lg_u32 s64, 0
    s_cbranch_scc1 Lh_ngot
    buffer_load_dword v23, v19, s[60:63], 0 offen sc1
    s_cmp_lt_u32 s72, 0x40000
    s_cbranch_scc1 Lh_npoll
Lh_ngot:
    v_mov_b32 v22, 163832
    ds_write_b32 v22, v23
    s_waitcnt lgkmcnt(0)
    s_barrier
    ds_read_b128 v[120:123], v12
    ds_read_b128 v[124:127], v13
    s_waitcnt lgkmcnt(0)
    v_mfma_f32_16x16x32_bf16 v[128:131], v[72:75], v[120:123], v[128:131]
    v_mfma_f32_16x16x32_bf16 v[128:131], v[76:79], v[124:127], v[128:131]
    s_add_u32 s56, s36, 0x1080000
    s_addc_u32 s57, s37, 0
    s_mov_b32 s58, 0x8000
    s_mov_b32 s59, 0x20000
    s_cmp_lg_u32 s90, 2
    s_cbranch_scc1 Lh_noflag
    s_lshl_b32 s66, s2, 7
    v_lshlrev_b32 v22, 2, v0
    s_mov_b32 exec_hi, 0
    buffer_store_dword v23, v22, s[56:59], s66 offen sc1
    s_mov_b64 exec, -1
Lh_noflag:
    s_barrier
    ds_read_b128 v[120:123], v14
    ds_read_b128 v[124:127], v15
    s_waitcnt lgkmcnt(0)
    v_mfma_f32_16x16x32_bf16 v[128:131], v[80:83], v[120:123], v[128:131]
    v_mfma_f32_16x16x32_bf16 v[128:131], v[84:87], v[124:127], v[128:131]
    s_barrier
    ds_read_b128 v[120:123], v16
    ds_read_b128 v[124:127], v17
    s_waitcnt lgkmcnt(0)
    v_mfma_f32_16x16x32_bf16 v[128:131], v[88:91], v[120:123], v[128:131]
    v_mfma_f32_16x16x32_bf16 v[128:131], v[92:95], v[124:127], v[128:131]
    s_barrier
    ds_read_b128 v[120:123], v12
    ds_read_b128 v[124:127], v13
    s_waitcnt lgkmcnt(0)
    v_mfma_f32_16x16x32_bf16 v[128:131], v[96:99], v[120:123], v[128:131]
    v_mfma_f32_16x16x32_bf16 v[128:131], v[100:103], v[124:127], v[128:131]
    s_mov_b32 s48, s36
    s_mov_b32 s49, s37
    s_nop 0
    s_mov_b32 s50, 0xbc0000
    s_mov_b32 s51, 0x20000
    s_add_u32 s52, s36, 0xc00000
    s_addc_u32 s53, s37, 0
    s_mov_b32 s54, 0x3ac000
    s_mov_b32 s55, 0x20000
    s_mul_i32 s74, s90, 14
    s_min_u32 s74, s74, 40
    s_nop 0
    s_mul_i32 s66, s42, 385024
    s_add_u32 s66, s66, 163840
    s_mul_i32 s67, s43, 481280
    s_add_u32 s67, s67, 204800
    s_cmp_lt_u32 s90, 3
    s_cselect_b32 s50, s66, s50
    s_cselect_b32 s54, s67, s54
    s_add_u32 s56, s36, 0xc00000
    s_addc_u32 s57, s37, 0
    s_mov_b32 s58, 0x3ac000
    s_mov_b32 s59, 0x20000
    v_lshlrev_b32 v1, 4, v0
    s_mul_i32 s76, s74, 5120
    s_mul_i32 s66, s43, 481280
    s_add_u32 s76, s76, s66
    s_mul_i32 s77, s101, 35840
    s_add_u32 s76, s76, s77
    s_add_u32 s77, s76, 4096
    s_mul_i32 s75, s101, 5
    s_add_u32 s60, s36, 0x1080000
    s_addc_u32 s61, s37, 0
    s_nop 0
    s_mov_b32 s62, 0x8000
    s_mov_b32 s63, 0x20000
    s_mul_i32 s44, s43, 80
    s_add_u32 s45, s44, 79
    s_lshr_b32 s44, s44, 7
    s_lshr_b32 s45, s45, 7
    s_mul_i32 s44, s44, 47
    s_mul_i32 s45, s45, 47
    s_add_u32 s45, s45, 46
    v_add_u32 v26, s44, v0
    v_add_u32 v27, 64, v26
    v_min_u32 v26, s45, v26
    v_min_u32 v27, s45, v27
    v_lshlrev_b32 v26, 7, v26
    v_lshlrev_b32 v27, 7, v27
    v_mov_b32 v28, 163824
    s_cmp_lg_u32 s90, 2
    s_cbranch_scc1 Lp_nolook
    buffer_load_dword v24, v26, s[60:63], 0 offen sc1
    buffer_load_dword v25, v27, s[60:63], 0 offen sc1
    s_waitcnt vmcnt(0)
    v_xor_b32 v24, s64, v24
    v_xor_b32 v25, s64, v25
    v_or_b32 v24, v24, v25
    v_cmp_ne_u32 vcc, 0, v24
    s_cmp_eq_u64 vcc, 0
    s_cselect_b32 s44, s64, 0
    v_mov_b32 v29, s44
    ds_write_b32 v28, v29
    s_waitcnt lgkmcnt(0)
Lp_nolook:
    s_barrier
    ds_read_b128 v[120:123], v14
    ds_read_b128 v[124:127], v15
    s_waitcnt lgkmcnt(0)
    v_mfma_f32_16x16x32_bf16 v[128:131], v[104:107], v[120:123], v[128:131]
    v_mfma_f32_16x16x32_bf16 v[128:131], v[108:111], v[124:127], v[128:131]
    ds_read_b32 v29, v28
    s_waitcnt vmcnt(0) lgkmcnt(0)
    v_cmp_ne_u32 vcc, s64, v29
    s_cmp_eq_u64 vcc, 0
    s_cbranch_scc0 Lp_late0
    s_cmp_eq_u32 s41, 1
    s_cbranch_scc1 Lp_essm0
    buffer_load_dwordx4 v[134:137], v1, s[52:55], s76 offen offset:0 sc1
    buffer_load_dwordx4 v[138:141], v1, s[52:55], s76 offen offset:1024 sc1
    buffer_load_dwordx4 v[142:145], v1, s[52:55], s76 offen offset:2048 sc1
    buffer_load_dwordx4 v[146:149], v1, s[52:55], s76 offen offset:3072 sc1
    buffer_load_dwordx4 v[150:153], v1, s[52:55], s77 offen offset:0 sc1
    s_add_u32 s76, s76, 5120
    s_add_u32 s77, s77, 5120
    buffer_load_dwordx4 v[154:157], v1, s[52:55], s76 offen offset:0 sc1
    buffer_load_dwordx4 v[158:161], v1, s[52:55], s76 offen offset:1024 sc1
    buffer_load_dwordx4 v[162:165], v1, s[52:55], s76 offen offset:2048 sc1
    buffer_load_dwordx4 v[166:169], v1, s[52:55], s76 offen offset:3072 sc1
    buffer_load_dwordx4 v[170:173], v1, s[52:55], s77 offen offset:0 sc1
    s_add_u32 s76, s76, 5120
    s_add_u32 s77, s77, 5120
    buffer_load_dwordx4 v[174:177], v1, s[52:55], s76 offen offset:0 sc1
    buffer_load_dwordx4 v[178:181], v1, s[52:55], s76 offen offset:1024 sc1
    s_barrier
    ds_read_b128 v[120:123], v16
    ds_read_b128 v[124:127], v17
    s_waitcnt lgkmcnt(0)
    v_mfma_f32_16x16x32_bf16 v[128:131], v[112:115], v[120:123], v[128:131]
    v_mfma_f32_16x16x32_bf16 v[128:131], v[116:119], v[124:127], v[128:131]
    buffer_load_dwordx4 v[182:185], v1, s[52:55], s76 offen offset:2048 sc1
    buffer_load_dwordx4 v[186:189], v1, s[52:55], s76 offen offset:3072 sc1
    buffer_load_dwordx4 v[190:193], v1, s[52:55], s77 offen offset:0 sc1
    s_add_u32 s76, s76, 5120
    s_add_u32 s77, s77, 5120
    buffer_load_dwordx4 v[194:197], v1, s[52:55], s76 offen offset:0 sc1
    buffer_load_dwordx4 v[198:201], v1, s[52:55], s76 offen offset:1024 sc1
    buffer_load_dwordx4 v[202:205], v1, s[52:55], s76 offen offset:2048 sc1
    buffer_load_dwordx4 v[206:209], v1, s[52:55], s76 offen offset:3072 sc1
    buffer_load_dwordx4 v[210:213], v1, s[52:55], s77 offen offset:0 sc1
    s_add_u32 s76, s76, 5120
    s_add_u32 s77, s77, 5120
    buffer_load_dwordx4 v[214:217], v1, s[52:55], s76 offen offset:0 sc1
    buffer_load_dwordx4 v[218:221], v1, s[52:55], s76 offen offset:1024 sc1
    s_barrier
    s_setprio 0
    buffer_load_dwordx4 v[222:225], v1, s[52:55], s76 offen offset:2048 sc1
    buffer_load_dwordx4 v[226:229], v1, s[52:55], s76 offen offset:3072 sc1
    buffer_load_dwordx4 v[230:233], v1, s[52:55], s77 offen offset:0 sc1
    s_add_u32 s76, s76, 5120
    s_add_u32 s77, s77, 5120
    buffer_load_dwordx4 v[234:237], v1, s[52:55], s76 offen offset:0 sc1
    buffer_load_dwordx4 v[238:241], v1, s[52:55], s76 offen offset:1024 sc1
    buffer_load_dwordx4 v[242:245], v1, s[52:55], s76 offen offset:2048 sc1
    buffer_load_dwordx4 v[246:249], v1, s[52:55], s76 offen offset:3072 sc1
    buffer_load_dwordx4 v[250:253], v1, s[52:55], s77 offen offset:0 sc1
    s_add_u32 s76, s76, 5120
    s_add_u32 s77, s77, 5120
    s_add_u32 s69, s90, 0
    s_mul_i32 s68, s69, 43
    s_lshr_b32 s68, s68, 8
    s_mul_i32 s70, s68, 6
    s_sub_u32 s70, s69, s70
    s_add_u32 s70, s70, s75
    s_cmp_ge_u32 s70, 8
    s_cselect_b32 s71, 46, 56
    s_add_u32 s70, s70, s71
    s_mul_i32 s68, s68, 10
    s_add_u32 s68, s68, s70
    s_mul_i32 s68, s68, 5120
    s_add_u32 s68, s68, s66
    s_mul_i32 m0, s69, 5120
    s_add_u32 s70, s68, 4096
    buffer_load_dwordx4 v1, s[56:59], s68 offen offset:0 sc1 lds
    buffer_load_dwordx4 v1, s[56:59], s68 offen offset:1024 sc1 lds
    buffer_load_dwordx4 v1, s[56:59], s68 offen offset:2048 sc1 lds
    buffer_load_dwordx4 v1, s[56:59], s68 offen offset:3072 sc1 lds
    s_add_u32 m0, m0, 4096
    s_nop 0
    buffer_load_dwordx4 v1, s[56:59], s70 offen offset:0 sc1 lds
    s_add_u32 s69, s90, 4
    s_mul_i32 s68, s69, 43
    s_lshr_b32 s68, s68, 8
    s_mul_i32 s70, s68, 6
    s_sub_u32 s70, s69, s70
    s_add_u32 s70, s70, s75
    s_cmp_ge_u32 s70, 8
    s_cselect_b32 s71, 46, 56
    s_add_u32 s70, s70, s71
    s_mul_i32 s68, s68, 10
    s_add_u32 s68, s68, s70
    s_mul_i32 s68, s68, 5120
    s_add_u32 s68, s68, s66
    s_nop 0
    s_mul_i32 m0, s69, 5120
    s_add_u32 s70, s68, 4096
    buffer_load_dwordx4 v1, s[56:59], s68 offen offset:0 sc1 lds
    buffer_load_dwordx4 v1, s[56:59], s68 offen offset:1024 sc1 lds
    buffer_load_dwordx4 v1, s[56:59], s68 offen offset:2048 sc1 lds
    buffer_load_dwordx4 v1, s[56:59], s68 offen offset:3072 sc1 lds
    s_add_u32 m0, m0, 4096
    s_nop 0
    buffer_load_dwordx4 v1, s[56:59], s70 offen offset:0 sc1 lds
    s_add_u32 s69, s90, 8
    s_mul_i32 s68, s69, 43
    s_lshr_b32 s68, s68, 8
    s_mul_i32 s70, s68, 6
    s_sub_u32 s70, s69, s70
    s_add_u32 s70, s70, s75
    s_cmp_ge_u32 s70, 8
    s_cselect_b32 s71, 46, 56
    s_add_u32 s70, s70, s71
    s_mul_i32 s68, s68, 10
    s_add_u32 s68, s68, s70
    s_mul_i32 s68, s68, 5120
    s_add_u32 s68, s68, s66
    s_nop 0
    s_mul_i32 m0, s69, 5120
    s_add_u32 s70, s68, 4096
    buffer_load_dwordx4 v1, s[56:59], s68 offen offset:0 sc1 lds
    buffer_load_dwordx4 v1, s[56:59], s68 offen offset:1024 sc1 lds
    s_barrier
    s_setprio 0
    s_lshl_b32 s67, s90, 2
    s_add_u32 s67, s67, 160512
    v_mov_b32 v2, s67
    v_mov_b32 v3, s64
    ds_write_b32 v2, v3 offset:144
    s_waitcnt vmcnt(5)
    buffer_load_dwordx4 v1, s[56:59], s68 offen offset:2048 sc1 lds
    s_waitcnt vmcnt(5)
    buffer_load_dwordx4 v1, s[56:59], s68 offen offset:3072 sc1 lds
    s_add_u32 m0, m0, 4096
    s_nop 0
    s_waitcnt vmcnt(5)
    buffer_load_dwordx4 v1, s[56:59], s70 offen offset:0 sc1 lds
    s_add_u32 s69, s90, 12
    s_mul_i32 s68, s69, 43
    s_lshr_b32 s68, s68, 8
    s_mul_i32 s70, s68, 6
    s_sub_u32 s70, s69, s70
    s_add_u32 s70, s70, s75
    s_cmp_ge_u32 s70, 8
    s_cselect_b32 s71, 46, 56
    s_add_u32 s70, s70, s71
    s_mul_i32 s68, s68, 10
    s_add_u32 s68, s68, s70
    s_mul_i32 s68, s68, 5120
    s_add_u32 s68, s68, s66
    s_mul_i32 m0, s69, 5120
    s_add_u32 s70, s68, 4096
    s_waitcnt vmcnt(5)
    buffer_load_dwordx4 v1, s[56:59], s68 offen offset:0 sc1 lds
    s_waitcnt vmcnt(5)
    buffer_load_dwordx4 v1, s[56:59], s68 offen offset:1024 sc1 lds
    s_waitcnt vmcnt(5)
    buffer_load_dwordx4 v1, s[56:59], s68 offen offset:2048 sc1 lds
    s_waitcnt vmcnt(5)
    buffer_load_dwordx4 v1, s[56:59], s68 offen offset:3072 sc1 lds
    s_add_u32 m0, m0, 4096
    s_nop 0
    s_waitcnt vmcnt(5)
    buffer_load_dwordx4 v1, s[56:59], s70 offen offset:0 sc1 lds
    s_add_u32 s69, s90, 16
    s_mul_i32 s68, s69, 43
    s_lshr_b32 s68, s68, 8
    s_mul_i32 s70, s68, 6
    s_sub_u32 s70, s69, s70
    s_add_u32 s70, s70, s75
    s_cmp_ge_u32 s70, 8
    s_cselect_b32 s71, 46, 56
    s_add_u32 s70, s70, s71
    s_mul_i32 s68, s68, 10
    s_add_u32 s68, s68, s70
    s_mul_i32 s68, s68, 5120
    s_add_u32 s68, s68, s66
    s_mul_i32 m0, s69, 5120
    s_add_u32 s70, s68, 4096
    s_waitcnt vmcnt(5)
    buffer_load_dwordx4 v1, s[56:59], s68 offen offset:0 sc1 lds
    s_waitcnt vmcnt(5)
    buffer_load_dwordx4 v1, s[56:59], s68 offen offset:1024 sc1 lds
    s_waitcnt vmcnt(5)
    buffer_load_dwordx4 v1, s[56:59], s68 offen offset:2048 sc1 lds
    s_waitcnt vmcnt(5)
    buffer_load_dwordx4 v1, s[56:59], s68 offen offset:3072 sc1 lds
    s_add_u32 m0, m0, 4096
    s_nop 0
    s_waitcnt vmcnt(5)
    buffer_load_dwordx4 v1, s[56:59], s70 offen offset:0 sc1 lds
    s_add_u32 s69, s90, 20
    s_mul_i32 s68, s69, 43
    s_lshr_b32 s68, s68, 8
    s_mul_i32 s70, s68, 6
    s_sub_u32 s70, s69, s70
    s_add_u32 s70, s70, s75
    s_cmp_ge_u32 s70, 8
    s_cselect_b32 s71, 46, 56
    s_add_u32 s70, s70, s71
    s_mul_i32 s68, s68, 10
    s_add_u32 s68, s68, s70
    s_mul_i32 s68, s68, 5120
    s_add_u32 s68, s68, s66
    s_mul_i32 m0, s69, 5120
    s_add_u32 s70, s68, 4096
    s_waitcnt vmcnt(5)
    buffer_load_dwordx4 v1, s[56:59], s68 offen offset:0 sc1 lds
    s_waitcnt vmcnt(5)
    buffer_load_dwordx4 v1, s[56:59], s68 offen offset:1024 sc1 lds
    s_waitcnt vmcnt(5)
    buffer_load_dwordx4 v1, s[56:59], s68 offen offset:2048 sc1 lds
    s_waitcnt vmcnt(5)
    buffer_load_dwordx4 v1, s[56:59], s68 offen offset:3072 sc1 lds
    s_add_u32 m0, m0, 4096
    s_nop 0
    s_waitcnt vmcnt(5)
    buffer_load_dwordx4 v1, s[56:59], s70 offen offset:0 sc1 lds
    s_branch Lp_done0
Lp_essm0:
    buffer_load_dwordx4 v[134:137], v1, s[52:55], s76 offen offset:0 sc1
    buffer_load_dwordx4 v[138:141], v1, s[52:55], s76 offen offset:1024 sc1
    buffer_load_dwordx4 v[142:145], v1, s[52:55], s76 offen offset:2048 sc1
    buffer_load_dwordx4 v[146:149], v1, s[52:55], s76 offen offset:3072 sc1
    buffer_load_dwordx4 v[150:153], v1, s[52:55], s77 offen offset:0 sc1
    s_add_u32 s76, s76, 5120
    s_add_u32 s77, s77, 5120
    buffer_load_dwordx4 v[154:157], v1, s[52:55], s76 offen offset:0 sc1
    buffer_load_dwordx4 v[158:161], v1, s[52:55], s76 offen offset:1024 sc1
    buffer_load_dwordx4 v[162:165], v1, s[52:55], s76 offen offset:2048 sc1
    buffer_load_dwordx4 v[166:169], v1, s[52:55], s76 offen offset:3072 sc1
    buffer_load_dwordx4 v[170:173], v1, s[52:55], s77 offen offset:0 sc1
    s_add_u32 s76, s76, 5120
    s_add_u32 s77, s77, 5120
    buffer_load_dwordx4 v[174:177], v1, s[52:55], s76 offen offset:0 sc1
    buffer_load_dwordx4 v[178:181], v1, s[52:55], s76 offen offset:1024 sc1
    buffer_load_dwordx4 v[182:185], v1, s[52:55], s76 offen offset:2048 sc1
    buffer_load_dwordx4 v[186:189], v1, s[52:55], s76 offen offset:3072 sc1
    buffer_load_dwordx4 v[190:193], v1, s[52:55], s77 offen offset:0 sc1
    s_add_u32 s76, s76, 5120
    s_add_u32 s77, s77, 5120
    buffer_load_dwordx4 v[194:197], v1, s[52:55], s76 offen offset:0 sc1
    s_barrier
    ds_read_b128 v[120:123], v16
    ds_read_b128 v[124:127], v17
    s_waitcnt lgkmcnt(0)
    v_mfma_f32_16x16x32_bf16 v[128:131], v[112:115], v[120:123], v[128:131]
    v_mfma_f32_16x16x32_bf16 v[128:131], v[116:119], v[124:127], v[128:131]
    buffer_load_dwordx4 v[198:201], v1, s[52:55], s76 offen offset:1024 sc1
    buffer_load_dwordx4 v[202:205], v1, s[52:55], s76 offen offset:2048 sc1
    buffer_load_dwordx4 v[206:209], v1, s[52:55], s76 offen offset:3072 sc1
    buffer_load_dwordx4 v[210:213], v1, s[52:55], s77 offen offset:0 sc1
    s_add_u32 s76, s76, 5120
    s_add_u32 s77, s77, 5120
    buffer_load_dwordx4 v[214:217], v1, s[52:55], s76 offen offset:0 sc1
    buffer_load_dwordx4 v[218:221], v1, s[52:55], s76 offen offset:1024 sc1
    buffer_load_dwordx4 v[222:225], v1, s[52:55], s76 offen offset:2048 sc1
    buffer_load_dwordx4 v[226:229], v1, s[52:55], s76 offen offset:3072 sc1
    buffer_load_dwordx4 v[230:233], v1, s[52:55], s77 offen offset:0 sc1
    s_add_u32 s76, s76, 5120
    s_add_u32 s77, s77, 5120
    buffer_load_dwordx4 v[234:237], v1, s[52:55], s76 offen offset:0 sc1
    buffer_load_dwordx4 v[238:241], v1, s[52:55], s76 offen offset:1024 sc1
    buffer_load_dwordx4 v[242:245], v1, s[52:55], s76 offen offset:2048 sc1
    buffer_load_dwordx4 v[246:249], v1, s[52:55], s76 offen offset:3072 sc1
    buffer_load_dwordx4 v[250:253], v1, s[52:55], s77 offen offset:0 sc1
    s_add_u32 s76, s76, 5120
    s_add_u32 s77, s77, 5120
    s_add_u32 s69, s90, 0
    s_mul_i32 s68, s69, 43
    s_lshr_b32 s68, s68, 8
    s_mul_i32 s70, s68, 6
    s_sub_u32 s70, s69, s70
    s_add_u32 s70, s70, s75
    s_cmp_ge_u32 s70, 8
    s_cselect_b32 s71, 46, 56
    s_add_u32 s70, s70, s71
    s_mul_i32 s68, s68, 10
    s_add_u32 s68, s68, s70
    s_mul_i32 s68, s68, 5120
    s_add_u32 s68, s68, s66
    s_mul_i32 m0, s69, 5120
    s_add_u32 s70, s68, 4096
    buffer_load_dwordx4 v1, s[56:59], s68 offen offset:0 sc1 lds
    buffer_load_dwordx4 v1, s[56:59], s68 offen offset:1024 sc1 lds
    buffer_load_dwordx4 v1, s[56:59], s68 offen offset:2048 sc1 lds
    buffer_load_dwordx4 v1, s[56:59], s68 offen offset:3072 sc1 lds
    s_barrier
    s_setprio 0
    s_lshl_b32 s67, s90, 2
    s_add_u32 s67, s67, 160512
    v_mov_b32 v2, s67
    v_mov_b32 v3, s64
    ds_write_b32 v2, v3 offset:144
    s_add_u32 m0, m0, 4096
    s_nop 0
    s_waitcnt vmcnt(5)
    buffer_load_dwordx4 v1, s[56:59], s70 offen offset:0 sc1 lds
    s_add_u32 s69, s90, 4
    s_mul_i32 s68, s69, 43
    s_lshr_b32 s68, s68, 8
    s_mul_i32 s70, s68, 6
    s_sub_u32 s70, s69, s70
    s_add_u32 s70, s70, s75
    s_cmp_ge_u32 s70, 8
    s_cselect_b32 s71, 46, 56
    s_add_u32 s70, s70, s71
    s_mul_i32 s68, s68, 10
    s_add_u32 s68, s68, s70
    s_mul_i32 s68, s68, 5120
    s_add_u32 s68, s68, s66
    s_mul_i32 m0, s69, 5120
    s_add_u32 s70, s68, 4096
    s_waitcnt vmcnt(5)
    buffer_load_dwordx4 v1, s[56:59], s68 offen offset:0 sc1 lds
    s_waitcnt vmcnt(5)
    buffer_load_dwordx4 v1, s[56:59], s68 offen offset:1024 sc1 lds
    s_waitcnt vmcnt(5)
    buffer_load_dwordx4 v1, s[56:59], s68 offen offset:2048 sc1 lds
    s_waitcnt vmcnt(5)
    buffer_load_dwordx4 v1, s[56:59], s68 offen offset:3072 sc1 lds
    s_add_u32 m0, m0, 4096
    s_nop 0
    s_waitcnt vmcnt(5)
    buffer_load_dwordx4 v1, s[56:59], s70 offen offset:0 sc1 lds
    s_add_u32 s69, s90, 8
    s_mul_i32 s68, s69, 43
    s_lshr_b32 s68, s68, 8
    s_mul_i32 s70, s68, 6
    s_sub_u32 s70, s69, s70
    s_add_u32 s70, s70, s75
    s_cmp_ge_u32 s70, 8
    s_cselect_b32 s71, 46, 56
    s_add_u32 s70, s70, s71
    s_mul_i32 s68, s68, 10
    s_add_u32 s68, s68, s70
    s_mul_i32 s68, s68, 5120
    s_add_u32 s68, s68, s66
    s_mul_i32 m0, s69, 5120
    s_add_u32 s70, s68, 4096
    s_waitcnt vmcnt(5)
    buffer_load_dwordx4 v1, s[56:59], s68 offen offset:0 sc1 lds
    s_waitcnt vmcnt(5)
    buffer_load_dwordx4 v1, s[56:59], s68 offen offset:1024 sc1 lds
    s_waitcnt vmcnt(5)
    buffer_load_dwordx4 v1, s[56:59], s68 offen offset:2048 sc1 lds
    s_waitcnt vmcnt(5)
    buffer_load_dwordx4 v1, s[56:59], s68 offen offset:3072 sc1 lds
    s_add_u32 m0, m0, 4096
    s_nop 0
    s_waitcnt vmcnt(5)
    buffer_load_dwordx4 v1, s[56:59], s70 offen offset:0 sc1 lds
    s_add_u32 s69, s90, 12
    s_mul_i32 s68, s69, 43
    s_lshr_b32 s68, s68, 8
    s_mul_i32 s70, s68, 6
    s_sub_u32 s70, s69, s70
    s_add_u32 s70, s70, s75
    s_cmp_ge_u32 s70, 8
    s_cselect_b32 s71, 46, 56
    s_add_u32 s70, s70, s71
    s_mul_i32 s68, s68, 10
    s_add_u32 s68, s68, s70
    s_mul_i32 s68, s68, 5120
    s_add_u32 s68, s68, s66
    s_mul_i32 m0, s69, 5120
    s_add_u32 s70, s68, 4096
    s_waitcnt vmcnt(5)
    buffer_load_dwordx4 v1, s[56:59], s68 offen offset:0 sc1 lds
    s_waitcnt vmcnt(5)
    buffer_load_dwordx4 v1, s[56:59], s68 offen offset:1024 sc1 lds
    s_waitcnt vmcnt(5)
    buffer_load_dwordx4 v1, s[56:59], s68 offen offset:2048 sc1 lds
    s_waitcnt vmcnt(5)
    buffer_load_dwordx4 v1, s[56:59], s68 offen offset:3072 sc1 lds
    s_add_u32 m0, m0, 4096
    s_nop 0
    s_waitcnt vmcnt(5)
    buffer_load_dwordx4 v1, s[56:59], s70 offen offset:0 sc1 lds
    s_add_u32 s69, s90, 16
    s_mul_i32 s68, s69, 43
    s_lshr_b32 s68, s68, 8
    s_mul_i32 s70, s68, 6
    s_sub_u32 s70, s69, s70
    s_add_u32 s70, s70, s75
    s_cmp_ge_u32 s70, 8
    s_cselect_b32 s71, 46, 56
    s_add_u32 s70, s70, s71
    s_mul_i32 s68, s68, 10
    s_add_u32 s68, s68, s70
    s_mul_i32 s68, s68, 5120
    s_add_u32 s68, s68, s66
    s_mul_i32 m0, s69, 5120
    s_add_u32 s70, s68, 4096
    s_waitcnt vmcnt(5)
    buffer_load_dwordx4 v1, s[56:59], s68 offen offset:0 sc1 lds
    s_waitcnt vmcnt(5)
    buffer_load_dwordx4 v1, s[56:59], s68 offen offset:1024 sc1 lds
    s_waitcnt vmcnt(5)
    buffer_load_dwordx4 v1, s[56:59], s68 offen offset:2048 sc1 lds
    s_waitcnt vmcnt(5)
    buffer_load_dwordx4 v1, s[56:59], s68 offen offset:3072 sc1 lds
    s_add_u32 m0, m0, 4096
    s_nop 0
    s_waitcnt vmcnt(5)
    buffer_load_dwordx4 v1, s[56:59], s70 offen offset:0 sc1 lds
    s_add_u32 s69, s90, 20
    s_mul_i32 s68, s69, 43
    s_lshr_b32 s68, s68, 8
    s_mul_i32 s70, s68, 6
    s_sub_u32 s70, s69, s70
    s_add_u32 s70, s70, s75
    s_cmp_ge_u32 s70, 8
    s_cselect_b32 s71, 46, 56
    s_add_u32 s70, s70, s71
    s_mul_i32 s68, s68, 10
    s_add_u32 s68, s68, s70
    s_mul_i32 s68, s68, 5120
    s_add_u32 s68, s68, s66
    s_mul_i32 m0, s69, 5120
    s_add_u32 s70, s68, 4096
    s_waitcnt vmcnt(5)
    buffer_load_dwordx4 v1, s[56:59], s68 offen offset:0 sc1 lds
    s_waitcnt vmcnt(5)
    buffer_load_dwordx4 v1, s[56:59], s68 offen offset:1024 sc1 lds
    s_waitcnt vmcnt(5)
    buffer_load_dwordx4 v1, s[56:59], s68 offen offset:2048 sc1 lds
    s_waitcnt vmcnt(5)
    buffer_load_dwordx4 v1, s[56:59], s68 offen offset:3072 sc1 lds
    s_add_u32 m0, m0, 4096
    s_nop 0
    s_waitcnt vmcnt(5)
    buffer_load_dwordx4 v1, s[56:59], s70 offen offset:0 sc1 lds
    s_branch Lp_done0
Lp_late0:
    s_barrier
    ds_read_b128 v[120:123], v16
    ds_read_b128 v[124:127], v17
    s_waitcnt lgkmcnt(0)
    v_mfma_f32_16x16x32_bf16 v[128:131], v[112:115], v[120:123], v[128:131]
    v_mfma_f32_16x16x32_bf16 v[128:131], v[116:119], v[124:127], v[128:131]
    s_cmp_eq_u32 s41, 1
    s_cbranch_scc1 Lp_no9b0
    s_barrier
Lp_no9b0:
    s_barrier
    s_mov_b32 s72, 0
Lfw_poll2:
    buffer_load_dword v24, v26, s[60:63], 0 offen sc1
    buffer_load_dword v25, v27, s[60:63], 0 offen sc1
    s_waitcnt vmcnt(0)
    v_xor_b32 v24, s64, v24
    v_xor_b32 v25, s64, v25
    v_or_b32 v24, v24, v25
    v_cmp_ne_u32 vcc, 0, v24
    s_cmp_eq_u64 vcc, 0
    s_cbranch_scc1 Lfw_got2
    s_sleep 12
    s_add_u32 s72, s72, 1
    s_cmp_lt_u32 s72, 0x40000
    s_cbranch_scc1 Lfw_poll2
Lfw_got2:
    s_setprio 0
    s_lshl_b32 s67, s90, 2
    s_add_u32 s67, s67, 160512
    v_mov_b32 v2, s67
    v_mov_b32 v3, s64
    ds_write_b32 v2, v3 offset:144
    s_waitcnt vmcnt(7)
    buffer_load_dwordx4 v[134:137], v1, s[52:55], s76 offen offset:0 sc1
    s_waitcnt vmcnt(7)
    buffer_load_dwordx4 v[138:141], v1, s[52:55], s76 offen offset:1024 sc1
    s_waitcnt vmcnt(7)
    buffer_load_dwordx4 v[142:145], v1, s[52:55], s76 offen offset:2048 sc1
    s_waitcnt vmcnt(7)
    buffer_load_dwordx4 v[146:149], v1, s[52:55], s76 offen offset:3072 sc1
    s_waitcnt vmcnt(7)
    buffer_load_dwordx4 v[150:153], v1, s[52:55], s77 offen offset:0 sc1
    s_add_u32 s76, s76, 5120
    s_add_u32 s77, s77, 5120
    s_waitcnt vmcnt(7)
    buffer_load_dwordx4 v[154:157], v1, s[52:55], s76 offen offset:0 sc1
    s_waitcnt vmcnt(7)
    buffer_load_dwordx4 v[158:161], v1, s[52:55], s76 offen offset:1024 sc1
    s_waitcnt vmcnt(7)
    buffer_load_dwordx4 v[162:165], v1, s[52:55], s76 offen offset:2048 sc1
    s_waitcnt vmcnt(7)
    buffer_load_dwordx4 v[166:169], v1, s[52:55], s76 offen offset:3072 sc1
    s_waitcnt vmcnt(7)
    s_nop 0
    buffer_load_dwordx4 v[170:173], v1, s[52:55], s77 offen offset:0 sc1
    s_add_u32 s76, s76, 5120
    s_add_u32 s77, s77, 5120
    s_waitcnt vmcnt(7)
    buffer_load_dwordx4 v[174:177], v1, s[52:55], s76 offen offset:0 sc1
    s_waitcnt vmcnt(7)
    buffer_load_dwordx4 v[178:181], v1, s[52:55], s76 offen offset:1024 sc1
    s_waitcnt vmcnt(7)
    buffer_load_dwordx4 v[182:185], v1, s[52:55], s76 offen offset:2048 sc1
    s_waitcnt vmcnt(7)
    buffer_load_dwordx4 v[186:189], v1, s[52:55], s76 offen offset:3072 sc1
    s_waitcnt vmcnt(7)
    s_nop 0
    buffer_load_dwordx4 v[190:193], v1, s[52:55], s77 offen offset:0 sc1
    s_add_u32 s76, s76, 5120
    s_add_u32 s77, s77, 5120
    s_waitcnt vmcnt(7)
    buffer_load_dwordx4 v[194:197], v1, s[52:55], s76 offen offset:0 sc1
    s_waitcnt vmcnt(7)
    buffer_load_dwordx4 v[198:201], v1, s[52:55], s76 offen offset:1024 sc1
    s_waitcnt vmcnt(7)
    buffer_load_dwordx4 v[202:205], v1, s[52:55], s76 offen offset:2048 sc1
    s_waitcnt vmcnt(7)
    buffer_load_dwordx4 v[206:209], v1, s[52:55], s76 offen offset:3072 sc1
    s_waitcnt vmcnt(7)
    s_nop 0
    buffer_load_dwordx4 v[210:213], v1, s[52:55], s77 offen offset:0 sc1
    s_add_u32 s76, s76, 5120
    s_add_u32 s77, s77, 5120
    s_waitcnt vmcnt(7)
    buffer_load_dwordx4 v[214:217], v1, s[52:55], s76 offen offset:0 sc1
    s_waitcnt vmcnt(7)
    buffer_load_dwordx4 v[218:221], v1, s[52:55], s76 offen offset:1024 sc1
    s_waitcnt vmcnt(7)
    buffer_load_dwordx4 v[222:225], v1, s[52:55], s76 offen offset:2048 sc1
    s_waitcnt vmcnt(7)
    buffer_load_dwordx4 v[226:229], v1, s[52:55], s76 offen offset:3072 sc1
    s_waitcnt vmcnt(7)
    s_nop 0
    buffer_load_dwordx4 v[230:233], v1, s[52:55], s77 offen offset:0 sc1
    s_add_u32 s76, s76, 5120
    s_add_u32 s77, s77, 5120
    s_waitcnt vmcnt(7)
    buffer_load_dwordx4 v[234:237], v1, s[52:55], s76 offen offset:0 sc1
    s_waitcnt vmcnt(7)
    buffer_load_dwordx4 v[238:241], v1, s[52:55], s76 offen offset:1024 sc1
    s_waitcnt vmcnt(7)
    buffer_load_dwordx4 v[242:245], v1, s[52:55], s76 offen offset:2048 sc1
    s_waitcnt vmcnt(7)
    buffer_load_dwordx4 v[246:249], v1, s[52:55], s76 offen offset:3072 sc1
    s_waitcnt vmcnt(7)
    s_nop 0
    buffer_load_dwordx4 v[250:253], v1, s[52:55], s77 offen offset:0 sc1
    s_add_u32 s76, s76, 5120
    s_add_u32 s77, s77, 5120
    s_add_u32 s69, s90, 0
    s_mul_i32 s68, s69, 43
    s_lshr_b32 s68, s68, 8
    s_mul_i32 s70, s68, 6
    s_sub_u32 s70, s69, s70
    s_add_u32 s70, s70, s75
    s_cmp_ge_u32 s70, 8
    s_cselect_b32 s71, 46, 56
    s_add_u32 s70, s70, s71
    s_mul_i32 s68, s68, 10
    s_add_u32 s68, s68, s70
    s_mul_i32 s68, s68, 5120
    s_add_u32 s68, s68, s66
    s_mul_i32 m0, s69, 5120
    s_add_u32 s70, s68, 4096
    s_waitcnt vmcnt(7)
    buffer_load_dwordx4 v1, s[56:59], s68 offen offset:0 sc1 lds
    s_waitcnt vmcnt(7)
    buffer_load_dwordx4 v1, s[56:59], s68 offen offset:1024 sc1 lds
    s_waitcnt vmcnt(7)
    buffer_load_dwordx4 v1, s[56:59], s68 offen offset:2048 sc1 lds
    s_waitcnt vmcnt(7)
    buffer_load_dwordx4 v1, s[56:59], s68 offen offset:3072 sc1 lds
    s_add_u32 m0, m0, 4096
    s_nop 0
    s_waitcnt vmcnt(7)
    buffer_load_dwordx4 v1, s[56:59], s70 offen offset:0 sc1 lds
    s_add_u32 s69, s90, 4
    s_mul_i32 s68, s69, 43
    s_lshr_b32 s68, s68, 8
    s_mul_i32 s70, s68, 6
    s_sub_u32 s70, s69, s70
    s_add_u32 s70, s70, s75
    s_cmp_ge_u32 s70, 8
    s_cselect_b32 s71, 46, 56
    s_add_u32 s70, s70, s71
    s_mul_i32 s68, s68, 10
    s_add_u32 s68, s68, s70
    s_mul_i32 s68, s68, 5120
    s_add_u32 s68, s68, s66
    s_mul_i32 m0, s69, 5120
    s_add_u32 s70, s68, 4096
    s_waitcnt vmcnt(7)
    buffer_load_dwordx4 v1, s[56:59], s68 offen offset:0 sc1 lds
    s_waitcnt vmcnt(7)
    buffer_load_dwordx4 v1, s[56:59], s68 offen offset:1024 sc1 lds
    s_waitcnt vmcnt(7)
    buffer_load_dwordx4 v1, s[56:59], s68 offen offset:2048 sc1 lds
    s_waitcnt vmcnt(7)
    buffer_load_dwordx4 v1, s[56:59], s68 offen offset:3072 sc1 lds
    s_add_u32 m0, m0, 4096
    s_nop 0
    s_waitcnt vmcnt(7)
    buffer_load_dwordx4 v1, s[56:59], s70 offen offset:0 sc1 lds
    s_add_u32 s69, s90, 8
    s_mul_i32 s68, s69, 43
    s_lshr_b32 s68, s68, 8
    s_mul_i32 s70, s68, 6
    s_sub_u32 s70, s69, s70
    s_add_u32 s70, s70, s75
    s_cmp_ge_u32 s70, 8
    s_cselect_b32 s71, 46, 56
    s_add_u32 s70, s70, s71
    s_mul_i32 s68, s68, 10
    s_add_u32 s68, s68, s70
    s_mul_i32 s68, s68, 5120
    s_add_u32 s68, s68, s66
    s_mul_i32 m0, s69, 5120
    s_add_u32 s70, s68, 4096
    s_waitcnt vmcnt(7)
    buffer_load_dwordx4 v1, s[56:59], s68 offen offset:0 sc1 lds
    s_waitcnt vmcnt(7)
    buffer_load_dwordx4 v1, s[56:59], s68 offen offset:1024 sc1 lds
    s_waitcnt vmcnt(7)
    buffer_load_dwordx4 v1, s[56:59], s68 offen offset:2048 sc1 lds
    s_waitcnt vmcnt(7)
    buffer_load_dwordx4 v1, s[56:59], s68 offen offset:3072 sc1 lds
    s_add_u32 m0, m0, 4096
    s_nop 0
    s_waitcnt vmcnt(7)
    buffer_load_dwordx4 v1, s[56:59], s70 offen offset:0 sc1 lds
    s_add_u32 s69, s90, 12
    s_mul_i32 s68, s69, 43
    s_lshr_b32 s68, s68, 8
    s_mul_i32 s70, s68, 6
    s_sub_u32 s70, s69, s70
    s_add_u32 s70, s70, s75
    s_cmp_ge_u32 s70, 8
    s_cselect_b32 s71, 46, 56
    s_add_u32 s70, s70, s71
    s_mul_i32 s68, s68, 10
    s_add_u32 s68, s68, s70
    s_mul_i32 s68, s68, 5120
    s_add_u32 s68, s68, s66
    s_mul_i32 m0, s69, 5120
    s_add_u32 s70, s68, 4096
    s_waitcnt vmcnt(7)
    buffer_load_dwordx4 v1, s[56:59], s68 offen offset:0 sc1 lds
    s_waitcnt vmcnt(7)
    buffer_load_dwordx4 v1, s[56:59], s68 offen offset:1024 sc1 lds
    s_waitcnt vmcnt(7)
    buffer_load_dwordx4 v1, s[56:59], s68 offen offset:2048 sc1 lds
    s_waitcnt vmcnt(7)
    buffer_load_dwordx4 v1, s[56:59], s68 offen offset:3072 sc1 lds
    s_add_u32 m0, m0, 4096
    s_nop 0
    s_waitcnt vmcnt(7)
    buffer_load_dwordx4 v1, s[56:59], s70 offen offset:0 sc1 lds
    s_add_u32 s69, s90, 16
    s_mul_i32 s68, s69, 43
    s_lshr_b32 s68, s68, 8
    s_mul_i32 s70, s68, 6
    s_sub_u32 s70, s69, s70
    s_add_u32 s70, s70, s75
    s_cmp_ge_u32 s70, 8
    s_cselect_b32 s71, 46, 56
    s_add_u32 s70, s70, s71
    s_mul_i32 s68, s68, 10
    s_add_u32 s68, s68, s70
    s_mul_i32 s68, s68, 5120
    s_add_u32 s68, s68, s66
    s_mul_i32 m0, s69, 5120
    s_add_u32 s70, s68, 4096
    s_waitcnt vmcnt(7)
    buffer_load_dwordx4 v1, s[56:59], s68 offen offset:0 sc1 lds
    s_waitcnt vmcnt(7)
    buffer_load_dwordx4 v1, s[56:59], s68 offen offset:1024 sc1 lds
    s_waitcnt vmcnt(7)
    buffer_load_dwordx4 v1, s[56:59], s68 offen offset:2048 sc1 lds
    s_waitcnt vmcnt(7)
    buffer_load_dwordx4 v1, s[56:59], s68 offen offset:3072 sc1 lds
    s_add_u32 m0, m0, 4096
    s_nop 0
    s_waitcnt vmcnt(7)
    buffer_load_dwordx4 v1, s[56:59], s70 offen offset:0 sc1 lds
    s_add_u32 s69, s90, 20
    s_mul_i32 s68, s69, 43
    s_lshr_b32 s68, s68, 8
    s_mul_i32 s70, s68, 6
    s_sub_u32 s70, s69, s70
    s_add_u32 s70, s70, s75
    s_cmp_ge_u32 s70, 8
    s_cselect_b32 s71, 46, 56
    s_add_u32 s70, s70, s71
    s_mul_i32 s68, s68, 10
    s_add_u32 s68, s68, s70
    s_mul_i32 s68, s68, 5120
    s_add_u32 s68, s68, s66
    s_mul_i32 m0, s69, 5120
    s_add_u32 s70, s68, 4096
    s_waitcnt vmcnt(7)
    buffer_load_dwordx4 v1, s[56:59], s68 offen offset:0 sc1 lds
    s_waitcnt vmcnt(7)
    buffer_load_dwordx4 v1, s[56:59], s68 offen offset:1024 sc1 lds
    s_waitcnt vmcnt(7)
    buffer_load_dwordx4 v1, s[56:59], s68 offen offset:2048 sc1 lds
    s_waitcnt vmcnt(7)
    buffer_load_dwordx4 v1, s[56:59], s68 offen offset:3072 sc1 lds
    s_add_u32 m0, m0, 4096
    s_nop 0
    s_waitcnt vmcnt(7)
    buffer_load_dwordx4 v1, s[56:59], s70 offen offset:0 sc1 lds
Lp_done0:
    s_cmp_ge_u32 s73, 16
    s_cbranch_scc1 Lh_nog
    v_cvt_pk_bf16_f32 v128, v128, v128
    v_lshlrev_b32 v128, 16, v128
    v_mul_f32 v128, 0xbfb8aa3b, v128
    v_exp_f32 v128, v128
    s_nop 0
    v_add_f32 v128, 1.0, v128
    v_rcp_f32 v128, v128
    s_nop 0
    v_cvt_pk_bf16_f32 v128, v128, v128
    v_lshlrev_b32 v128, 16, v128
    v_mov_b32 v129, s64
    s_add_u32 s60, s36, 0x1000000
    s_addc_u32 s61, s37, 0
    s_mov_b32 s62, 0x4000
    s_mov_b32 s63, 0x20000
    v_lshlrev_b32 v2, 3, v0
    s_lshl_b32 s66, s39, 4
    s_add_u32 s66, s66, s40
    s_lshl_b32 s66, s66, 7
    s_mov_b64 exec, 0xffff
    buffer_store_dwordx2 v[128:129], v2, s[60:63], s66 offen sc1
    s_mov_b64 exec, -1
Lh_nog:
    s_waitcnt vmcnt(0)
    s_lshl_b32 s66, s90, 2
    s_add_u32 s66, s66, 160512
    v_mov_b32 v2, s66
    v_mov_b32 v3, s64
    ds_write_b32 v2, v3
L_p2l:
    s_setprio 0
    s_add_u32 s56, s36, 0x1040000
    s_addc_u32 s57, s37, 0
    s_mov_b32 s58, 0x40000
    s_mov_b32 s59, 0x20000
    s_lshl_b32 s80, s74, 12
    s_mul_i32 s69, s42, 385024
    s_add_u32 s80, s80, s69
    s_mul_i32 s69, s101, 28672
    s_add_u32 s80, s80, s69
    s_nop 0
    s_mul_i32 s83, s101, -57344
    s_add_u32 s83, s83, 4096
    s_mul_i32 s75, s101, -71680
    s_add_u32 s75, s75, 5120
    s_mul_i32 s68, s90, 7
    s_add_u32 s68, s68, 22
    s_cmp_eq_u32 s90, 2
    s_cselect_b32 s69, 6, 7
    s_cmp_eq_u32 s90, 3
    s_cselect_b32 s68, 0, s68
    s_cselect_b32 s69, 6, s69
    s_bfm_b64 s[78:79], s69, s68
    v_lshlrev_b32 v2, 7, v0
    s_lshl_b32 s65, s42, 13
    s_lshl_b32 s70, s90, 2
    s_add_u32 s70, s70, 160512
    v_mov_b32_e64 v6, s70
    s_mov_b32 s72, 0
L2L_gpoll:
    ds_read_b32 v7, v6 offset:288
    s_waitcnt lgkmcnt(0)
    v_cmp_ne_u32 vcc, s64, v7
    s_add_u32 s72, s72, 1
    s_cmp_eq_u64 vcc, 0
    s_cbranch_scc1 L2L_ggot
    s_sleep 1
    s_cmp_lt_u32 s72, 0x100000
    s_cbranch_scc1 L2L_gpoll
L2L_ggot:
    s_mov_b32 s72, 0
    s_lshl_b32 s68, s68, 7
    s_add_u32 s68, s68, s65
    s_add_u32 s78, s56, s68
    s_addc_u32 s79, s57, 0
    s_sub_u32 s69, s69, 1
    s_lshl_b32 s69, s69, 7
L2L_poll:
    s_load_dword s6, s[78:79], 0 glc
    s_load_dword s7, s[78:79], 128 glc
    s_load_dword s8, s[78:79], 256 glc
    s_load_dword s9, s[78:79], 384 glc
    s_load_dword s10, s[78:79], 512 glc
    s_load_dword s11, s[78:79], 640 glc
    s_load_dword s12, s[78:79], s69 glc
L2L_chk:
    s_waitcnt lgkmcnt(0)
    s_xor_b32 s6, s6, s64
    s_xor_b32 s7, s7, s64
    s_xor_b32 s8, s8, s64
    s_xor_b32 s9, s9, s64
    s_xor_b32 s10, s10, s64
    s_xor_b32 s11, s11, s64
    s_xor_b32 s12, s12, s64
    s_or_b32 s6, s6, s7
    s_or_b32 s6, s6, s8
    s_or_b32 s6, s6, s9
    s_or_b32 s6, s6, s10
    s_or_b32 s6, s6, s11
    s_or_b32 s6, s6, s12
    s_cbranch_scc0 L2L_go
    s_sleep 4
    s_add_u32 s72, s72, 1
    s_cmp_lt_u32 s72, 0x40000
    s_cbranch_scc1 L2L_poll
L2L_go:
    buffer_load_dwordx4 v[86:89], v1, s[48:51], s80 offen offset:0 sc1
    buffer_load_dwordx4 v[90:93], v1, s[48:51], s80 offen offset:1024 sc1
    buffer_load_dwordx4 v[94:97], v1, s[48:51], s80 offen offset:2048 sc1
    buffer_load_dwordx4 v[98:101], v1, s[48:51], s80 offen offset:3072 sc1
    s_add_u32 s80, s80, 4096
    buffer_load_dwordx4 v[102:105], v1, s[48:51], s80 offen offset:0 sc1
    buffer_load_dwordx4 v[106:109], v1, s[48:51], s80 offen offset:1024 sc1
    buffer_load_dwordx4 v[110:113], v1, s[48:51], s80 offen offset:2048 sc1
    buffer_load_dwordx4 v[114:117], v1, s[48:51], s80 offen offset:3072 sc1
    s_add_u32 s80, s80, 4096
    buffer_load_dwordx4 v[118:121], v1, s[48:51], s80 offen offset:0 sc1
    buffer_load_dwordx4 v[122:125], v1, s[48:51], s80 offen offset:1024 sc1
    buffer_load_dwordx4 v[126:129], v1, s[48:51], s80 offen offset:2048 sc1
    buffer_load_dwordx4 v[130:133], v1, s[48:51], s80 offen offset:3072 sc1
    s_add_u32 s80, s80, 4096
    v_lshrrev_b32 v4, 4, v0
    v_bfe_u32 v3, v0, 1, 2
    v_xor_b32 v4, v4, v3
    v_and_b32 v3, 15, v0
    v_lshl_or_b32 v4, v3, 2, v4
    v_lshlrev_b32 v4, 4, v4
    s_mul_i32 s68, s90, 61440
    s_add_u32 s68, s68, 20480
    s_add_u32 s69, s68, 30720
    s_mul_i32 s70, s90, 20480
    s_add_u32 s70, s70, 81920
    s_add_u32 s82, s70, 10240
    s_cmp_ge_u32 s90, 2
    s_cselect_b32 s68, s70, s68
    s_cselect_b32 s69, s82, s69
    v_add_u32 v3, s68, v4
    v_add_u32 v5, s69, v4
    s_waitcnt vmcnt(8)
    v_mfma_f32_16x16x32_bf16 v[6:9], v[134:137], v[86:89], 0
    v_mfma_f32_16x16x32_bf16 v[10:13], v[134:137], v[90:93], 0
    v_mfma_f32_16x16x32_bf16 v[14:17], v[134:137], v[94:97], 0
    v_mfma_f32_16x16x32_bf16 v[18:21], v[134:137], v[98:101], 0
    v_mfma_f32_16x16x32_bf16 v[22:25], v[138:141], v[86:89], 0
    v_mfma_f32_16x16x32_bf16 v[26:29], v[138:141], v[90:93], 0
    buffer_load_dwordx4 v[134:137], v1, s[48:51], s80 offen offset:0 sc1
    v_mfma_f32_16x16x32_bf16 v[30:33], v[138:141], v[94:97], 0
    v_mfma_f32_16x16x32_bf16 v[34:37], v[138:141], v[98:101], 0
    v_mfma_f32_16x16x32_bf16 v[38:41], v[142:145], v[86:89], 0
    v_mfma_f32_16x16x32_bf16 v[42:45], v[142:145], v[90:93], 0
    buffer_load_dwordx4 v[138:141], v1, s[48:51], s80 offen offset:1024 sc1
    v_mfma_f32_16x16x32_bf16 v[46:49], v[142:145], v[94:97], 0
    v_mfma_f32_16x16x32_bf16 v[50:53], v[142:145], v[98:101], 0
    v_mfma_f32_16x16x32_bf16 v[54:57], v[146:149], v[86:89], 0
    v_mfma_f32_16x16x32_bf16 v[58:61], v[146:149], v[90:93], 0
    buffer_load_dwordx4 v[142:145], v1, s[48:51], s80 offen offset:2048 sc1
    v_mfma_f32_16x16x32_bf16 v[62:65], v[146:149], v[94:97], 0
    v_mfma_f32_16x16x32_bf16 v[66:69], v[146:149], v[98:101], 0
    v_mfma_f32_16x16x32_bf16 v[70:73], v[150:153], v[86:89], 0
    v_mfma_f32_16x16x32_bf16 v[74:77], v[150:153], v[90:93], 0
    buffer_load_dwordx4 v[146:149], v1, s[48:51], s80 offen offset:3072 sc1
    s_add_u32 s80, s80, 4096
    v_mfma_f32_16x16x32_bf16 v[78:81], v[150:153], v[94:97], 0
    v_mfma_f32_16x16x32_bf16 v[82:85], v[150:153], v[98:101], 0
    s_waitcnt vmcnt(8)
    s_nop 0
    v_mfma_f32_16x16x32_bf16 v[6:9], v[154:157], v[102:105], v[6:9]
    v_mfma_f32_16x16x32_bf16 v[10:13], v[154:157], v[106:109], v[10:13]
    buffer_load_dwordx4 v[86:89], v1, s[48:51], s80 offen offset:0 sc1
    v_mfma_f32_16x16x32_bf16 v[14:17], v[154:157], v[110:113], v[14:17]
    v_mfma_f32_16x16x32_bf16 v[18:21], v[154:157], v[114:117], v[18:21]
    buffer_load_dwordx4 v[90:93], v1, s[48:51], s80 offen offset:1024 sc1
    v_mfma_f32_16x16x32_bf16 v[22:25], v[158:161], v[102:105], v[22:25]
    v_mfma_f32_16x16x32_bf16 v[26:29], v[158:161], v[106:109], v[26:29]
    buffer_load_dwordx4 v[94:97], v1, s[48:51], s80 offen offset:2048 sc1
    v_mfma_f32_16x16x32_bf16 v[30:33], v[158:161], v[110:113], v[30:33]
    v_mfma_f32_16x16x32_bf16 v[34:37], v[158:161], v[114:117], v[34:37]
    buffer_load_dwordx4 v[98:101], v1, s[48:51], s80 offen offset:3072 sc1
    s_add_u32 s80, s80, 4096
    v_mfma_f32_16x16x32_bf16 v[38:41], v[162:165], v[102:105], v[38:41]
    v_mfma_f32_16x16x32_bf16 v[42:45], v[162:165], v[106:109], v[42:45]
    v_mfma_f32_16x16x32_bf16 v[46:49], v[162:165], v[110:113], v[46:49]
    v_mfma_f32_16x16x32_bf16 v[50:53], v[162:165], v[114:117], v[50:53]
    v_mfma_f32_16x16x32_bf16 v[54:57], v[166:169], v[102:105], v[54:57]
    v_mfma_f32_16x16x32_bf16 v[58:61], v[166:169], v[106:109], v[58:61]
    v_mfma_f32_16x16x32_bf16 v[62:65], v[166:169], v[110:113], v[62:65]
    v_mfma_f32_16x16x32_bf16 v[66:69], v[166:169], v[114:117], v[66:69]
    v_mfma_f32_16x16x32_bf16 v[70:73], v[170:173], v[102:105], v[70:73]
    v_mfma_f32_16x16x32_bf16 v[74:77], v[170:173], v[106:109], v[74:77]
    v_mfma_f32_16x16x32_bf16 v[78:81], v[170:173], v[110:113], v[78:81]
    v_mfma_f32_16x16x32_bf16 v[82:85], v[170:173], v[114:117], v[82:85]
    s_waitcnt vmcnt(8)
    s_nop 0
    v_mfma_f32_16x16x32_bf16 v[6:9], v[174:177], v[118:121], v[6:9]
    v_mfma_f32_16x16x32_bf16 v[10:13], v[174:177], v[122:125], v[10:13]
    buffer_load_dwordx4 v[150:153], v1, s[48:51], s80 offen offset:0 sc1
    v_mfma_f32_16x16x32_bf16 v[14:17], v[174:177], v[126:129], v[14:17]
    v_mfma_f32_16x16x32_bf16 v[18:21], v[174:177], v[130:133], v[18:21]
    buffer_load_dwordx4 v[154:157], v1, s[48:51], s80 offen offset:1024 sc1
    v_mfma_f32_16x16x32_bf16 v[22:25], v[178:181], v[118:121], v[22:25]
    v_mfma_f32_16x16x32_bf16 v[26:29], v[178:181], v[122:125], v[26:29]
    buffer_load_dwordx4 v[158:161], v1, s[48:51], s80 offen offset:2048 sc1
    v_mfma_f32_16x16x32_bf16 v[30:33], v[178:181], v[126:129], v[30:33]
    v_mfma_f32_16x16x32_bf16 v[34:37], v[178:181], v[130:133], v[34:37]
    buffer_load_dwordx4 v[162:165], v1, s[48:51], s80 offen offset:3072 sc1
    s_add_u32 s80, s80, 4096
    v_mfma_f32_16x16x32_bf16 v[38:41], v[182:185], v[118:121], v[38:41]
    v_mfma_f32_16x16x32_bf16 v[42:45], v[182:185], v[122:125], v[42:45]
    v_mfma_f32_16x16x32_bf16 v[46:49], v[182:185], v[126:129], v[46:49]
    v_mfma_f32_16x16x32_bf16 v[50:53], v[182:185], v[130:133], v[50:53]
    v_mfma_f32_16x16x32_bf16 v[54:57], v[186:189], v[118:121], v[54:57]
    v_mfma_f32_16x16x32_bf16 v[58:61], v[186:189], v[122:125], v[58:61]
    v_mfma_f32_16x16x32_bf16 v[62:65], v[186:189], v[126:129], v[62:65]
    v_mfma_f32_16x16x32_bf16 v[66:69], v[186:189], v[130:133], v[66:69]
    v_mfma_f32_16x16x32_bf16 v[70:73], v[190:193], v[118:121], v[70:73]
    v_mfma_f32_16x16x32_bf16 v[74:77], v[190:193], v[122:125], v[74:77]
    v_mfma_f32_16x16x32_bf16 v[78:81], v[190:193], v[126:129], v[78:81]
    v_mfma_f32_16x16x32_bf16 v[82:85], v[190:193], v[130:133], v[82:85]
    s_waitcnt vmcnt(8)
    s_nop 0
    v_mfma_f32_16x16x32_bf16 v[6:9], v[194:197], v[134:137], v[6:9]
    v_mfma_f32_16x16x32_bf16 v[10:13], v[194:197], v[138:141], v[10:13]
    buffer_load_dwordx4 v[166:169], v1, s[52:55], s76 offen offset:0 sc1
    v_mfma_f32_16x16x32_bf16 v[14:17], v[194:197], v[142:145], v[14:17]
    v_mfma_f32_16x16x32_bf16 v[18:21], v[194:197], v[146:149], v[18:21]
    buffer_load_dwordx4 v[102:105], v1, s[52:55], s76 offen offset:1024 sc1
    v_mfma_f32_16x16x32_bf16 v[22:25], v[198:201], v[134:137], v[22:25]
    v_mfma_f32_16x16x32_bf16 v[26:29], v[198:201], v[138:141], v[26:29]
    buffer_load_dwordx4 v[106:109], v1, s[52:55], s76 offen offset:2048 sc1
    v_mfma_f32_16x16x32_bf16 v[30:33], v[198:201], v[142:145], v[30:33]
    v_mfma_f32_16x16x32_bf16 v[34:37], v[198:201], v[146:149], v[34:37]
    buffer_load_dwordx4 v[110:113], v1, s[52:55], s76 offen offset:3072 sc1
    s_add_u32 s76, s76, s75
    s_nop 0
    v_mfma_f32_16x16x32_bf16 v[38:41], v[202:205], v[134:137], v[38:41]
    v_mfma_f32_16x16x32_bf16 v[42:45], v[202:205], v[138:141], v[42:45]
    buffer_load_dwordx4 v[114:117], v1, s[52:55], s77 offen offset:0 sc1
    s_add_u32 s77, s77, s75
    s_nop 0
    v_mfma_f32_16x16x32_bf16 v[46:49], v[202:205], v[142:145], v[46:49]
    v_mfma_f32_16x16x32_bf16 v[50:53], v[202:205], v[146:149], v[50:53]
    buffer_load_dwordx4 v[170:173], v1, s[48:51], s80 offen offset:0 sc1
    v_mfma_f32_16x16x32_bf16 v[54:57], v[206:209], v[134:137], v[54:57]
    v_mfma_f32_16x16x32_bf16 v[58:61], v[206:209], v[138:141], v[58:61]
    buffer_load_dwordx4 v[174:177], v1, s[48:51], s80 offen offset:1024 sc1
    v_mfma_f32_16x16x32_bf16 v[62:65], v[206:209], v[142:145], v[62:65]
    v_mfma_f32_16x16x32_bf16 v[66:69], v[206:209], v[146:149], v[66:69]
    buffer_load_dwordx4 v[178:181], v1, s[48:51], s80 offen offset:2048 sc1
    v_mfma_f32_16x16x32_bf16 v[70:73], v[210:213], v[134:137], v[70:73]
    v_mfma_f32_16x16x32_bf16 v[74:77], v[210:213], v[138:141], v[74:77]
    buffer_load_dwordx4 v[182:185], v1, s[48:51], s80 offen offset:3072 sc1
    s_add_u32 s80, s80, s83
    v_mfma_f32_16x16x32_bf16 v[78:81], v[210:213], v[142:145], v[78:81]
    v_mfma_f32_16x16x32_bf16 v[82:85], v[210:213], v[146:149], v[82:85]
    s_waitcnt vmcnt(13)
    v_mfma_f32_16x16x32_bf16 v[6:9], v[214:217], v[86:89], v[6:9]
    v_mfma_f32_16x16x32_bf16 v[10:13], v[214:217], v[90:93], v[10:13]
    buffer_load_dwordx4 v[186:189], v1, s[52:55], s76 offen offset:0 sc1
    v_mfma_f32_16x16x32_bf16 v[14:17], v[214:217], v[94:97], v[14:17]
    v_mfma_f32_16x16x32_bf16 v[18:21], v[214:217], v[98:101], v[18:21]
    buffer_load_dwordx4 v[118:121], v1, s[52:55], s76 offen offset:1024 sc1
    v_mfma_f32_16x16x32_bf16 v[22:25], v[218:221], v[86:89], v[22:25]
    v_mfma_f32_16x16x32_bf16 v[26:29], v[218:221], v[90:93], v[26:29]
    buffer_load_dwordx4 v[122:125], v1, s[52:55], s76 offen offset:2048 sc1
    v_mfma_f32_16x16x32_bf16 v[30:33], v[218:221], v[94:97], v[30:33]
    v_mfma_f32_16x16x32_bf16 v[34:37], v[218:221], v[98:101], v[34:37]
    buffer_load_dwordx4 v[126:129], v1, s[52:55], s76 offen offset:3072 sc1
    s_add_u32 s76, s76, 5120
    v_mfma_f32_16x16x32_bf16 v[38:41], v[222:225], v[86:89], v[38:41]
    v_mfma_f32_16x16x32_bf16 v[42:45], v[222:225], v[90:93], v[42:45]
    buffer_load_dwordx4 v[130:133], v1, s[52:55], s77 offen offset:0 sc1
    s_add_u32 s77, s77, 5120
    v_mfma_f32_16x16x32_bf16 v[46:49], v[222:225], v[94:97], v[46:49]
    v_mfma_f32_16x16x32_bf16 v[50:53], v[222:225], v[98:101], v[50:53]
    buffer_load_dwordx4 v[190:193], v1, s[48:51], s80 offen offset:0 sc1
    v_mfma_f32_16x16x32_bf16 v[54:57], v[226:229], v[86:89], v[54:57]
    v_mfma_f32_16x16x32_bf16 v[58:61], v[226:229], v[90:93], v[58:61]
    buffer_load_dwordx4 v[194:197], v1, s[48:51], s80 offen offset:1024 sc1
    v_mfma_f32_16x16x32_bf16 v[62:65], v[226:229], v[94:97], v[62:65]
    v_mfma_f32_16x16x32_bf16 v[66:69], v[226:229], v[98:101], v[66:69]
    buffer_load_dwordx4 v[198:201], v1, s[48:51], s80 offen offset:2048 sc1
    v_mfma_f32_16x16x32_bf16 v[70:73], v[230:233], v[86:89], v[70:73]
    v_mfma_f32_16x16x32_bf16 v[74:77], v[230:233], v[90:93], v[74:77]
    buffer_load_dwordx4 v[202:205], v1, s[48:51], s80 offen offset:3072 sc1
    s_add_u32 s80, s80, 4096
    v_mfma_f32_16x16x32_bf16 v[78:81], v[230:233], v[94:97], v[78:81]
    v_mfma_f32_16x16x32_bf16 v[82:85], v[230:233], v[98:101], v[82:85]
    s_waitcnt vmcnt(18)
    s_nop 0
    v_mfma_f32_16x16x32_bf16 v[6:9], v[234:237], v[150:153], v[6:9]
    v_mfma_f32_16x16x32_bf16 v[10:13], v[234:237], v[154:157], v[10:13]
    buffer_load_dwordx4 v[206:209], v1, s[52:55], s76 offen offset:0 sc1
    v_mfma_f32_16x16x32_bf16 v[14:17], v[234:237], v[158:161], v[14:17]
    v_mfma_f32_16x16x32_bf16 v[18:21], v[234:237], v[162:165], v[18:21]
    buffer_load_dwordx4 v[134:137], v1, s[52:55], s76 offen offset:1024 sc1
    v_mfma_f32_16x16x32_bf16 v[22:25], v[238:241], v[150:153], v[22:25]
    v_mfma_f32_16x16x32_bf16 v[26:29], v[238:241], v[154:157], v[26:29]
    buffer_load_dwordx4 v[138:141], v1, s[52:55], s76 offen offset:2048 sc1
    v_mfma_f32_16x16x32_bf16 v[30:33], v[238:241], v[158:161], v[30:33]
    v_mfma_f32_16x16x32_bf16 v[34:37], v[238:241], v[162:165], v[34:37]
    buffer_load_dwordx4 v[142:145], v1, s[52:55], s76 offen offset:3072 sc1
    s_add_u32 s76, s76, 5120
    v_mfma_f32_16x16x32_bf16 v[38:41], v[242:245], v[150:153], v[38:41]
    v_mfma_f32_16x16x32_bf16 v[42:45], v[242:245], v[154:157], v[42:45]
    buffer_load_dwordx4 v[146:149], v1, s[52:55], s77 offen offset:0 sc1
    s_add_u32 s77, s77, 5120
    v_mfma_f32_16x16x32_bf16 v[46:49], v[242:245], v[158:161], v[46:49]
    v_mfma_f32_16x16x32_bf16 v[50:53], v[242:245], v[162:165], v[50:53]
    buffer_load_dwordx4 v[210:213], v1, s[48:51], s80 offen offset:0 sc1
    v_mfma_f32_16x16x32_bf16 v[54:57], v[246:249], v[150:153], v[54:57]
    v_mfma_f32_16x16x32_bf16 v[58:61], v[246:249], v[154:157], v[58:61]
    buffer_load_dwordx4 v[214:217], v1, s[48:51], s80 offen offset:1024 sc1
    v_mfma_f32_16x16x32_bf16 v[62:65], v[246:249], v[158:161], v[62:65]
    v_mfma_f32_16x16x32_bf16 v[66:69], v[246:249], v[162:165], v[66:69]
    buffer_load_dwordx4 v[218:221], v1, s[48:51], s80 offen offset:2048 sc1
    v_mfma_f32_16x16x32_bf16 v[70:73], v[250:253], v[150:153], v[70:73]
    v_mfma_f32_16x16x32_bf16 v[74:77], v[250:253], v[154:157], v[74:77]
    buffer_load_dwordx4 v[222:225], v1, s[48:51], s80 offen offset:3072 sc1
    s_add_u32 s80, s80, 4096
    v_mfma_f32_16x16x32_bf16 v[78:81], v[250:253], v[158:161], v[78:81]
    v_mfma_f32_16x16x32_bf16 v[82:85], v[250:253], v[162:165], v[82:85]
    s_waitcnt vmcnt(18)
    s_nop 0
    v_mfma_f32_16x16x32_bf16 v[6:9], v[166:169], v[170:173], v[6:9]
    v_mfma_f32_16x16x32_bf16 v[10:13], v[166:169], v[174:177], v[10:13]
    buffer_load_dwordx4 v[226:229], v1, s[52:55], s76 offen offset:0 sc1
    v_mfma_f32_16x16x32_bf16 v[14:17], v[166:169], v[178:181], v[14:17]
    v_mfma_f32_16x16x32_bf16 v[18:21], v[166:169], v[182:185], v[18:21]
    buffer_load_dwordx4 v[86:89], v1, s[52:55], s76 offen offset:1024 sc1
    v_mfma_f32_16x16x32_bf16 v[22:25], v[102:105], v[170:173], v[22:25]
    v_mfma_f32_16x16x32_bf16 v[26:29], v[102:105], v[174:177], v[26:29]
    buffer_load_dwordx4 v[90:93], v1, s[52:55], s76 offen offset:2048 sc1
    v_mfma_f32_16x16x32_bf16 v[30:33], v[102:105], v[178:181], v[30:33]
    v_mfma_f32_16x16x32_bf16 v[34:37], v[102:105], v[182:185], v[34:37]
    buffer_load_dwordx4 v[94:97], v1, s[52:55], s76 offen offset:3072 sc1
    s_add_u32 s76, s76, 5120
    v_mfma_f32_16x16x32_bf16 v[38:41], v[106:109], v[170:173], v[38:41]
    v_mfma_f32_16x16x32_bf16 v[42:45], v[106:109], v[174:177], v[42:45]
    buffer_load_dwordx4 v[98:101], v1, s[52:55], s77 offen offset:0 sc1
    s_add_u32 s77, s77, 5120
    v_mfma_f32_16x16x32_bf16 v[46:49], v[106:109], v[178:181], v[46:49]
    v_mfma_f32_16x16x32_bf16 v[50:53], v[106:109], v[182:185], v[50:53]
    buffer_load_dwordx4 v[230:233], v1, s[48:51], s80 offen offset:0 sc1
    v_mfma_f32_16x16x32_bf16 v[54:57], v[110:113], v[170:173], v[54:57]
    v_mfma_f32_16x16x32_bf16 v[58:61], v[110:113], v[174:177], v[58:61]
    buffer_load_dwordx4 v[234:237], v1, s[48:51], s80 offen offset:1024 sc1
    v_mfma_f32_16x16x32_bf16 v[62:65], v[110:113], v[178:181], v[62:65]
    v_mfma_f32_16x16x32_bf16 v[66:69], v[110:113], v[182:185], v[66:69]
    buffer_load_dwordx4 v[238:241], v1, s[48:51], s80 offen offset:2048 sc1
    v_mfma_f32_16x16x32_bf16 v[70:73], v[114:117], v[170:173], v[70:73]
    v_mfma_f32_16x16x32_bf16 v[74:77], v[114:117], v[174:177], v[74:77]
    buffer_load_dwordx4 v[242:245], v1, s[48:51], s80 offen offset:3072 sc1
    s_add_u32 s80, s80, 4096
    v_mfma_f32_16x16x32_bf16 v[78:81], v[114:117], v[178:181], v[78:81]
    v_mfma_f32_16x16x32_bf16 v[82:85], v[114:117], v[182:185], v[82:85]
    s_waitcnt vmcnt(18)
    s_nop 0
    v_mfma_f32_16x16x32_bf16 v[6:9], v[186:189], v[190:193], v[6:9]
    v_mfma_f32_16x16x32_bf16 v[10:13], v[186:189], v[194:197], v[10:13]
    buffer_load_dwordx4 v[246:249], v1, s[52:55], s76 offen offset:0 sc1
    v_mfma_f32_16x16x32_bf16 v[14:17], v[186:189], v[198:201], v[14:17]
    v_mfma_f32_16x16x32_bf16 v[18:21], v[186:189], v[202:205], v[18:21]
    buffer_load_dwordx4 v[150:153], v1, s[52:55], s76 offen offset:1024 sc1
    v_mfma_f32_16x16x32_bf16 v[22:25], v[118:121], v[190:193], v[22:25]
    v_mfma_f32_16x16x32_bf16 v[26:29], v[118:121], v[194:197], v[26:29]
    buffer_load_dwordx4 v[154:157], v1, s[52:55], s76 offen offset:2048 sc1
    v_mfma_f32_16x16x32_bf16 v[30:33], v[118:121], v[198:201], v[30:33]
    v_mfma_f32_16x16x32_bf16 v[34:37], v[118:121], v[202:205], v[34:37]
    buffer_load_dwordx4 v[158:161], v1, s[52:55], s76 offen offset:3072 sc1
    s_add_u32 s76, s76, 5120
    v_mfma_f32_16x16x32_bf16 v[38:41], v[122:125], v[190:193], v[38:41]
    v_mfma_f32_16x16x32_bf16 v[42:45], v[122:125], v[194:197], v[42:45]
    buffer_load_dwordx4 v[162:165], v1, s[52:55], s77 offen offset:0 sc1
    s_add_u32 s77, s77, 5120
    v_mfma_f32_16x16x32_bf16 v[46:49], v[122:125], v[198:201], v[46:49]
    v_mfma_f32_16x16x32_bf16 v[50:53], v[122:125], v[202:205], v[50:53]
    buffer_load_dwordx4 v[250:253], v1, s[48:51], s80 offen offset:0 sc1
    v_mfma_f32_16x16x32_bf16 v[54:57], v[126:129], v[190:193], v[54:57]
    v_mfma_f32_16x16x32_bf16 v[58:61], v[126:129], v[194:197], v[58:61]
    buffer_load_dwordx4 v[166:169], v1, s[48:51], s80 offen offset:1024 sc1
    v_mfma_f32_16x16x32_bf16 v[62:65], v[126:129], v[198:201], v[62:65]
    v_mfma_f32_16x16x32_bf16 v[66:69], v[126:129], v[202:205], v[66:69]
    buffer_load_dwordx4 v[102:105], v1, s[48:51], s80 offen offset:2048 sc1
    v_mfma_f32_16x16x32_bf16 v[70:73], v[130:133], v[190:193], v[70:73]
    v_mfma_f32_16x16x32_bf16 v[74:77], v[130:133], v[194:197], v[74:77]
    buffer_load_dwordx4 v[106:109], v1, s[48:51], s80 offen offset:3072 sc1
    s_add_u32 s80, s80, 4096
    v_mfma_f32_16x16x32_bf16 v[78:81], v[130:133], v[198:201], v[78:81]
    v_mfma_f32_16x16x32_bf16 v[82:85], v[130:133], v[202:205], v[82:85]
    s_waitcnt vmcnt(18)
    s_nop 0
    v_mfma_f32_16x16x32_bf16 v[6:9], v[206:209], v[210:213], v[6:9]
    v_mfma_f32_16x16x32_bf16 v[10:13], v[206:209], v[214:217], v[10:13]
    buffer_load_dwordx4 v[110:113], v1, s[52:55], s76 offen offset:0 sc1
    v_mfma_f32_16x16x32_bf16 v[14:17], v[206:209], v[218:221], v[14:17]
    v_mfma_f32_16x16x32_bf16 v[18:21], v[206:209], v[222:225], v[18:21]
    buffer_load_dwordx4 v[170:173], v1, s[52:55], s76 offen offset:1024 sc1
    v_mfma_f32_16x16x32_bf16 v[22:25], v[134:137], v[210:213], v[22:25]
    v_mfma_f32_16x16x32_bf16 v[26:29], v[134:137], v[214:217], v[26:29]
    buffer_load_dwordx4 v[174:177], v1, s[52:55], s76 offen offset:2048 sc1
    v_mfma_f32_16x16x32_bf16 v[30:33], v[134:137], v[218:221], v[30:33]
    v_mfma_f32_16x16x32_bf16 v[34:37], v[134:137], v[222:225], v[34:37]
    buffer_load_dwordx4 v[178:181], v1, s[52:55], s76 offen offset:3072 sc1
    s_add_u32 s76, s76, 5120
    v_mfma_f32_16x16x32_bf16 v[38:41], v[138:141], v[210:213], v[38:41]
    v_mfma_f32_16x16x32_bf16 v[42:45], v[138:141], v[214:217], v[42:45]
    buffer_load_dwordx4 v[182:185], v1, s[52:55], s77 offen offset:0 sc1
    s_add_u32 s77, s77, 5120
    v_mfma_f32_16x16x32_bf16 v[46:49], v[138:141], v[218:221], v[46:49]
    v_mfma_f32_16x16x32_bf16 v[50:53], v[138:141], v[222:225], v[50:53]
    buffer_load_dwordx4 v[114:117], v1, s[48:51], s80 offen offset:0 sc1
    v_mfma_f32_16x16x32_bf16 v[54:57], v[142:145], v[210:213], v[54:57]
    v_mfma_f32_16x16x32_bf16 v[58:61], v[142:145], v[214:217], v[58:61]
    buffer_load_dwordx4 v[186:189], v1, s[48:51], s80 offen offset:1024 sc1
    v_mfma_f32_16x16x32_bf16 v[62:65], v[142:145], v[218:221], v[62:65]
    v_mfma_f32_16x16x32_bf16 v[66:69], v[142:145], v[222:225], v[66:69]
    buffer_load_dwordx4 v[118:121], v1, s[48:51], s80 offen offset:2048 sc1
    v_mfma_f32_16x16x32_bf16 v[70:73], v[146:149], v[210:213], v[70:73]
    v_mfma_f32_16x16x32_bf16 v[74:77], v[146:149], v[214:217], v[74:77]
    buffer_load_dwordx4 v[122:125], v1, s[48:51], s80 offen offset:3072 sc1
    s_add_u32 s80, s80, 4096
    v_mfma_f32_16x16x32_bf16 v[78:81], v[146:149], v[218:221], v[78:81]
    v_mfma_f32_16x16x32_bf16 v[82:85], v[146:149], v[222:225], v[82:85]
    s_waitcnt vmcnt(18)
    s_nop 0
    v_mfma_f32_16x16x32_bf16 v[6:9], v[226:229], v[230:233], v[6:9]
    v_mfma_f32_16x16x32_bf16 v[10:13], v[226:229], v[234:237], v[10:13]
    buffer_load_dwordx4 v[126:129], v1, s[52:55], s76 offen offset:0 sc1
    v_mfma_f32_16x16x32_bf16 v[14:17], v[226:229], v[238:241], v[14:17]
    v_mfma_f32_16x16x32_bf16 v[18:21], v[226:229], v[242:245], v[18:21]
    buffer_load_dwordx4 v[190:193], v1, s[52:55], s76 offen offset:1024 sc1
    v_mfma_f32_16x16x32_bf16 v[22:25], v[86:89], v[230:233], v[22:25]
    v_mfma_f32_16x16x32_bf16 v[26:29], v[86:89], v[234:237], v[26:29]
    buffer_load_dwordx4 v[194:197], v1, s[52:55], s76 offen offset:2048 sc1
    v_mfma_f32_16x16x32_bf16 v[30:33], v[86:89], v[238:241], v[30:33]
    v_mfma_f32_16x16x32_bf16 v[34:37], v[86:89], v[242:245], v[34:37]
    buffer_load_dwordx4 v[198:201], v1, s[52:55], s76 offen offset:3072 sc1
    s_add_u32 s76, s76, 5120
    v_mfma_f32_16x16x32_bf16 v[38:41], v[90:93], v[230:233], v[38:41]
    v_mfma_f32_16x16x32_bf16 v[42:45], v[90:93], v[234:237], v[42:45]
    buffer_load_dwordx4 v[202:205], v1, s[52:55], s77 offen offset:0 sc1
    s_add_u32 s77, s77, 5120
    v_mfma_f32_16x16x32_bf16 v[46:49], v[90:93], v[238:241], v[46:49]
    v_mfma_f32_16x16x32_bf16 v[50:53], v[90:93], v[242:245], v[50:53]
    buffer_load_dwordx4 v[130:133], v1, s[48:51], s80 offen offset:0 sc1
    v_mfma_f32_16x16x32_bf16 v[54:57], v[94:97], v[230:233], v[54:57]
    v_mfma_f32_16x16x32_bf16 v[58:61], v[94:97], v[234:237], v[58:61]
    buffer_load_dwordx4 v[206:209], v1, s[48:51], s80 offen offset:1024 sc1
    v_mfma_f32_16x16x32_bf16 v[62:65], v[94:97], v[238:241], v[62:65]
    v_mfma_f32_16x16x32_bf16 v[66:69], v[94:97], v[242:245], v[66:69]
    buffer_load_dwordx4 v[134:137], v1, s[48:51], s80 offen offset:2048 sc1
    v_mfma_f32_16x16x32_bf16 v[70:73], v[98:101], v[230:233], v[70:73]
    v_mfma_f32_16x16x32_bf16 v[74:77], v[98:101], v[234:237], v[74:77]
    buffer_load_dwordx4 v[138:141], v1, s[48:51], s80 offen offset:3072 sc1
    s_add_u32 s80, s80, 4096
    v_mfma_f32_16x16x32_bf16 v[78:81], v[98:101], v[238:241], v[78:81]
    v_mfma_f32_16x16x32_bf16 v[82:85], v[98:101], v[242:245], v[82:85]
    s_waitcnt vmcnt(18)
    s_nop 0
    v_mfma_f32_16x16x32_bf16 v[6:9], v[246:249], v[250:253], v[6:9]
    v_mfma_f32_16x16x32_bf16 v[10:13], v[246:249], v[166:169], v[10:13]
    buffer_load_dwordx4 v[142:145], v1, s[52:55], s76 offen offset:0 sc1
    v_mfma_f32_16x16x32_bf16 v[14:17], v[246:249], v[102:105], v[14:17]
    v_mfma_f32_16x16x32_bf16 v[18:21], v[246:249], v[106:109], v[18:21]
    buffer_load_dwordx4 v[210:213], v1, s[52:55], s76 offen offset:1024 sc1
    v_mfma_f32_16x16x32_bf16 v[22:25], v[150:153], v[250:253], v[22:25]
    v_mfma_f32_16x16x32_bf16 v[26:29], v[150:153], v[166:169], v[26:29]
    buffer_load_dwordx4 v[214:217], v1, s[52:55], s76 offen offset:2048 sc1
    v_mfma_f32_16x16x32_bf16 v[30:33], v[150:153], v[102:105], v[30:33]
    v_mfma_f32_16x16x32_bf16 v[34:37], v[150:153], v[106:109], v[34:37]
    buffer_load_dwordx4 v[218:221], v1, s[52:55], s76 offen offset:3072 sc1
    s_add_u32 s76, s76, 5120
    v_mfma_f32_16x16x32_bf16 v[38:41], v[154:157], v[250:253], v[38:41]
    v_mfma_f32_16x16x32_bf16 v[42:45], v[154:157], v[166:169], v[42:45]
    buffer_load_dwordx4 v[222:225], v1, s[52:55], s77 offen offset:0 sc1
    s_add_u32 s77, s77, 5120
    v_mfma_f32_16x16x32_bf16 v[46:49], v[154:157], v[102:105], v[46:49]
    v_mfma_f32_16x16x32_bf16 v[50:53], v[154:157], v[106:109], v[50:53]
    buffer_load_dwordx4 v[146:149], v1, s[48:51], s80 offen offset:0 sc1
    v_mfma_f32_16x16x32_bf16 v[54:57], v[158:161], v[250:253], v[54:57]
    v_mfma_f32_16x16x32_bf16 v[58:61], v[158:161], v[166:169], v[58:61]
    buffer_load_dwordx4 v[226:229], v1, s[48:51], s80 offen offset:1024 sc1
    v_mfma_f32_16x16x32_bf16 v[62:65], v[158:161], v[102:105], v[62:65]
    v_mfma_f32_16x16x32_bf16 v[66:69], v[158:161], v[106:109], v[66:69]
    buffer_load_dwordx4 v[86:89], v1, s[48:51], s80 offen offset:2048 sc1
    v_mfma_f32_16x16x32_bf16 v[70:73], v[162:165], v[250:253], v[70:73]
    v_mfma_f32_16x16x32_bf16 v[74:77], v[162:165], v[166:169], v[74:77]
    buffer_load_dwordx4 v[90:93], v1, s[48:51], s80 offen offset:3072 sc1
    s_add_u32 s80, s80, 4096
    v_mfma_f32_16x16x32_bf16 v[78:81], v[162:165], v[102:105], v[78:81]
    v_mfma_f32_16x16x32_bf16 v[82:85], v[162:165], v[106:109], v[82:85]
    s_waitcnt vmcnt(18)
    s_nop 0
    v_mfma_f32_16x16x32_bf16 v[6:9], v[110:113], v[114:117], v[6:9]
    v_mfma_f32_16x16x32_bf16 v[10:13], v[110:113], v[186:189], v[10:13]
    v_mfma_f32_16x16x32_bf16 v[14:17], v[110:113], v[118:121], v[14:17]
    v_mfma_f32_16x16x32_bf16 v[18:21], v[110:113], v[122:125], v[18:21]
    v_mfma_f32_16x16x32_bf16 v[22:25], v[170:173], v[114:117], v[22:25]
    v_mfma_f32_16x16x32_bf16 v[26:29], v[170:173], v[186:189], v[26:29]
    v_mfma_f32_16x16x32_bf16 v[30:33], v[170:173], v[118:121], v[30:33]
    v_mfma_f32_16x16x32_bf16 v[34:37], v[170:173], v[122:125], v[34:37]
    v_mfma_f32_16x16x32_bf16 v[38:41], v[174:177], v[114:117], v[38:41]
    v_mfma_f32_16x16x32_bf16 v[42:45], v[174:177], v[186:189], v[42:45]
    v_mfma_f32_16x16x32_bf16 v[46:49], v[174:177], v[118:121], v[46:49]
    v_mfma_f32_16x16x32_bf16 v[50:53], v[174:177], v[122:125], v[50:53]
    v_mfma_f32_16x16x32_bf16 v[54:57], v[178:181], v[114:117], v[54:57]
    v_mfma_f32_16x16x32_bf16 v[58:61], v[178:181], v[186:189], v[58:61]
    v_mfma_f32_16x16x32_bf16 v[62:65], v[178:181], v[118:121], v[62:65]
    v_mfma_f32_16x16x32_bf16 v[66:69], v[178:181], v[122:125], v[66:69]
    v_mfma_f32_16x16x32_bf16 v[70:73], v[182:185], v[114:117], v[70:73]
    v_mfma_f32_16x16x32_bf16 v[74:77], v[182:185], v[186:189], v[74:77]
    v_mfma_f32_16x16x32_bf16 v[78:81], v[182:185], v[118:121], v[78:81]
    v_mfma_f32_16x16x32_bf16 v[82:85], v[182:185], v[122:125], v[82:85]
    s_barrier
    s_waitcnt vmcnt(9)
    v_mfma_f32_16x16x32_bf16 v[6:9], v[126:129], v[130:133], v[6:9]
    v_mfma_f32_16x16x32_bf16 v[10:13], v[126:129], v[206:209], v[10:13]
    v_mfma_f32_16x16x32_bf16 v[14:17], v[126:129], v[134:137], v[14:17]
    v_mfma_f32_16x16x32_bf16 v[18:21], v[126:129], v[138:141], v[18:21]
    s_waitcnt vmcnt(0)
    s_nop 0
    v_mfma_f32_16x16x32_bf16 v[22:25], v[190:193], v[130:133], v[22:25]
    v_mfma_f32_16x16x32_bf16 v[26:29], v[190:193], v[206:209], v[26:29]
    v_mfma_f32_16x16x32_bf16 v[30:33], v[190:193], v[134:137], v[30:33]
    v_mfma_f32_16x16x32_bf16 v[34:37], v[190:193], v[138:141], v[34:37]
    v_mfma_f32_16x16x32_bf16 v[6:9], v[142:145], v[146:149], v[6:9]
    v_mfma_f32_16x16x32_bf16 v[10:13], v[142:145], v[226:229], v[10:13]
    v_mfma_f32_16x16x32_bf16 v[14:17], v[142:145], v[86:89], v[14:17]
    v_mfma_f32_16x16x32_bf16 v[18:21], v[142:145], v[90:93], v[18:21]
    v_mfma_f32_16x16x32_bf16 v[38:41], v[194:197], v[130:133], v[38:41]
    v_mfma_f32_16x16x32_bf16 v[42:45], v[194:197], v[206:209], v[42:45]
    v_mfma_f32_16x16x32_bf16 v[46:49], v[194:197], v[134:137], v[46:49]
    v_mfma_f32_16x16x32_bf16 v[50:53], v[194:197], v[138:141], v[50:53]
    v_mfma_f32_16x16x32_bf16 v[22:25], v[210:213], v[146:149], v[22:25]
    v_mfma_f32_16x16x32_bf16 v[26:29], v[210:213], v[226:229], v[26:29]
    v_mfma_f32_16x16x32_bf16 v[30:33], v[210:213], v[86:89], v[30:33]
    v_mfma_f32_16x16x32_bf16 v[34:37], v[210:213], v[90:93], v[34:37]
    ds_write_b128 v3, v[6:9] offset:0
    ds_write_b128 v3, v[10:13] offset:5120
    ds_write_b128 v5, v[14:17] offset:0
    ds_write_b128 v5, v[18:21] offset:5120
    v_mfma_f32_16x16x32_bf16 v[54:57], v[198:201], v[130:133], v[54:57]
    v_mfma_f32_16x16x32_bf16 v[58:61], v[198:201], v[206:209], v[58:61]
    v_mfma_f32_16x16x32_bf16 v[62:65], v[198:201], v[134:137], v[62:65]
    v_mfma_f32_16x16x32_bf16 v[66:69], v[198:201], v[138:141], v[66:69]
    v_mfma_f32_16x16x32_bf16 v[38:41], v[214:217], v[146:149], v[38:41]
    v_mfma_f32_16x16x32_bf16 v[42:45], v[214:217], v[226:229], v[42:45]
    v_mfma_f32_16x16x32_bf16 v[46:49], v[214:217], v[86:89], v[46:49]
    v_mfma_f32_16x16x32_bf16 v[50:53], v[214:217], v[90:93], v[50:53]
    ds_write_b128 v3, v[22:25] offset:1024
    ds_write_b128 v3, v[26:29] offset:6144
    ds_write_b128 v5, v[30:33] offset:1024
    ds_write_b128 v5, v[34:37] offset:6144
    v_mfma_f32_16x16x32_bf16 v[70:73], v[202:205], v[130:133], v[70:73]
    v_mfma_f32_16x16x32_bf16 v[74:77], v[202:205], v[206:209], v[74:77]
    v_mfma_f32_16x16x32_bf16 v[78:81], v[202:205], v[134:137], v[78:81]
    v_mfma_f32_16x16x32_bf16 v[82:85], v[202:205], v[138:141], v[82:85]
    v_mfma_f32_16x16x32_bf16 v[54:57], v[218:221], v[146:149], v[54:57]
    v_mfma_f32_16x16x32_bf16 v[58:61], v[218:221], v[226:229], v[58:61]
    v_mfma_f32_16x16x32_bf16 v[62:65], v[218:221], v[86:89], v[62:65]
    v_mfma_f32_16x16x32_bf16 v[66:69], v[218:221], v[90:93], v[66:69]
    ds_write_b128 v3, v[38:41] offset:2048
    ds_write_b128 v3, v[42:45] offset:7168
    ds_write_b128 v5, v[46:49] offset:2048
    ds_write_b128 v5, v[50:53] offset:7168
    v_mfma_f32_16x16x32_bf16 v[70:73], v[222:225], v[146:149], v[70:73]
    v_mfma_f32_16x16x32_bf16 v[74:77], v[222:225], v[226:229], v[74:77]
    v_mfma_f32_16x16x32_bf16 v[78:81], v[222:225], v[86:89], v[78:81]
    v_mfma_f32_16x16x32_bf16 v[82:85], v[222:225], v[90:93], v[82:85]
    s_nop 3
    s_nop 0
    ds_write_b128 v3, v[54:57] offset:3072
    ds_write_b128 v3, v[58:61] offset:8192
    ds_write_b128 v5, v[62:65] offset:3072
    ds_write_b128 v5, v[66:69] offset:8192
    s_nop 3
    s_nop 0
    ds_write_b128 v3, v[70:73] offset:4096
    ds_write_b128 v3, v[74:77] offset:9216
    ds_write_b128 v5, v[78:81] offset:4096
    ds_write_b128 v5, v[82:85] offset:9216
    s_waitcnt lgkmcnt(0)
    s_barrier
    s_endpgm
L_compute:
    s_and_b32 s42, s2, 6
    s_bfe_u32 s43, s2, 0x30003
    s_lshl2_add_u32 s42, s42, s43
    s_and_b32 s43, s2, 1
    s_lshr_b32 s101, s2, 6
    s_lshl2_add_u32 s43, s43, s101
    s_mov_b32 s101, 0
    s_waitcnt lgkmcnt(0)
    s_cmp_eq_u32 s41, 1
    s_cbranch_scc1 L_ssm
    v_and_b32 v1, 31, v0
    v_lshrrev_b32 v2, 5, v0
    v_bfe_u32 v3, v0, 1, 3
    v_xor_b32 v3, v3, v2
    v_lshlrev_b32 v3, 4, v3
    v_lshl_add_u32 v3, v1, 7, v3
    s_lshl_b32 s44, s38, 13
    s_add_u32 s44, s44, 65536
    v_add_u32 v4, s44, v3
    v_xor_b32 v5, 32, v4
    v_xor_b32 v6, 64, v4
    v_xor_b32 v7, 96, v4
    v_bfe_u32 v1, v0, 4, 1
    v_mul_u32_u24 v1, 10368, v1
    v_lshlrev_b32 v2, 3, v2
    v_bfe_u32 v3, v0, 2, 2
    v_add_u32 v2, v2, v3
    v_mul_u32_u24 v2, 160, v2
    v_add_u32 v1, v1, v2
    v_and_b32 v2, 1, v0
    v_lshlrev_b32 v2, 4, v2
    v_add_u32 v1, v1, v2
    v_bfe_u32 v2, v0, 1, 1
    v_lshlrev_b32 v2, 3, v2
    v_add_u32 v1, v1, v2
    v_add_u32 v8, 139776, v1
    v_mov_b32 v11, 163832
    v_mov_b32 v16, 0
    v_mov_b32 v17, 0
    v_mov_b32 v18, 0
    v_mov_b32 v19, 0
    v_mov_b32 v20, 0
    v_mov_b32 v21, 0
    v_mov_b32 v22, 0
    v_mov_b32 v23, 0
    v_mov_b32 v24, 0
    v_mov_b32 v25, 0
    v_mov_b32 v26, 0
    v_mov_b32 v27, 0
    v_mov_b32 v28, 0
    v_mov_b32 v29, 0
    v_mov_b32 v30, 0
    v_mov_b32 v31, 0
    v_mov_b32 v32, 0
    v_mov_b32 v33, 0
    v_mov_b32 v34, 0
    v_mov_b32 v35, 0
    v_mov_b32 v36, 0
    v_mov_b32 v37, 0
    v_mov_b32 v38, 0
    v_mov_b32 v39, 0
    v_mov_b32 v40, 0
    v_mov_b32 v41, 0
    v_mov_b32 v42, 0
    v_mov_b32 v43, 0
    v_mov_b32 v44, 0
    v_mov_b32 v45, 0
    v_mov_b32 v46, 0
    v_mov_b32 v47, 0
    v_mov_b32 v48, 0
    v_mov_b32 v49, 0
    v_mov_b32 v50, 0
    v_mov_b32 v51, 0
    v_mov_b32 v52, 0
    v_mov_b32 v53, 0
    v_mov_b32 v54, 0
    v_mov_b32 v55, 0
    v_mov_b32 v56, 0
    v_mov_b32 v57, 0
    v_mov_b32 v58, 0
    v_mov_b32 v59, 0
    v_mov_b32 v60, 0
    v_mov_b32 v61, 0
    v_mov_b32 v62, 0
    v_mov_b32 v63, 0
    v_mov_b32 v64, 0
    v_mov_b32 v65, 0
    v_mov_b32 v66, 0
    v_mov_b32 v67, 0
    v_mov_b32 v68, 0
    v_mov_b32 v69, 0
    v_mov_b32 v70, 0
    v_mov_b32 v71, 0
    v_mov_b32 v72, 0
    v_mov_b32 v73, 0
    v_mov_b32 v74, 0
    v_mov_b32 v75, 0
    v_mov_b32 v76, 0
    v_mov_b32 v77, 0
    v_mov_b32 v78, 0
    v_mov_b32 v79, 0
    v_mov_b32 v80, 0
    v_mov_b32 v81, 0
    v_mov_b32 v82, 0
    v_mov_b32 v83, 0
    v_mov_b32 v84, 0
    v_mov_b32 v85, 0
    v_mov_b32 v86, 0
    v_mov_b32 v87, 0
    v_mov_b32 v88, 0
    v_mov_b32 v89, 0
    v_mov_b32 v90, 0
    v_mov_b32 v91, 0
    v_mov_b32 v92, 0
    v_mov_b32 v93, 0
    v_mov_b32 v94, 0
    v_mov_b32 v95, 0
    v_mov_b32 v96, 0
    v_mov_b32 v97, 0
    v_mov_b32 v98, 0
    v_mov_b32 v99, 0
    v_mov_b32 v100, 0
    v_mov_b32 v101, 0
    v_mov_b32 v102, 0
    v_mov_b32 v103, 0
    v_mov_b32 v104, 0
    v_mov_b32 v105, 0
    v_mov_b32 v106, 0
    v_mov_b32 v107, 0
    v_mov_b32 v108, 0
    v_mov_b32 v109, 0
    v_mov_b32 v110, 0
    v_mov_b32 v111, 0
    v_mov_b32 v112, 0
    v_mov_b32 v113, 0
    v_mov_b32 v114, 0
    v_mov_b32 v115, 0
    v_mov_b32 v116, 0
    v_mov_b32 v117, 0
    v_mov_b32 v118, 0
    v_mov_b32 v119, 0
    v_mov_b32 v120, 0
    v_mov_b32 v121, 0
    v_mov_b32 v122, 0
    v_mov_b32 v123, 0
    v_mov_b32 v124, 0
    v_mov_b32 v125, 0
    v_mov_b32 v126, 0
    v_mov_b32 v127, 0
    v_mov_b32 v128, 0
    v_mov_b32 v129, 0
    v_mov_b32 v130, 0
    v_mov_b32 v131, 0
    v_mov_b32 v132, 0
    v_mov_b32 v133, 0
    v_mov_b32 v134, 0
    v_mov_b32 v135, 0
    v_mov_b32 v136, 0
    v_mov_b32 v137, 0
    v_mov_b32 v138, 0
    v_mov_b32 v139, 0
    v_mov_b32 v140, 0
    v_mov_b32 v141, 0
    v_mov_b32 v142, 0
    v_mov_b32 v143, 0
    v_mov_b32 v144, 0
    v_mov_b32 v145, 0
    v_mov_b32 v146, 0
    v_mov_b32 v147, 0
    v_mov_b32 v148, 0
    v_mov_b32 v149, 0
    v_mov_b32 v150, 0
    v_mov_b32 v151, 0
    v_mov_b32 v152, 0
    v_mov_b32 v153, 0
    v_mov_b32 v154, 0
    v_mov_b32 v155, 0
    v_mov_b32 v156, 0
    v_mov_b32 v157, 0
    v_mov_b32 v158, 0
    v_mov_b32 v159, 0
    v_mov_b32 v160, 0
    v_mov_b32 v161, 0
    v_mov_b32 v162, 0
    v_mov_b32 v163, 0
    v_mov_b32 v164, 0
    v_mov_b32 v165, 0
    v_mov_b32 v166, 0
    v_mov_b32 v167, 0
    v_mov_b32 v168, 0
    v_mov_b32 v169, 0
    v_mov_b32 v170, 0
    v_mov_b32 v171, 0
    v_mov_b32 v172, 0
    v_mov_b32 v173, 0
    v_mov_b32 v174, 0
    v_mov_b32 v175, 0
    s_mov_b32 s48, s36
    s_mov_b32 s49, s37
    s_mov_b32 s50, 0xbc0000
    s_mov_b32 s51, 0x20000
    v_bfe_u32 v1, v0, 4, 1
    v_lshlrev_b32 v1, 10, v1
    v_lshrrev_b32 v2, 5, v0
    v_lshlrev_b32 v2, 8, v2
    v_and_b32 v3, 15, v0
    v_lshlrev_b32 v3, 4, v3
    v_add3_u32 v9, v1, v2, v3
    s_mov_b32 s52, 0
    s_mov_b32 s53, 2
    s_mov_b32 s55, 32768
    s_mov_b32 s57, 20736
    s_barrier
    ds_read_b128 v[216:219], v4 offset:0
    ds_read_b128 v[220:223], v4 offset:4096
    ds_read_b64_tr_b16 v[176:177], v8 offset:0
    ds_read_b64_tr_b16 v[178:179], v8 offset:640
    ds_read_b64_tr_b16 v[180:181], v8 offset:32
    ds_read_b64_tr_b16 v[182:183], v8 offset:672
    ds_read_b64_tr_b16 v[184:185], v8 offset:64
    ds_read_b64_tr_b16 v[186:187], v8 offset:704
    ds_read_b64_tr_b16 v[188:189], v8 offset:96
    ds_read_b64_tr_b16 v[190:191], v8 offset:736
    ds_read_b64_tr_b16 v[192:193], v8 offset:128
    ds_read_b64_tr_b16 v[194:195], v8 offset:768
Lf_loop:
    s_waitcnt lgkmcnt(8)
    s_nop 0
    v_mfma_f32_32x32x16_bf16 v[16:31], v[176:179], v[216:219], v[16:31]
    ds_read_b128 v[224:227], v5 offset:0
    ds_read_b128 v[228:231], v5 offset:4096
    v_mfma_f32_32x32x16_bf16 v[32:47], v[176:179], v[220:223], v[32:47]
    ds_read_b64_tr_b16 v[196:197], v8 offset:2560
    ds_read_b64_tr_b16 v[198:199], v8 offset:3200
    s_waitcnt lgkmcnt(10)
    s_nop 0
    v_mfma_f32_32x32x16_bf16 v[48:63], v[180:183], v[216:219], v[48:63]
    ds_read_b64_tr_b16 v[200:201], v8 offset:2592
    ds_read_b64_tr_b16 v[202:203], v8 offset:3232
    v_mfma_f32_32x32x16_bf16 v[64:79], v[180:183], v[220:223], v[64:79]
    ds_read_b64_tr_b16 v[204:205], v8 offset:2624
    s_waitcnt lgkmcnt(11)
    s_nop 0
    v_mfma_f32_32x32x16_bf16 v[80:95], v[184:187], v[216:219], v[80:95]
    ds_read_b64_tr_b16 v[206:207], v8 offset:3264
    ds_read_b64_tr_b16 v[208:209], v8 offset:2656
    v_mfma_f32_32x32x16_bf16 v[96:111], v[184:187], v[220:223], v[96:111]
    s_waitcnt lgkmcnt(11)
    s_nop 0
    v_mfma_f32_32x32x16_bf16 v[112:127], v[188:191], v[216:219], v[112:127]
    ds_read_b64_tr_b16 v[210:211], v8 offset:3296
    ds_read_b64_tr_b16 v[212:213], v8 offset:2688
    v_mfma_f32_32x32x16_bf16 v[128:143], v[188:191], v[220:223], v[128:143]
    s_waitcnt lgkmcnt(11)
    s_nop 0
    v_mfma_f32_32x32x16_bf16 v[144:159], v[192:195], v[216:219], v[144:159]
    ds_read_b64_tr_b16 v[214:215], v8 offset:3328
    v_mfma_f32_32x32x16_bf16 v[160:175], v[192:195], v[220:223], v[160:175]
    ds_read_b32 v10, v11
    s_waitcnt lgkmcnt(9)
    s_nop 0
    v_mfma_f32_32x32x16_bf16 v[16:31], v[196:199], v[224:227], v[16:31]
    ds_read_b128 v[216:219], v6 offset:0
    ds_read_b128 v[220:223], v6 offset:4096
    v_mfma_f32_32x32x16_bf16 v[32:47], v[196:199], v[228:231], v[32:47]
    ds_read_b64_tr_b16 v[176:177], v8 offset:5120
    ds_read_b64_tr_b16 v[178:179], v8 offset:5760
    s_waitcnt lgkmcnt(11)
    s_nop 0
    v_mfma_f32_32x32x16_bf16 v[48:63], v[200:203], v[224:227], v[48:63]
    ds_read_b64_tr_b16 v[180:181], v8 offset:5152
    ds_read_b64_tr_b16 v[182:183], v8 offset:5792
    v_mfma_f32_32x32x16_bf16 v[64:79], v[200:203], v[228:231], v[64:79]
    s_waitcnt lgkmcnt(11)
    s_nop 0
    v_mfma_f32_32x32x16_bf16 v[80:95], v[204:207], v[224:227], v[80:95]
    ds_read_b64_tr_b16 v[184:185], v8 offset:5184
    ds_read_b64_tr_b16 v[186:187], v8 offset:5824
    v_mfma_f32_32x32x16_bf16 v[96:111], v[204:207], v[228:231], v[96:111]
    s_waitcnt lgkmcnt(11)
    s_nop 0
    v_mfma_f32_32x32x16_bf16 v[112:127], v[208:211], v[224:227], v[112:127]
    ds_read_b64_tr_b16 v[188:189], v8 offset:5216
    ds_read_b64_tr_b16 v[190:191], v8 offset:5856
    v_mfma_f32_32x32x16_bf16 v[128:143], v[208:211], v[228:231], v[128:143]
    s_waitcnt lgkmcnt(11)
    s_nop 0
    v_mfma_f32_32x32x16_bf16 v[144:159], v[212:215], v[224:227], v[144:159]
    ds_read_b64_tr_b16 v[192:193], v8 offset:5248
    ds_read_b64_tr_b16 v[194:195], v8 offset:5888
    v_mfma_f32_32x32x16_bf16 v[160:175], v[212:215], v[228:231], v[160:175]
    s_waitcnt lgkmcnt(8)
    s_nop 0
    v_mfma_f32_32x32x16_bf16 v[16:31], v[176:179], v[216:219], v[16:31]
    ds_read_b128 v[224:227], v7 offset:0
    ds_read_b128 v[228:231], v7 offset:4096
    v_mfma_f32_32x32x16_bf16 v[32:47], v[176:179], v[220:223], v[32:47]
    ds_read_b64_tr_b16 v[196:197], v8 offset:7680
    ds_read_b64_tr_b16 v[198:199], v8 offset:8320
    s_waitcnt lgkmcnt(10)
    s_nop 0
    v_mfma_f32_32x32x16_bf16 v[48:63], v[180:183], v[216:219], v[48:63]
    ds_read_b64_tr_b16 v[200:201], v8 offset:7712
    ds_read_b64_tr_b16 v[202:203], v8 offset:8352
    v_mfma_f32_32x32x16_bf16 v[64:79], v[180:183], v[220:223], v[64:79]
    ds_read_b64_tr_b16 v[204:205], v8 offset:7744
    s_waitcnt lgkmcnt(11)
    s_nop 0
    v_mfma_f32_32x32x16_bf16 v[80:95], v[184:187], v[216:219], v[80:95]
    ds_read_b64_tr_b16 v[206:207], v8 offset:8384
    ds_read_b64_tr_b16 v[208:209], v8 offset:7776
    v_mfma_f32_32x32x16_bf16 v[96:111], v[184:187], v[220:223], v[96:111]
    s_waitcnt lgkmcnt(11)
    s_nop 0
    v_mfma_f32_32x32x16_bf16 v[112:127], v[188:191], v[216:219], v[112:127]
    ds_read_b64_tr_b16 v[210:211], v8 offset:8416
    ds_read_b64_tr_b16 v[212:213], v8 offset:7808
    v_mfma_f32_32x32x16_bf16 v[128:143], v[188:191], v[220:223], v[128:143]
    s_waitcnt lgkmcnt(11)
    s_nop 0
    v_mfma_f32_32x32x16_bf16 v[144:159], v[192:195], v[216:219], v[144:159]
    ds_read_b64_tr_b16 v[214:215], v8 offset:8448
    v_mfma_f32_32x32x16_bf16 v[160:175], v[192:195], v[220:223], v[160:175]
    s_waitcnt lgkmcnt(8)
    v_mfma_f32_32x32x16_bf16 v[16:31], v[196:199], v[224:227], v[16:31]
    s_add_u32 s52, s52, 1
    s_add_u32 s53, s53, 1
    s_cmp_eq_u32 s53, 3
    s_cselect_b32 s54, 0xffff0000, s55
    s_cselect_b32 s56, 0xffff5e00, s57
    s_cselect_b32 s53, 0, s53
    v_mfma_f32_32x32x16_bf16 v[32:47], v[196:199], v[228:231], v[32:47]
    v_add_u32 v4, s54, v4
    v_add_u32 v5, s54, v5
    v_add_u32 v6, s54, v6
    s_waitcnt lgkmcnt(6)
    v_mfma_f32_32x32x16_bf16 v[48:63], v[200:203], v[224:227], v[48:63]
    v_add_u32 v7, s54, v7
    v_add_u32_e64 v8, s56, v8
    s_waitcnt lgkmcnt(0)
    s_barrier
    ds_read_b128 v[216:219], v4 offset:0
    ds_read_b128 v[220:223], v4 offset:4096
    v_mfma_f32_32x32x16_bf16 v[64:79], v[200:203], v[228:231], v[64:79]
    ds_read_b64_tr_b16 v[176:177], v8 offset:0
    ds_read_b64_tr_b16 v[178:179], v8 offset:640
    v_mfma_f32_32x32x16_bf16 v[80:95], v[204:207], v[224:227], v[80:95]
    ds_read_b64_tr_b16 v[180:181], v8 offset:32
    ds_read_b64_tr_b16 v[182:183], v8 offset:672
    v_mfma_f32_32x32x16_bf16 v[96:111], v[204:207], v[228:231], v[96:111]
    ds_read_b64_tr_b16 v[184:185], v8 offset:64
    ds_read_b64_tr_b16 v[186:187], v8 offset:704
    v_mfma_f32_32x32x16_bf16 v[112:127], v[208:211], v[224:227], v[112:127]
    ds_read_b64_tr_b16 v[188:189], v8 offset:96
    ds_read_b64_tr_b16 v[190:191], v8 offset:736
    v_mfma_f32_32x32x16_bf16 v[128:143], v[208:211], v[228:231], v[128:143]
    ds_read_b64_tr_b16 v[192:193], v8 offset:128
    ds_read_b64_tr_b16 v[194:195], v8 offset:768
    v_mfma_f32_32x32x16_bf16 v[144:159], v[212:215], v[224:227], v[144:159]
    v_mfma_f32_32x32x16_bf16 v[160:175], v[212:215], v[228:231], v[160:175]
    s_cmp_lt_u32 s52, 8
    s_cbranch_scc1 Lf_loop
    s_waitcnt lgkmcnt(8)
    s_nop 0
    v_mfma_f32_32x32x16_bf16 v[16:31], v[176:179], v[216:219], v[16:31]
    ds_read_b128 v[224:227], v5 offset:0
    ds_read_b128 v[228:231], v5 offset:4096
    v_readfirstlane_b32 s64, v10
    s_nop 0
    s_mov_b32 s56, 0xbfb8aa3b
    v_mfma_f32_32x32x16_bf16 v[32:47], v[176:179], v[220:223], v[32:47]
    ds_read_b64_tr_b16 v[196:197], v8 offset:2560
    ds_read_b64_tr_b16 v[198:199], v8 offset:3200
    s_mov_b32 s57, 0xbfb8aa3b
    s_mul_i32 s58, s40, 5
    s_waitcnt lgkmcnt(10)
    v_mfma_f32_32x32x16_bf16 v[48:63], v[180:183], v[216:219], v[48:63]
    ds_read_b64_tr_b16 v[200:201], v8 offset:2592
    ds_read_b64_tr_b16 v[202:203], v8 offset:3232
    s_lshl_b32 s59, s39, 2
    s_add_u32 s59, s59, s38
    v_mfma_f32_32x32x16_bf16 v[64:79], v[180:183], v[220:223], v[64:79]
    s_mul_i32 s59, s59, 385024
    s_add_u32 s59, s59, 163840
    s_waitcnt lgkmcnt(10)
    s_nop 0
    v_mfma_f32_32x32x16_bf16 v[80:95], v[184:187], v[216:219], v[80:95]
    ds_read_b128 v[204:207], v6 offset:0
    ds_read_b128 v[208:211], v6 offset:4096
    s_add_u32 s60, s58, 0
    s_lshr_b32 s61, s60, 1
    v_mfma_f32_32x32x16_bf16 v[96:111], v[184:187], v[220:223], v[96:111]
    s_lshl_b32 s61, s61, 12
    s_and_b32 s60, s60, 1
    s_waitcnt lgkmcnt(10)
    s_nop 0
    v_mfma_f32_32x32x16_bf16 v[112:127], v[188:191], v[216:219], v[112:127]
    ds_read_b64_tr_b16 v[212:213], v8 offset:5120
    ds_read_b64_tr_b16 v[214:215], v8 offset:5760
    s_lshl_b32 s60, s60, 9
    s_add_u32 s61, s61, s60
    v_mfma_f32_32x32x16_bf16 v[128:143], v[188:191], v[220:223], v[128:143]
    s_add_u32 s68, s61, s59
    s_add_u32 s60, s58, 1
    s_waitcnt lgkmcnt(10)
    s_nop 0
    v_mfma_f32_32x32x16_bf16 v[144:159], v[192:195], v[216:219], v[144:159]
    ds_read_b64_tr_b16 v[232:233], v8 offset:5152
    ds_read_b64_tr_b16 v[234:235], v8 offset:5792
    s_lshr_b32 s61, s60, 1
    s_lshl_b32 s61, s61, 12
    v_mfma_f32_32x32x16_bf16 v[160:175], v[192:195], v[220:223], v[160:175]
    s_and_b32 s60, s60, 1
    s_lshl_b32 s60, s60, 9
    s_waitcnt lgkmcnt(8)
    s_nop 0
    v_mfma_f32_32x32x16_bf16 v[16:31], v[196:199], v[224:227], v[16:31]
    ds_read_b128 v[236:239], v7 offset:0
    ds_read_b128 v[240:243], v7 offset:4096
    s_add_u32 s61, s61, s60
    s_add_u32 s69, s61, s59
    v_mfma_f32_32x32x16_bf16 v[32:47], v[196:199], v[228:231], v[32:47]
    ds_read_b64_tr_b16 v[244:245], v8 offset:7680
    ds_read_b64_tr_b16 v[246:247], v8 offset:8320
    s_add_u32 s60, s58, 2
    s_lshr_b32 s61, s60, 1
    s_waitcnt lgkmcnt(10)
    s_nop 0
    v_mfma_f32_32x32x16_bf16 v[48:63], v[200:203], v[224:227], v[48:63]
    ds_read_b64_tr_b16 v[248:249], v8 offset:7712
    ds_read_b64_tr_b16 v[250:251], v8 offset:8352
    s_lshl_b32 s61, s61, 12
    s_and_b32 s60, s60, 1
    v_mfma_f32_32x32x16_bf16 v[64:79], v[200:203], v[228:231], v[64:79]
    s_lshl_b32 s60, s60, 9
    s_add_u32 s61, s61, s60
    s_waitcnt lgkmcnt(8)
    v_mfma_f32_32x32x16_bf16 v[16:31], v[212:215], v[204:207], v[16:31]
    s_add_u32 s70, s61, s59
    v_mfma_f32_32x32x16_bf16 v[32:47], v[212:215], v[208:211], v[32:47]
    s_add_u32 s60, s58, 3
    s_waitcnt lgkmcnt(6)
    v_mfma_f32_32x32x16_bf16 v[48:63], v[232:235], v[204:207], v[48:63]
    s_lshr_b32 s61, s60, 1
    v_mfma_f32_32x32x16_bf16 v[64:79], v[232:235], v[208:211], v[64:79]
    s_lshl_b32 s61, s61, 12
    s_waitcnt lgkmcnt(2)
    v_mfma_f32_32x32x16_bf16 v[16:31], v[244:247], v[236:239], v[16:31]
    s_barrier
    ds_read_b128 v[176:179], v4 offset:32768
    ds_read_b128 v[180:183], v4 offset:36864
    s_and_b32 s60, s60, 1
    s_nop 0
    v_mfma_f32_32x32x16_bf16 v[32:47], v[244:247], v[240:243], v[32:47]
    ds_read_b64_tr_b16 v[184:185], v8 offset:20736
    ds_read_b64_tr_b16 v[186:187], v8 offset:21376
    ds_read_b128 v[188:191], v5 offset:32768
    s_lshl_b32 s60, s60, 9
    s_waitcnt lgkmcnt(5)
    v_mfma_f32_32x32x16_bf16 v[48:63], v[248:251], v[236:239], v[48:63]
    ds_read_b128 v[216:219], v5 offset:36864
    ds_read_b64_tr_b16 v[220:221], v8 offset:23296
    ds_read_b64_tr_b16 v[222:223], v8 offset:23936
    s_add_u32 s61, s61, s60
    s_nop 0
    v_mfma_f32_32x32x16_bf16 v[64:79], v[248:251], v[240:243], v[64:79]
    ds_read_b128 v[192:195], v6 offset:32768
    ds_read_b128 v[196:199], v6 offset:36864
    s_add_u32 s71, s61, s59
    s_waitcnt lgkmcnt(6)
    v_mfma_f32_32x32x16_bf16 v[16:31], v[184:187], v[176:179], v[16:31]
    ds_read_b64_tr_b16 v[200:201], v8 offset:25856
    ds_read_b64_tr_b16 v[202:203], v8 offset:26496
    ds_read_b128 v[212:215], v7 offset:32768
    s_add_u32 s60, s58, 4
    s_nop 0
    v_mfma_f32_32x32x16_bf16 v[32:47], v[184:187], v[180:183], v[32:47]
    ds_read_b128 v[232:235], v7 offset:36864
    ds_read_b64_tr_b16 v[244:245], v8 offset:28416
    ds_read_b64_tr_b16 v[246:247], v8 offset:29056
    s_lshr_b32 s61, s60, 1
    s_setprio 3
    s_waitcnt lgkmcnt(8)
    s_nop 0
    v_mfma_f32_32x32x16_bf16 v[16:31], v[220:223], v[188:191], v[16:31]
    ds_read_b64_tr_b16 v[248:249], v8 offset:20768
    ds_read_b64_tr_b16 v[250:251], v8 offset:21408
    ds_read_b64_tr_b16 v[184:185], v8 offset:23328
    ds_read_b64_tr_b16 v[186:187], v8 offset:23968
    s_lshl_b32 s61, s61, 12
    v_mfma_f32_32x32x16_bf16 v[32:47], v[220:223], v[216:219], v[32:47]
    s_and_b32 s60, s60, 1
    s_waitcnt lgkmcnt(8)
    s_nop 0
    v_mfma_f32_32x32x16_bf16 v[16:31], v[200:203], v[192:195], v[16:31]
    ds_read_b64_tr_b16 v[220:221], v8 offset:25888
    ds_read_b64_tr_b16 v[222:223], v8 offset:26528
    s_lshl_b32 s60, s60, 9
    s_nop 0
    v_mfma_f32_32x32x16_bf16 v[32:47], v[200:203], v[196:199], v[32:47]
    ds_read_b64_tr_b16 v[200:201], v8 offset:28448
    ds_read_b64_tr_b16 v[202:203], v8 offset:29088
    s_add_u32 s61, s61, s60
    s_waitcnt lgkmcnt(8)
    v_mfma_f32_32x32x16_bf16 v[16:31], v[244:247], v[212:215], v[16:31]
    s_add_u32 s72, s61, s59
    s_nop 0
    v_mfma_f32_32x32x16_bf16 v[32:47], v[244:247], v[232:235], v[32:47]
    ds_read_b64_tr_b16 v[244:245], v8 offset:2624
    ds_read_b64_tr_b16 v[246:247], v8 offset:3264
    s_cmp_eq_u32 s40, 21
    s_cselect_b32 s71, 0x40000000, s71
    s_cselect_b32 s72, 0x40000000, s72
    s_waitcnt lgkmcnt(8)
    v_mfma_f32_32x32x16_bf16 v[48:63], v[248:251], v[176:179], v[48:63]
    v_mfma_f32_32x32x16_bf16 v[64:79], v[248:251], v[180:183], v[64:79]
    ds_read_b64_tr_b16 v[248:249], v8 offset:5184
    ds_read_b64_tr_b16 v[250:251], v8 offset:5824
    s_waitcnt lgkmcnt(8)
    s_nop 0
    v_mfma_f32_32x32x16_bf16 v[48:63], v[184:187], v[188:191], v[48:63]
    v_mfma_f32_32x32x16_bf16 v[64:79], v[184:187], v[216:219], v[64:79]
    ds_read_b64_tr_b16 v[184:185], v8 offset:7744
    ds_read_b64_tr_b16 v[186:187], v8 offset:8384
    s_waitcnt lgkmcnt(8)
    s_nop 0
    v_mfma_f32_32x32x16_bf16 v[48:63], v[220:223], v[192:195], v[48:63]
    v_mfma_f32_32x32x16_bf16 v[64:79], v[220:223], v[196:199], v[64:79]
    ds_read_b64_tr_b16 v[220:221], v8 offset:20800
    ds_read_b64_tr_b16 v[222:223], v8 offset:21440
    v_mul_f32 v24, v16, v24
    v_mul_f32 v25, v17, v25
    v_mul_f32 v26, v18, v26
    v_mul_f32 v27, v19, v27
    v_mul_f32 v28, v20, v28
    v_mul_f32 v29, v21, v29
    v_mul_f32 v30, v22, v30
    v_mul_f32 v31, v23, v31
    v_mul_f32 v16, s56, v16
    v_mul_f32 v17, s56, v17
    s_waitcnt lgkmcnt(8)
    v_mfma_f32_32x32x16_bf16 v[48:63], v[200:203], v[212:215], v[48:63]
    s_barrier
    v_mul_f32 v18, s56, v18
    v_mul_f32 v19, s56, v19
    v_mul_f32 v20, s56, v20
    v_mul_f32 v21, s56, v21
    v_mul_f32 v22, s56, v22
    v_mul_f32 v23, s56, v23
    v_exp_f32 v16, v16
    v_exp_f32 v17, v17
    v_exp_f32 v18, v18
    v_exp_f32 v19, v19
    v_mfma_f32_32x32x16_bf16 v[64:79], v[200:203], v[232:235], v[64:79]
    ds_read_b64_tr_b16 v[200:201], v8 offset:23360
    ds_read_b64_tr_b16 v[202:203], v8 offset:24000
    v_exp_f32 v20, v20
    v_exp_f32 v21, v21
    v_exp_f32 v22, v22
    v_exp_f32 v23, v23
    v_add_f32 v16, 1.0, v16
    v_add_f32 v17, 1.0, v17
    v_add_f32 v18, 1.0, v18
    v_add_f32 v19, 1.0, v19
    v_add_f32 v20, 1.0, v20
    v_add_f32 v21, 1.0, v21
    s_waitcnt lgkmcnt(8)
    v_mfma_f32_32x32x16_bf16 v[80:95], v[244:247], v[224:227], v[80:95]
    v_add_f32 v22, 1.0, v22
    v_add_f32 v23, 1.0, v23
    v_rcp_f32 v16, v16
    v_rcp_f32 v17, v17
    v_rcp_f32 v18, v18
    v_rcp_f32_e64 v19, v19
    v_mfma_f32_32x32x16_bf16 v[96:111], v[244:247], v[228:231], v[96:111]
    ds_read_b64_tr_b16 v[244:245], v8 offset:25920
    ds_read_b64_tr_b16 v[246:247], v8 offset:26560
    v_rcp_f32 v20, v20
    v_rcp_f32 v21, v21
    v_rcp_f32 v22, v22
    v_rcp_f32 v23, v23
    v_mul_f32 v24, v24, v16
    v_mul_f32 v25, v25, v17
    s_waitcnt lgkmcnt(8)
    v_mfma_f32_32x32x16_bf16 v[80:95], v[248:251], v[204:207], v[80:95]
    v_mul_f32 v26, v26, v18
    v_mul_f32 v27, v27, v19
    v_mul_f32 v28, v28, v20
    v_mul_f32 v29, v29, v21
    v_mul_f32 v30, v30, v22
    v_mul_f32_e64 v31, v31, v23
    v_mfma_f32_32x32x16_bf16 v[96:111], v[248:251], v[208:211], v[96:111]
    ds_read_b64_tr_b16 v[248:249], v8 offset:28480
    ds_read_b64_tr_b16 v[250:251], v8 offset:29120
    v_cvt_pk_bf16_f32 v16, v24, v25
    v_cvt_pk_bf16_f32 v17, v26, v27
    v_cvt_pk_bf16_f32 v18, v28, v29
    v_cvt_pk_bf16_f32 v19, v30, v31
    buffer_store_dwordx4 v[16:19], v9, s[48:51], s68 offen offset:0 sc1
    v_mul_f32 v40, v32, v40
    s_waitcnt lgkmcnt(8)
    v_mfma_f32_32x32x16_bf16 v[80:95], v[184:187], v[236:239], v[80:95]
    v_mul_f32 v41, v33, v41
    v_mul_f32 v42, v34, v42
    v_mul_f32 v43, v35, v43
    v_mul_f32 v44, v36, v44
    v_mul_f32 v45, v37, v45
    v_mul_f32 v46, v38, v46
    v_mfma_f32_32x32x16_bf16 v[96:111], v[184:187], v[240:243], v[96:111]
    ds_read_b64_tr_b16 v[184:185], v8 offset:2656
    ds_read_b64_tr_b16 v[186:187], v8 offset:3296
    v_mul_f32 v47, v39, v47
    v_mul_f32 v32, s56, v32
    v_mul_f32 v33, s56, v33
    v_mul_f32 v34, s56, v34
    v_mul_f32 v35, s56, v35
    v_mul_f32 v36, s56, v36
    s_waitcnt lgkmcnt(8)
    v_mfma_f32_32x32x16_bf16 v[80:95], v[220:223], v[176:179], v[80:95]
    v_mul_f32 v37, s56, v37
    v_mul_f32 v38, s56, v38
    v_mul_f32 v39, s56, v39
    v_exp_f32 v32, v32
    v_exp_f32 v33, v33
    v_mfma_f32_32x32x16_bf16 v[96:111], v[220:223], v[180:183], v[96:111]
    ds_read_b64_tr_b16 v[220:221], v8 offset:5216
    ds_read_b64_tr_b16 v[222:223], v8 offset:5856
    v_exp_f32 v34, v34
    v_exp_f32 v35, v35
    v_exp_f32 v36, v36
    v_exp_f32 v37, v37
    v_exp_f32 v38, v38
    s_waitcnt lgkmcnt(8)
    v_mfma_f32_32x32x16_bf16 v[80:95], v[200:203], v[188:191], v[80:95]
    v_exp_f32 v39, v39
    v_add_f32 v32, 1.0, v32
    v_add_f32 v33, 1.0, v33
    v_add_f32 v34, 1.0, v34
    v_add_f32_e64 v35, 1.0, v35
    v_mfma_f32_32x32x16_bf16 v[96:111], v[200:203], v[216:219], v[96:111]
    ds_read_b64_tr_b16 v[200:201], v8 offset:7776
    ds_read_b64_tr_b16 v[202:203], v8 offset:8416
    v_add_f32 v36, 1.0, v36
    v_add_f32 v37, 1.0, v37
    v_add_f32 v38, 1.0, v38
    v_add_f32 v39, 1.0, v39
    v_rcp_f32 v32, v32
    s_waitcnt lgkmcnt(8)
    v_mfma_f32_32x32x16_bf16 v[80:95], v[244:247], v[192:195], v[80:95]
    v_rcp_f32 v33, v33
    v_rcp_f32 v34, v34
    v_rcp_f32 v35, v35
    v_rcp_f32 v36, v36
    v_rcp_f32_e64 v37, v37
    v_mfma_f32_32x32x16_bf16 v[96:111], v[244:247], v[196:199], v[96:111]
    ds_read_b64_tr_b16 v[244:245], v8 offset:20832
    ds_read_b64_tr_b16 v[246:247], v8 offset:21472
    v_rcp_f32 v38, v38
    v_rcp_f32 v39, v39
    v_mul_f32 v40, v40, v32
    v_mul_f32 v41, v41, v33
    v_mul_f32 v42, v42, v34
    s_waitcnt lgkmcnt(8)
    v_mfma_f32_32x32x16_bf16 v[80:95], v[248:251], v[212:215], v[80:95]
    v_mul_f32 v43, v43, v35
    v_mul_f32 v44, v44, v36
    v_mul_f32 v45, v45, v37
    v_mul_f32 v46, v46, v38
    v_mul_f32_e64 v47, v47, v39
    v_mfma_f32_32x32x16_bf16 v[96:111], v[248:251], v[232:235], v[96:111]
    ds_read_b64_tr_b16 v[248:249], v8 offset:23392
    ds_read_b64_tr_b16 v[250:251], v8 offset:24032
    v_cvt_pk_bf16_f32 v32, v40, v41
    v_cvt_pk_bf16_f32 v33, v42, v43
    v_cvt_pk_bf16_f32 v34, v44, v45
    v_cvt_pk_bf16_f32 v35, v46, v47
    buffer_store_dwordx4 v[32:35], v9, s[48:51], s68 offen offset:2048 sc1
    s_waitcnt lgkmcnt(8)
    v_mfma_f32_32x32x16_bf16 v[112:127], v[184:187], v[224:227], v[112:127]
    v_mul_f32 v56, v48, v56
    v_mul_f32 v57, v49, v57
    v_mul_f32 v58, v50, v58
    v_mul_f32 v59, v51, v59
    v_mul_f32 v60, v52, v60
    v_mul_f32 v61, v53, v61
    v_mul_f32 v62, v54, v62
    v_mul_f32_e64 v63, v55, v63
    v_mfma_f32_32x32x16_bf16 v[128:143], v[184:187], v[228:231], v[128:143]
    ds_read_b64_tr_b16 v[184:185], v8 offset:25952
    ds_read_b64_tr_b16 v[186:187], v8 offset:26592
    v_mul_f32 v48, s56, v48
    v_mul_f32 v49, s56, v49
    v_mul_f32 v50, s56, v50
    v_mul_f32 v51, s56, v51
    v_mul_f32 v52, s56, v52
    v_mul_f32 v53, s56, v53
    v_mul_f32 v54, s56, v54
    v_mul_f32 v55, s56, v55
    s_waitcnt lgkmcnt(8)
    v_mfma_f32_32x32x16_bf16 v[112:127], v[220:223], v[204:207], v[112:127]
    v_exp_f32 v48, v48
    v_exp_f32 v49, v49
    v_exp_f32 v50, v50
    v_exp_f32 v51, v51
    v_exp_f32 v52, v52
    v_exp_f32 v53, v53
    v_exp_f32 v54, v54
    v_exp_f32_e64 v55, v55
    v_mfma_f32_32x32x16_bf16 v[128:143], v[220:223], v[208:211], v[128:143]
    ds_read_b64_tr_b16 v[220:221], v8 offset:28512
    ds_read_b64_tr_b16 v[222:223], v8 offset:29152
    v_add_f32 v48, 1.0, v48
    v_add_f32 v49, 1.0, v49
    v_add_f32 v50, 1.0, v50
    v_add_f32 v51, 1.0, v51
    v_add_f32 v52, 1.0, v52
    v_add_f32 v53, 1.0, v53
    v_add_f32 v54, 1.0, v54
    v_add_f32 v55, 1.0, v55
    s_waitcnt lgkmcnt(8)
    v_mfma_f32_32x32x16_bf16 v[112:127], v[200:203], v[236:239], v[112:127]
    v_rcp_f32 v48, v48
    v_rcp_f32 v49, v49
    v_rcp_f32 v50, v50
    v_rcp_f32 v51, v51
    v_rcp_f32 v52, v52
    v_rcp_f32 v53, v53
    v_rcp_f32 v54, v54
    v_rcp_f32_e64 v55, v55
    v_mfma_f32_32x32x16_bf16 v[128:143], v[200:203], v[240:243], v[128:143]
    ds_read_b64_tr_b16 v[200:201], v8 offset:2688
    ds_read_b64_tr_b16 v[202:203], v8 offset:3328
    v_mul_f32 v56, v56, v48
    v_mul_f32 v57, v57, v49
    v_mul_f32 v58, v58, v50
    v_mul_f32 v59, v59, v51
    v_mul_f32 v60, v60, v52
    v_mul_f32 v61, v61, v53
    v_mul_f32 v62, v62, v54
    v_mul_f32_e64 v63, v63, v55
    s_waitcnt lgkmcnt(8)
    v_mfma_f32_32x32x16_bf16 v[112:127], v[244:247], v[176:179], v[112:127]
    v_cvt_pk_bf16_f32 v48, v56, v57
    v_cvt_pk_bf16_f32 v49, v58, v59
    v_cvt_pk_bf16_f32 v50, v60, v61
    v_cvt_pk_bf16_f32 v51, v62, v63
    buffer_store_dwordx4 v[48:51], v9, s[48:51], s69 offen offset:0 sc1
    v_mul_f32 v72, v64, v72
    v_mul_f32 v73, v65, v73
    v_mul_f32_e64 v74, v66, v74
    v_mfma_f32_32x32x16_bf16 v[128:143], v[244:247], v[180:183], v[128:143]
    ds_read_b64_tr_b16 v[244:245], v8 offset:5248
    ds_read_b64_tr_b16 v[246:247], v8 offset:5888
    v_mul_f32 v75, v67, v75
    v_mul_f32 v76, v68, v76
    v_mul_f32 v77, v69, v77
    v_mul_f32 v78, v70, v78
    v_mul_f32 v79, v71, v79
    v_mul_f32 v64, s56, v64
    v_mul_f32 v65, s56, v65
    v_mul_f32 v66, s56, v66
    s_waitcnt lgkmcnt(8)
    v_mfma_f32_32x32x16_bf16 v[112:127], v[248:251], v[188:191], v[112:127]
    v_mul_f32 v67, s56, v67
    v_mul_f32 v68, s56, v68
    v_mul_f32 v69, s56, v69
    v_mul_f32 v70, s56, v70
    v_mul_f32 v71, s56, v71
    v_exp_f32 v64, v64
    v_exp_f32 v65, v65
    v_mfma_f32_32x32x16_bf16 v[128:143], v[248:251], v[216:219], v[128:143]
    ds_read_b64_tr_b16 v[248:249], v8 offset:7808
    ds_read_b64_tr_b16 v[250:251], v8 offset:8448
    v_exp_f32 v66, v66
    v_exp_f32 v67, v67
    v_exp_f32 v68, v68
    v_exp_f32 v69, v69
    v_exp_f32 v70, v70
    v_exp_f32 v71, v71
    v_add_f32 v64, 1.0, v64
    s_waitcnt lgkmcnt(8)
    v_mfma_f32_32x32x16_bf16 v[112:127], v[184:187], v[192:195], v[112:127]
    v_add_f32 v65, 1.0, v65
    v_add_f32 v66, 1.0, v66
    v_add_f32 v67, 1.0, v67
    v_add_f32 v68, 1.0, v68
    v_add_f32 v69, 1.0, v69
    v_add_f32 v70, 1.0, v70
    v_add_f32_e64 v71, 1.0, v71
    v_mfma_f32_32x32x16_bf16 v[128:143], v[184:187], v[196:199], v[128:143]
    ds_read_b64_tr_b16 v[184:185], v8 offset:20864
    ds_read_b64_tr_b16 v[186:187], v8 offset:21504
    v_rcp_f32 v64, v64
    v_rcp_f32 v65, v65
    v_rcp_f32 v66, v66
    v_rcp_f32 v67, v67
    v_rcp_f32 v68, v68
    v_rcp_f32 v69, v69
    v_rcp_f32 v70, v70
    s_waitcnt lgkmcnt(8)
    v_mfma_f32_32x32x16_bf16 v[112:127], v[220:223], v[212:215], v[112:127]
    v_rcp_f32 v71, v71
    v_mul_f32 v72, v72, v64
    v_mul_f32 v73, v73, v65
    v_mul_f32 v74, v74, v66
    v_mul_f32 v75, v75, v67
    v_mul_f32 v76, v76, v68
    v_mul_f32_e64 v77, v77, v69
    v_mfma_f32_32x32x16_bf16 v[128:143], v[220:223], v[232:235], v[128:143]
    ds_read_b64_tr_b16 v[220:221], v8 offset:23424
    ds_read_b64_tr_b16 v[222:223], v8 offset:24064
    v_mul_f32 v78, v78, v70
    v_mul_f32 v79, v79, v71
    v_cvt_pk_bf16_f32 v64, v72, v73
    v_cvt_pk_bf16_f32 v65, v74, v75
    v_cvt_pk_bf16_f32 v66, v76, v77
    v_cvt_pk_bf16_f32 v67, v78, v79
    buffer_store_dwordx4 v[64:67], v9, s[48:51], s69 offen offset:2048 sc1
    s_waitcnt lgkmcnt(8)
    s_nop 0
    v_mfma_f32_32x32x16_bf16 v[144:159], v[200:203], v[224:227], v[144:159]
    ds_read_b64_tr_b16 v[224:225], v8 offset:25984
    ds_read_b64_tr_b16 v[226:227], v8 offset:26624
    v_mul_f32 v88, v80, v88
    v_mul_f32 v89, v81, v89
    v_mul_f32 v90, v82, v90
    v_mul_f32 v91, v83, v91
    v_mul_f32 v92, v84, v92
    v_mul_f32 v93, v85, v93
    v_mul_f32 v94, v86, v94
    v_mul_f32 v95, v87, v95
    v_mfma_f32_32x32x16_bf16 v[160:175], v[200:203], v[228:231], v[160:175]
    ds_read_b64_tr_b16 v[228:229], v8 offset:28544
    ds_read_b64_tr_b16 v[230:231], v8 offset:29184
    v_mul_f32 v80, s56, v80
    v_mul_f32 v81, s56, v81
    v_mul_f32 v82, s56, v82
    v_mul_f32 v83, s56, v83
    v_mul_f32 v84, s56, v84
    v_mul_f32 v85, s56, v85
    v_mul_f32 v86, s56, v86
    v_mul_f32 v87, s56, v87
    s_waitcnt lgkmcnt(10)
    v_mfma_f32_32x32x16_bf16 v[144:159], v[244:247], v[204:207], v[144:159]
    v_exp_f32 v80, v80
    v_exp_f32 v81, v81
    v_exp_f32 v82, v82
    v_exp_f32 v83, v83
    v_exp_f32 v84, v84
    v_exp_f32 v85, v85
    v_exp_f32 v86, v86
    v_exp_f32 v87, v87
    v_mfma_f32_32x32x16_bf16 v[160:175], v[244:247], v[208:211], v[160:175]
    v_add_f32 v80, 1.0, v80
    v_add_f32 v81, 1.0, v81
    v_add_f32 v82, 1.0, v82
    v_add_f32 v83, 1.0, v83
    v_add_f32 v84, 1.0, v84
    v_add_f32 v85, 1.0, v85
    v_add_f32 v86, 1.0, v86
    v_add_f32 v87, 1.0, v87
    s_waitcnt lgkmcnt(8)
    v_mfma_f32_32x32x16_bf16 v[144:159], v[248:251], v[236:239], v[144:159]
    v_rcp_f32 v80, v80
    v_rcp_f32 v81, v81
    v_rcp_f32 v82, v82
    v_rcp_f32 v83, v83
    v_rcp_f32 v84, v84
    v_rcp_f32 v85, v85
    v_rcp_f32 v86, v86
    v_rcp_f32 v87, v87
    v_mfma_f32_32x32x16_bf16 v[160:175], v[248:251], v[240:243], v[160:175]
    v_mul_f32 v88, v88, v80
    v_mul_f32 v89, v89, v81
    v_mul_f32 v90, v90, v82
    v_mul_f32 v91, v91, v83
    v_mul_f32 v92, v92, v84
    v_mul_f32 v93, v93, v85
    v_mul_f32 v94, v94, v86
    v_mul_f32_e64 v95, v95, v87
    s_waitcnt lgkmcnt(6)
    v_mfma_f32_32x32x16_bf16 v[144:159], v[184:187], v[176:179], v[144:159]
    v_cvt_pk_bf16_f32 v80, v88, v89
    v_cvt_pk_bf16_f32 v81, v90, v91
    v_cvt_pk_bf16_f32 v82, v92, v93
    v_cvt_pk_bf16_f32 v83, v94, v95
    buffer_store_dwordx4 v[80:83], v9, s[48:51], s70 offen offset:0 sc1
    v_mul_f32 v104, v96, v104
    v_mul_f32 v105, v97, v105
    v_mul_f32 v106, v98, v106
    v_mfma_f32_32x32x16_bf16 v[160:175], v[184:187], v[180:183], v[160:175]
    v_mul_f32 v107, v99, v107
    v_mul_f32 v108, v100, v108
    v_mul_f32 v109, v101, v109
    v_mul_f32 v110, v102, v110
    v_mul_f32 v111, v103, v111
    v_mul_f32 v96, s56, v96
    v_mul_f32 v97, s56, v97
    v_mul_f32 v98, s56, v98
    s_waitcnt lgkmcnt(4)
    v_mfma_f32_32x32x16_bf16 v[144:159], v[220:223], v[188:191], v[144:159]
    v_mul_f32 v99, s56, v99
    v_mul_f32 v100, s56, v100
    v_mul_f32 v101, s56, v101
    v_mul_f32 v102, s56, v102
    v_mul_f32 v103, s56, v103
    v_exp_f32 v96, v96
    v_exp_f32 v97, v97
    v_mfma_f32_32x32x16_bf16 v[160:175], v[220:223], v[216:219], v[160:175]
    v_exp_f32 v98, v98
    v_exp_f32 v99, v99
    v_exp_f32 v100, v100
    v_exp_f32 v101, v101
    v_exp_f32 v102, v102
    v_exp_f32 v103, v103
    v_add_f32 v96, 1.0, v96
    s_waitcnt lgkmcnt(2)
    v_mfma_f32_32x32x16_bf16 v[144:159], v[224:227], v[192:195], v[144:159]
    v_add_f32 v97, 1.0, v97
    v_add_f32 v98, 1.0, v98
    v_add_f32 v99, 1.0, v99
    v_add_f32 v100, 1.0, v100
    v_add_f32 v101, 1.0, v101
    v_add_f32 v102, 1.0, v102
    v_add_f32 v103, 1.0, v103
    v_mfma_f32_32x32x16_bf16 v[160:175], v[224:227], v[196:199], v[160:175]
    v_rcp_f32 v96, v96
    v_rcp_f32 v97, v97
    v_rcp_f32 v98, v98
    v_rcp_f32 v99, v99
    v_rcp_f32 v100, v100
    v_rcp_f32 v101, v101
    v_rcp_f32 v102, v102
    s_waitcnt lgkmcnt(0)
    v_mfma_f32_32x32x16_bf16 v[144:159], v[228:231], v[212:215], v[144:159]
    s_barrier
    v_rcp_f32 v103, v103
    v_mul_f32 v104, v104, v96
    v_mul_f32 v105, v105, v97
    v_mul_f32 v106, v106, v98
    v_mul_f32 v107, v107, v99
    v_mul_f32 v108, v108, v100
    v_mul_f32 v109, v109, v101
    v_mfma_f32_32x32x16_bf16 v[160:175], v[228:231], v[232:235], v[160:175]
    v_mul_f32 v110, v110, v102
    v_mul_f32 v111, v111, v103
    v_cvt_pk_bf16_f32 v96, v104, v105
    v_cvt_pk_bf16_f32 v97, v106, v107
    v_cvt_pk_bf16_f32 v98, v108, v109
    v_cvt_pk_bf16_f32 v99, v110, v111
    buffer_store_dwordx4 v[96:99], v9, s[48:51], s70 offen offset:2048 sc1
    s_add_u32 s52, s36, 0xc00000
    s_addc_u32 s53, s37, 0
    s_mov_b32 s54, 0x3ac000
    s_mov_b32 s55, 0x20000
    s_mul_i32 s74, s90, 10
    s_add_u32 s74, s74, 54
    s_mul_i32 s76, s74, 5120
    s_mul_i32 s77, s43, 481280
    s_add_u32 s76, s76, s77
    s_mul_i32 s77, s101, 25600
    s_add_u32 s76, s76, s77
    s_nop 0
    s_mul_i32 s75, s101, -51200
    s_add_u32 s75, s75, 35840
    s_add_u32 s77, s76, 4096
    v_lshlrev_b32 v12, 4, v0
    s_nop 7
    v_pk_mul_f32 v[120:121], v[112:113], v[120:121]
    v_pk_mul_f32 v[122:123], v[114:115], v[122:123]
    v_pk_mul_f32 v[124:125], v[116:117], v[124:125]
    v_pk_mul_f32 v[126:127], v[118:119], v[126:127]
    v_pk_mul_f32 v[112:113], v[112:113], s[56:57]
    v_pk_mul_f32 v[114:115], v[114:115], s[56:57]
    v_pk_mul_f32 v[116:117], v[116:117], s[56:57]
    v_pk_mul_f32 v[118:119], v[118:119], s[56:57]
    v_exp_f32 v112, v112
    v_exp_f32 v113, v113
    v_exp_f32 v114, v114
    v_exp_f32 v115, v115
    v_exp_f32 v116, v116
    v_exp_f32 v117, v117
    v_exp_f32 v118, v118
    v_exp_f32_e64 v119, v119
    s_nop 0
    v_pk_add_f32 v[112:113], v[112:113], 1.0 op_sel_hi:[1,0]
    v_pk_add_f32 v[114:115], v[114:115], 1.0 op_sel_hi:[1,0]
    v_pk_add_f32 v[116:117], v[116:117], 1.0 op_sel_hi:[1,0]
    v_pk_add_f32 v[118:119], v[118:119], 1.0 op_sel_hi:[1,0]
    v_rcp_f32 v112, v112
    v_rcp_f32 v113, v113
    v_rcp_f32 v114, v114
    v_rcp_f32 v115, v115
    v_rcp_f32 v116, v116
    v_rcp_f32 v117, v117
    v_rcp_f32 v118, v118
    v_rcp_f32_e64 v119, v119
    s_nop 0
    v_pk_mul_f32 v[120:121], v[120:121], v[112:113]
    v_pk_mul_f32 v[122:123], v[122:123], v[114:115]
    v_pk_mul_f32 v[124:125], v[124:125], v[116:117]
    v_pk_mul_f32 v[126:127], v[126:127], v[118:119]
    v_cvt_pk_bf16_f32 v112, v120, v121
    v_cvt_pk_bf16_f32 v113, v122, v123
    v_cvt_pk_bf16_f32 v114, v124, v125
    v_cvt_pk_bf16_f32 v115, v126, v127
    buffer_store_dwordx4 v[112:115], v9, s[48:51], s71 offen offset:0 sc1
    v_pk_mul_f32 v[136:137], v[128:129], v[136:137]
    v_pk_mul_f32 v[138:139], v[130:131], v[138:139]
    v_pk_mul_f32 v[140:141], v[132:133], v[140:141]
    v_pk_mul_f32 v[142:143], v[134:135], v[142:143]
    v_pk_mul_f32 v[128:129], v[128:129], s[56:57]
    v_pk_mul_f32 v[130:131], v[130:131], s[56:57]
    v_pk_mul_f32 v[132:133], v[132:133], s[56:57]
    v_pk_mul_f32 v[134:135], v[134:135], s[56:57]
    v_exp_f32 v128, v128
    v_exp_f32 v129, v129
    v_exp_f32 v130, v130
    v_exp_f32 v131, v131
    v_exp_f32 v132, v132
    v_exp_f32 v133, v133
    v_exp_f32 v134, v134
    v_exp_f32_e64 v135, v135
    s_nop 0
    v_pk_add_f32 v[128:129], v[128:129], 1.0 op_sel_hi:[1,0]
    v_pk_add_f32 v[130:131], v[130:131], 1.0 op_sel_hi:[1,0]
    v_pk_add_f32 v[132:133], v[132:133], 1.0 op_sel_hi:[1,0]
    v_pk_add_f32 v[134:135], v[134:135], 1.0 op_sel_hi:[1,0]
    v_rcp_f32 v128, v128
    v_rcp_f32 v129, v129
    v_rcp_f32 v130, v130
    v_rcp_f32 v131, v131
    v_rcp_f32 v132, v132
    v_rcp_f32 v133, v133
    v_rcp_f32 v134, v134
    v_rcp_f32_e64 v135, v135
    s_nop 0
    v_pk_mul_f32 v[136:137], v[136:137], v[128:129]
    v_pk_mul_f32 v[138:139], v[138:139], v[130:131]
    v_pk_mul_f32 v[140:141], v[140:141], v[132:133]
    v_pk_mul_f32 v[142:143], v[142:143], v[134:135]
    v_cvt_pk_bf16_f32 v128, v136, v137
    v_cvt_pk_bf16_f32 v129, v138, v139
    v_cvt_pk_bf16_f32 v130, v140, v141
    v_cvt_pk_bf16_f32 v131, v142, v143
    buffer_store_dwordx4 v[128:131], v9, s[48:51], s71 offen offset:2048 sc1
    v_pk_mul_f32 v[152:153], v[144:145], v[152:153]
    v_pk_mul_f32 v[154:155], v[146:147], v[154:155]
    v_pk_mul_f32 v[156:157], v[148:149], v[156:157]
    v_pk_mul_f32 v[158:159], v[150:151], v[158:159]
    v_pk_mul_f32 v[144:145], v[144:145], s[56:57]
    v_pk_mul_f32 v[146:147], v[146:147], s[56:57]
    v_pk_mul_f32 v[148:149], v[148:149], s[56:57]
    v_pk_mul_f32 v[150:151], v[150:151], s[56:57]
    v_exp_f32 v144, v144
    v_exp_f32 v145, v145
    v_exp_f32 v146, v146
    v_exp_f32 v147, v147
    v_exp_f32 v148, v148
    v_exp_f32 v149, v149
    v_exp_f32 v150, v150
    v_exp_f32_e64 v151, v151
    s_nop 0
    v_pk_add_f32 v[144:145], v[144:145], 1.0 op_sel_hi:[1,0]
    v_pk_add_f32 v[146:147], v[146:147], 1.0 op_sel_hi:[1,0]
    v_pk_add_f32 v[148:149], v[148:149], 1.0 op_sel_hi:[1,0]
    v_pk_add_f32 v[150:151], v[150:151], 1.0 op_sel_hi:[1,0]
    v_rcp_f32 v144, v144
    v_rcp_f32 v145, v145
    v_rcp_f32 v146, v146
    v_rcp_f32 v147, v147
    v_rcp_f32 v148, v148
    v_rcp_f32 v149, v149
    v_rcp_f32 v150, v150
    v_rcp_f32_e64 v151, v151
    s_nop 0
    v_pk_mul_f32 v[152:153], v[152:153], v[144:145]
    v_pk_mul_f32 v[154:155], v[154:155], v[146:147]
    v_pk_mul_f32 v[156:157], v[156:157], v[148:149]
    v_pk_mul_f32 v[158:159], v[158:159], v[150:151]
    v_cvt_pk_bf16_f32 v144, v152, v153
    v_cvt_pk_bf16_f32 v145, v154, v155
    v_cvt_pk_bf16_f32 v146, v156, v157
    v_cvt_pk_bf16_f32 v147, v158, v159
    buffer_store_dwordx4 v[144:147], v9, s[48:51], s72 offen offset:0 sc1
    v_pk_mul_f32 v[168:169], v[160:161], v[168:169]
    v_pk_mul_f32 v[170:171], v[162:163], v[170:171]
    v_pk_mul_f32 v[172:173], v[164:165], v[172:173]
    v_pk_mul_f32 v[174:175], v[166:167], v[174:175]
    v_pk_mul_f32 v[160:161], v[160:161], s[56:57]
    v_pk_mul_f32 v[162:163], v[162:163], s[56:57]
    v_pk_mul_f32 v[164:165], v[164:165], s[56:57]
    v_pk_mul_f32 v[166:167], v[166:167], s[56:57]
    v_exp_f32 v160, v160
    v_exp_f32 v161, v161
    v_exp_f32 v162, v162
    v_exp_f32 v163, v163
    v_exp_f32 v164, v164
    v_exp_f32 v165, v165
    v_exp_f32 v166, v166
    v_exp_f32_e64 v167, v167
    s_nop 0
    v_pk_add_f32 v[160:161], v[160:161], 1.0 op_sel_hi:[1,0]
    v_pk_add_f32 v[162:163], v[162:163], 1.0 op_sel_hi:[1,0]
    v_pk_add_f32 v[164:165], v[164:165], 1.0 op_sel_hi:[1,0]
    v_pk_add_f32 v[166:167], v[166:167], 1.0 op_sel_hi:[1,0]
    v_rcp_f32 v160, v160
    v_rcp_f32 v161, v161
    v_rcp_f32 v162, v162
    v_rcp_f32 v163, v163
    v_rcp_f32 v164, v164
    v_rcp_f32 v165, v165
    v_rcp_f32 v166, v166
    v_rcp_f32_e64 v167, v167
    s_nop 0
    v_pk_mul_f32 v[168:169], v[168:169], v[160:161]
    v_pk_mul_f32 v[170:171], v[170:171], v[162:163]
    v_pk_mul_f32 v[172:173], v[172:173], v[164:165]
    v_pk_mul_f32 v[174:175], v[174:175], v[166:167]
    v_cvt_pk_bf16_f32 v160, v168, v169
    v_cvt_pk_bf16_f32 v161, v170, v171
    v_cvt_pk_bf16_f32 v162, v172, v173
    v_cvt_pk_bf16_f32 v163, v174, v175
    buffer_store_dwordx4 v[160:163], v9, s[48:51], s72 offen offset:2048 sc1
Lf_done:
    s_lshl_b32 s65, s39, 2
    s_add_u32 s65, s65, s38
    s_lshl_b32 s65, s65, 13
    s_lshl_b32 s66, s40, 7
    s_add_u32 s65, s65, s66
    s_mov_b32 s66, -1
    s_mov_b32 s67, 0
    v_lshlrev_b32 v2, 2, v0
L_p2c:
    s_add_u32 s56, s36, 0x1040000
    s_addc_u32 s57, s37, 0
    s_mov_b32 s58, 0x40000
    s_mov_b32 s59, 0x20000
    v_mov_b32 v3, s64
    s_lshl_b32 s68, s90, 2
    s_add_u32 s68, s68, 160512
    v_mov_b32 v6, s68
    s_waitcnt vmcnt(0)
    s_mov_b64 exec, s[66:67]
    buffer_store_dword v3, v2, s[56:59], s65 offen sc1
    s_mov_b64 exec, -1
    s_setprio 0
    ds_write_b32 v6, v3 offset:288
    s_mov_b32 s72, 0
L2C_fpoll:
    ds_read_b32 v7, v6 offset:144
    s_waitcnt lgkmcnt(0)
    v_cmp_ne_u32 vcc, s64, v7
    s_add_u32 s72, s72, 1
    s_cmp_eq_u64 vcc, 0
    s_cbranch_scc1 L2C_fgot
    s_sleep 1
    s_cmp_lt_u32 s72, 0x100000
    s_cbranch_scc1 L2C_fpoll
L2C_fgot:
    s_mul_i32 s68, s90, 30720
    v_add_u32 v4, s68, v12
    s_lshl_b32 s80, s74, 12
    s_mul_i32 s69, s42, 385024
    s_add_u32 s80, s80, s69
    s_mul_i32 s69, s101, 20480
    s_add_u32 s80, s80, s69
    s_mul_i32 s83, s101, -40960
    s_add_u32 s83, s83, 4096
    s_lshl_b32 s68, s90, 2
    s_add_u32 s68, s68, 5
    s_mov_b32 s69, 5
    s_bfm_b64 s[78:79], s69, s68
    v_lshlrev_b32_e64 v2, 7, v0
    s_lshl_b32 s65, s42, 13
    s_mov_b32 s72, 0
    s_lshl_b32 s68, s68, 7
    s_add_u32 s68, s68, s65
    s_add_u32 s78, s56, s68
    s_addc_u32 s79, s57, 0
    s_sub_u32 s69, s69, 1
    s_lshl_b32 s69, s69, 7
    buffer_load_dwordx4 v[16:19], v12, s[52:55], s76 offen offset:0 sc1
    buffer_load_dwordx4 v[20:23], v12, s[52:55], s76 offen offset:1024 sc1
    buffer_load_dwordx4 v[24:27], v12, s[52:55], s76 offen offset:2048 sc1
    buffer_load_dwordx4 v[28:31], v12, s[52:55], s76 offen offset:3072 sc1
    buffer_load_dwordx4 v[32:35], v12, s[52:55], s77 offen offset:0 sc1
    s_add_u32 s76, s76, 5120
    s_add_u32 s77, s77, 5120
    buffer_load_dwordx4 v[36:39], v12, s[52:55], s76 offen offset:0 sc1
    buffer_load_dwordx4 v[40:43], v12, s[52:55], s76 offen offset:1024 sc1
    buffer_load_dwordx4 v[44:47], v12, s[52:55], s76 offen offset:2048 sc1
    buffer_load_dwordx4 v[48:51], v12, s[52:55], s76 offen offset:3072 sc1
    buffer_load_dwordx4 v[52:55], v12, s[52:55], s77 offen offset:0 sc1
    s_add_u32 s76, s76, s75
    s_add_u32 s77, s77, s75
    s_load_dword s6, s[78:79], 0 glc
    s_load_dword s7, s[78:79], 128 glc
    s_load_dword s8, s[78:79], 256 glc
    s_load_dword s9, s[78:79], 384 glc
    s_load_dword s10, s[78:79], s69 glc
    buffer_load_dwordx4 v[56:59], v12, s[52:55], s76 offen offset:0 sc1
    buffer_load_dwordx4 v[60:63], v12, s[52:55], s76 offen offset:1024 sc1
    buffer_load_dwordx4 v[64:67], v12, s[52:55], s76 offen offset:2048 sc1
    buffer_load_dwordx4 v[68:71], v12, s[52:55], s76 offen offset:3072 sc1
    buffer_load_dwordx4 v[72:75], v12, s[52:55], s77 offen offset:0 sc1
    s_add_u32 s76, s76, 5120
    s_add_u32 s77, s77, 5120
    buffer_load_dwordx4 v[76:79], v12, s[52:55], s76 offen offset:0 sc1
    buffer_load_dwordx4 v[80:83], v12, s[52:55], s76 offen offset:1024 sc1
    buffer_load_dwordx4 v[84:87], v12, s[52:55], s76 offen offset:2048 sc1
    buffer_load_dwordx4 v[88:91], v12, s[52:55], s76 offen offset:3072 sc1
    buffer_load_dwordx4 v[92:95], v12, s[52:55], s77 offen offset:0 sc1
    s_branch L2C_chk
L2C_poll:
    s_nop 0
    s_load_dword s6, s[78:79], 0 glc
    s_load_dword s7, s[78:79], 128 glc
    s_load_dword s8, s[78:79], 256 glc
    s_load_dword s9, s[78:79], 384 glc
    s_load_dword s10, s[78:79], s69 glc
L2C_chk:
    s_waitcnt lgkmcnt(0)
    s_xor_b32 s6, s6, s64
    s_xor_b32 s7, s7, s64
    s_xor_b32 s8, s8, s64
    s_xor_b32 s9, s9, s64
    s_xor_b32 s10, s10, s64
    s_or_b32 s6, s6, s7
    s_or_b32 s6, s6, s8
    s_or_b32 s6, s6, s9
    s_or_b32 s6, s6, s10
    s_cbranch_scc0 L2C_go
    s_sleep 4
    s_add_u32 s72, s72, 1
    s_cmp_lt_u32 s72, 0x40000
    s_cbranch_scc1 L2C_poll
L2C_go:
    buffer_load_dwordx4 v[176:179], v12, s[48:51], s80 offen offset:0 sc1
    buffer_load_dwordx4 v[180:183], v12, s[48:51], s80 offen offset:1024 sc1
    buffer_load_dwordx4 v[184:187], v12, s[48:51], s80 offen offset:2048 sc1
    buffer_load_dwordx4 v[188:191], v12, s[48:51], s80 offen offset:3072 sc1
    s_add_u32 s80, s80, 4096
    buffer_load_dwordx4 v[192:195], v12, s[48:51], s80 offen offset:0 sc1
    buffer_load_dwordx4 v[196:199], v12, s[48:51], s80 offen offset:1024 sc1
    buffer_load_dwordx4 v[200:203], v12, s[48:51], s80 offen offset:2048 sc1
    buffer_load_dwordx4 v[204:207], v12, s[48:51], s80 offen offset:3072 sc1
    s_add_u32 s80, s80, 4096
    buffer_load_dwordx4 v[208:211], v12, s[48:51], s80 offen offset:0 sc1
    buffer_load_dwordx4 v[212:215], v12, s[48:51], s80 offen offset:1024 sc1
    buffer_load_dwordx4 v[216:219], v12, s[48:51], s80 offen offset:2048 sc1
    buffer_load_dwordx4 v[220:223], v12, s[48:51], s80 offen offset:3072 sc1
    s_add_u32 s80, s80, 4096
    v_lshrrev_b32 v8, 4, v0
    v_bfe_u32 v3, v0, 1, 2
    v_xor_b32 v8, v8, v3
    v_and_b32 v3, 15, v0
    v_lshl_or_b32 v8, v3, 2, v8
    v_lshlrev_b32 v8, 4, v8
    v_bfe_u32 v9, v0, 3, 2
    v_xor_b32 v9, v9, v0
    v_lshlrev_b32_e64 v9, 4, v9
    s_waitcnt vmcnt(8)
    v_mfma_f32_16x16x32_bf16 v[96:99], v[16:19], v[176:179], 0
    v_mfma_f32_16x16x32_bf16 v[100:103], v[16:19], v[180:183], 0
    v_mfma_f32_16x16x32_bf16 v[104:107], v[16:19], v[184:187], 0
    v_mfma_f32_16x16x32_bf16 v[108:111], v[16:19], v[188:191], 0
    v_mfma_f32_16x16x32_bf16 v[112:115], v[20:23], v[176:179], 0
    v_mfma_f32_16x16x32_bf16 v[116:119], v[20:23], v[180:183], 0
    buffer_load_dwordx4 v[16:19], v12, s[48:51], s80 offen offset:0 sc1
    v_mfma_f32_16x16x32_bf16 v[120:123], v[20:23], v[184:187], 0
    v_mfma_f32_16x16x32_bf16 v[124:127], v[20:23], v[188:191], 0
    v_mfma_f32_16x16x32_bf16 v[128:131], v[24:27], v[176:179], 0
    v_mfma_f32_16x16x32_bf16 v[132:135], v[24:27], v[180:183], 0
    buffer_load_dwordx4 v[20:23], v12, s[48:51], s80 offen offset:1024 sc1
    v_mfma_f32_16x16x32_bf16 v[136:139], v[24:27], v[184:187], 0
    v_mfma_f32_16x16x32_bf16 v[140:143], v[24:27], v[188:191], 0
    v_mfma_f32_16x16x32_bf16 v[144:147], v[28:31], v[176:179], 0
    v_mfma_f32_16x16x32_bf16 v[148:151], v[28:31], v[180:183], 0
    buffer_load_dwordx4 v[24:27], v12, s[48:51], s80 offen offset:2048 sc1
    v_mfma_f32_16x16x32_bf16 v[152:155], v[28:31], v[184:187], 0
    v_mfma_f32_16x16x32_bf16 v[156:159], v[28:31], v[188:191], 0
    v_mfma_f32_16x16x32_bf16 v[160:163], v[32:35], v[176:179], 0
    v_mfma_f32_16x16x32_bf16 v[164:167], v[32:35], v[180:183], 0
    buffer_load_dwordx4 v[28:31], v12, s[48:51], s80 offen offset:3072 sc1
    s_add_u32 s80, s80, 4096
    v_mfma_f32_16x16x32_bf16 v[168:171], v[32:35], v[184:187], 0
    v_mfma_f32_16x16x32_bf16 v[172:175], v[32:35], v[188:191], 0
    buffer_load_dwordx4 v[176:179], v12, s[48:51], s80 offen offset:0 sc1
    s_waitcnt vmcnt(9)
    v_and_b32 v6, 3, v0
    v_lshlrev_b32_e64 v6, 2, v6
    v_add_u32 v6, 160512, v6
    s_mov_b32 s72, 0
L2C_spoll:
    ds_read_b32 v7, v6 offset:0
    s_waitcnt lgkmcnt(0)
    v_cmp_ne_u32 vcc, s64, v7
    s_add_u32 s72, s72, 1
    s_cmp_eq_u64 vcc, 0
    s_cbranch_scc1 L2C_sgot
    s_sleep 1
    s_cmp_lt_u32 s72, 0x100000
    s_cbranch_scc1 L2C_spoll
L2C_sgot:
    ds_read_b128 v[224:227], v4 offset:0
    ds_read_b128 v[228:231], v4 offset:1024
    ds_read_b128 v[232:235], v4 offset:2048
    ds_read_b128 v[236:239], v4 offset:3072
    ds_read_b128 v[240:243], v4 offset:4096
    v_mfma_f32_16x16x32_bf16 v[96:99], v[36:39], v[192:195], v[96:99]
    v_mfma_f32_16x16x32_bf16 v[100:103], v[36:39], v[196:199], v[100:103]
    buffer_load_dwordx4 v[180:183], v12, s[48:51], s80 offen offset:1024 sc1
    v_mfma_f32_16x16x32_bf16 v[104:107], v[36:39], v[200:203], v[104:107]
    v_mfma_f32_16x16x32_bf16 v[108:111], v[36:39], v[204:207], v[108:111]
    buffer_load_dwordx4 v[184:187], v12, s[48:51], s80 offen offset:2048 sc1
    v_mfma_f32_16x16x32_bf16 v[112:115], v[40:43], v[192:195], v[112:115]
    v_mfma_f32_16x16x32_bf16 v[116:119], v[40:43], v[196:199], v[116:119]
    buffer_load_dwordx4 v[188:191], v12, s[48:51], s80 offen offset:3072 sc1
    s_add_u32 s80, s80, s83
    s_nop 0
    v_mfma_f32_16x16x32_bf16 v[120:123], v[40:43], v[200:203], v[120:123]
    v_mfma_f32_16x16x32_bf16 v[124:127], v[40:43], v[204:207], v[124:127]
    buffer_load_dwordx4 v[32:35], v12, s[48:51], s80 offen offset:0 sc1
    v_mfma_f32_16x16x32_bf16 v[128:131], v[44:47], v[192:195], v[128:131]
    v_mfma_f32_16x16x32_bf16 v[132:135], v[44:47], v[196:199], v[132:135]
    buffer_load_dwordx4 v[36:39], v12, s[48:51], s80 offen offset:1024 sc1
    v_mfma_f32_16x16x32_bf16 v[136:139], v[44:47], v[200:203], v[136:139]
    v_mfma_f32_16x16x32_bf16 v[140:143], v[44:47], v[204:207], v[140:143]
    buffer_load_dwordx4 v[40:43], v12, s[48:51], s80 offen offset:2048 sc1
    v_mfma_f32_16x16x32_bf16 v[144:147], v[48:51], v[192:195], v[144:147]
    v_mfma_f32_16x16x32_bf16 v[148:151], v[48:51], v[196:199], v[148:151]
    buffer_load_dwordx4 v[44:47], v12, s[48:51], s80 offen offset:3072 sc1
    s_add_u32 s80, s80, 4096
    v_mfma_f32_16x16x32_bf16 v[152:155], v[48:51], v[200:203], v[152:155]
    v_mfma_f32_16x16x32_bf16 v[156:159], v[48:51], v[204:207], v[156:159]
    v_mfma_f32_16x16x32_bf16 v[160:163], v[52:55], v[192:195], v[160:163]
    v_mfma_f32_16x16x32_bf16 v[164:167], v[52:55], v[196:199], v[164:167]
    v_mfma_f32_16x16x32_bf16 v[168:171], v[52:55], v[200:203], v[168:171]
    v_mfma_f32_16x16x32_bf16 v[172:175], v[52:55], v[204:207], v[172:175]
    s_waitcnt vmcnt(12)
    s_waitcnt lgkmcnt(4)
    v_mfma_f32_16x16x32_bf16 v[96:99], v[224:227], v[208:211], v[96:99]
    ds_read_b128 v[244:247], v4 offset:5120
    v_mfma_f32_16x16x32_bf16 v[100:103], v[224:227], v[212:215], v[100:103]
    buffer_load_dwordx4 v[48:51], v12, s[48:51], s80 offen offset:0 sc1
    v_mfma_f32_16x16x32_bf16 v[104:107], v[224:227], v[216:219], v[104:107]
    v_mfma_f32_16x16x32_bf16 v[108:111], v[224:227], v[220:223], v[108:111]
    buffer_load_dwordx4 v[192:195], v12, s[48:51], s80 offen offset:1024 sc1
    s_waitcnt lgkmcnt(4)
    s_nop 0
    v_mfma_f32_16x16x32_bf16 v[112:115], v[228:231], v[208:211], v[112:115]
    ds_read_b128 v[224:227], v4 offset:6144
    v_mfma_f32_16x16x32_bf16 v[116:119], v[228:231], v[212:215], v[116:119]
    buffer_load_dwordx4 v[196:199], v12, s[48:51], s80 offen offset:2048 sc1
    v_mfma_f32_16x16x32_bf16 v[120:123], v[228:231], v[216:219], v[120:123]
    v_mfma_f32_16x16x32_bf16 v[124:127], v[228:231], v[220:223], v[124:127]
    buffer_load_dwordx4 v[200:203], v12, s[48:51], s80 offen offset:3072 sc1
    s_add_u32 s80, s80, 4096
    s_waitcnt lgkmcnt(4)
    s_nop 0
    v_mfma_f32_16x16x32_bf16 v[128:131], v[232:235], v[208:211], v[128:131]
    ds_read_b128 v[228:231], v4 offset:7168
    v_mfma_f32_16x16x32_bf16 v[132:135], v[232:235], v[212:215], v[132:135]
    v_mfma_f32_16x16x32_bf16 v[136:139], v[232:235], v[216:219], v[136:139]
    v_mfma_f32_16x16x32_bf16 v[140:143], v[232:235], v[220:223], v[140:143]
    s_waitcnt lgkmcnt(4)
    s_nop 0
    v_mfma_f32_16x16x32_bf16 v[144:147], v[236:239], v[208:211], v[144:147]
    ds_read_b128 v[232:235], v4 offset:8192
    v_mfma_f32_16x16x32_bf16 v[148:151], v[236:239], v[212:215], v[148:151]
    v_mfma_f32_16x16x32_bf16 v[152:155], v[236:239], v[216:219], v[152:155]
    v_mfma_f32_16x16x32_bf16 v[156:159], v[236:239], v[220:223], v[156:159]
    s_waitcnt lgkmcnt(4)
    s_nop 0
    v_mfma_f32_16x16x32_bf16 v[160:163], v[240:243], v[208:211], v[160:163]
    ds_read_b128 v[236:239], v4 offset:9216
    v_mfma_f32_16x16x32_bf16 v[164:167], v[240:243], v[212:215], v[164:167]
    v_mfma_f32_16x16x32_bf16 v[168:171], v[240:243], v[216:219], v[168:171]
    v_mfma_f32_16x16x32_bf16 v[172:175], v[240:243], v[220:223], v[172:175]
    s_waitcnt vmcnt(12)
    s_waitcnt lgkmcnt(4)
    v_mfma_f32_16x16x32_bf16 v[96:99], v[244:247], v[16:19], v[96:99]
    ds_read_b128 v[240:243], v4 offset:10240
    v_mfma_f32_16x16x32_bf16 v[100:103], v[244:247], v[20:23], v[100:103]
    buffer_load_dwordx4 v[204:207], v12, s[48:51], s80 offen offset:0 sc1
    v_mfma_f32_16x16x32_bf16 v[104:107], v[244:247], v[24:27], v[104:107]
    v_mfma_f32_16x16x32_bf16 v[108:111], v[244:247], v[28:31], v[108:111]
    buffer_load_dwordx4 v[52:55], v12, s[48:51], s80 offen offset:1024 sc1
    s_waitcnt lgkmcnt(4)
    s_nop 0
    v_mfma_f32_16x16x32_bf16 v[112:115], v[224:227], v[16:19], v[112:115]
    ds_read_b128 v[244:247], v4 offset:11264
    v_mfma_f32_16x16x32_bf16 v[116:119], v[224:227], v[20:23], v[116:119]
    buffer_load_dwordx4 v[208:211], v12, s[48:51], s80 offen offset:2048 sc1
    v_mfma_f32_16x16x32_bf16 v[120:123], v[224:227], v[24:27], v[120:123]
    v_mfma_f32_16x16x32_bf16 v[124:127], v[224:227], v[28:31], v[124:127]
    buffer_load_dwordx4 v[212:215], v12, s[48:51], s80 offen offset:3072 sc1
    s_add_u32 s80, s80, 4096
    s_waitcnt lgkmcnt(4)
    s_nop 0
    v_mfma_f32_16x16x32_bf16 v[128:131], v[228:231], v[16:19], v[128:131]
    ds_read_b128 v[224:227], v4 offset:12288
    v_mfma_f32_16x16x32_bf16 v[132:135], v[228:231], v[20:23], v[132:135]
    v_mfma_f32_16x16x32_bf16 v[136:139], v[228:231], v[24:27], v[136:139]
    v_mfma_f32_16x16x32_bf16 v[140:143], v[228:231], v[28:31], v[140:143]
    s_waitcnt lgkmcnt(4)
    s_nop 0
    v_mfma_f32_16x16x32_bf16 v[144:147], v[232:235], v[16:19], v[144:147]
    ds_read_b128 v[228:231], v4 offset:13312
    v_mfma_f32_16x16x32_bf16 v[148:151], v[232:235], v[20:23], v[148:151]
    v_mfma_f32_16x16x32_bf16 v[152:155], v[232:235], v[24:27], v[152:155]
    v_mfma_f32_16x16x32_bf16 v[156:159], v[232:235], v[28:31], v[156:159]
    s_waitcnt lgkmcnt(4)
    s_nop 0
    v_mfma_f32_16x16x32_bf16 v[160:163], v[236:239], v[16:19], v[160:163]
    ds_read_b128 v[232:235], v4 offset:14336
    v_mfma_f32_16x16x32_bf16 v[164:167], v[236:239], v[20:23], v[164:167]
    v_mfma_f32_16x16x32_bf16 v[168:171], v[236:239], v[24:27], v[168:171]
    v_mfma_f32_16x16x32_bf16 v[172:175], v[236:239], v[28:31], v[172:175]
    s_waitcnt vmcnt(12)
    s_waitcnt lgkmcnt(4)
    v_mfma_f32_16x16x32_bf16 v[96:99], v[240:243], v[176:179], v[96:99]
    ds_read_b128 v[236:239], v4 offset:15360
    v_mfma_f32_16x16x32_bf16 v[100:103], v[240:243], v[180:183], v[100:103]
    buffer_load_dwordx4 v[216:219], v12, s[48:51], s80 offen offset:0 sc1
    v_mfma_f32_16x16x32_bf16 v[104:107], v[240:243], v[184:187], v[104:107]
    v_mfma_f32_16x16x32_bf16 v[108:111], v[240:243], v[188:191], v[108:111]
    buffer_load_dwordx4 v[220:223], v12, s[48:51], s80 offen offset:1024 sc1
    s_waitcnt lgkmcnt(4)
    s_nop 0
    v_mfma_f32_16x16x32_bf16 v[112:115], v[244:247], v[176:179], v[112:115]
    ds_read_b128 v[240:243], v4 offset:16384
    v_mfma_f32_16x16x32_bf16 v[116:119], v[244:247], v[180:183], v[116:119]
    buffer_load_dwordx4 v[16:19], v12, s[48:51], s80 offen offset:2048 sc1
    v_mfma_f32_16x16x32_bf16 v[120:123], v[244:247], v[184:187], v[120:123]
    v_mfma_f32_16x16x32_bf16 v[124:127], v[244:247], v[188:191], v[124:127]
    buffer_load_dwordx4 v[20:23], v12, s[48:51], s80 offen offset:3072 sc1
    s_add_u32 s80, s80, 4096
    s_waitcnt lgkmcnt(4)
    s_nop 0
    v_mfma_f32_16x16x32_bf16 v[128:131], v[224:227], v[176:179], v[128:131]
    ds_read_b128 v[244:247], v4 offset:17408
    v_mfma_f32_16x16x32_bf16 v[132:135], v[224:227], v[180:183], v[132:135]
    v_mfma_f32_16x16x32_bf16 v[136:139], v[224:227], v[184:187], v[136:139]
    v_mfma_f32_16x16x32_bf16 v[140:143], v[224:227], v[188:191], v[140:143]
    s_waitcnt lgkmcnt(4)
    s_nop 0
    v_mfma_f32_16x16x32_bf16 v[144:147], v[228:231], v[176:179], v[144:147]
    ds_read_b128 v[224:227], v4 offset:18432
    v_mfma_f32_16x16x32_bf16 v[148:151], v[228:231], v[180:183], v[148:151]
    v_mfma_f32_16x16x32_bf16 v[152:155], v[228:231], v[184:187], v[152:155]
    v_mfma_f32_16x16x32_bf16 v[156:159], v[228:231], v[188:191], v[156:159]
    s_waitcnt lgkmcnt(4)
    s_nop 0
    v_mfma_f32_16x16x32_bf16 v[160:163], v[232:235], v[176:179], v[160:163]
    ds_read_b128 v[228:231], v4 offset:19456
    v_mfma_f32_16x16x32_bf16 v[164:167], v[232:235], v[180:183], v[164:167]
    v_mfma_f32_16x16x32_bf16 v[168:171], v[232:235], v[184:187], v[168:171]
    v_mfma_f32_16x16x32_bf16 v[172:175], v[232:235], v[188:191], v[172:175]
    s_waitcnt vmcnt(12)
    s_waitcnt lgkmcnt(4)
    v_mfma_f32_16x16x32_bf16 v[96:99], v[236:239], v[32:35], v[96:99]
    ds_read_b128 v[232:235], v4 offset:20480
    v_mfma_f32_16x16x32_bf16 v[100:103], v[236:239], v[36:39], v[100:103]
    buffer_load_dwordx4 v[24:27], v12, s[48:51], s80 offen offset:0 sc1
    v_mfma_f32_16x16x32_bf16 v[104:107], v[236:239], v[40:43], v[104:107]
    v_mfma_f32_16x16x32_bf16 v[108:111], v[236:239], v[44:47], v[108:111]
    buffer_load_dwordx4 v[28:31], v12, s[48:51], s80 offen offset:1024 sc1
    s_waitcnt lgkmcnt(4)
    s_nop 0
    v_mfma_f32_16x16x32_bf16 v[112:115], v[240:243], v[32:35], v[112:115]
    ds_read_b128 v[236:239], v4 offset:21504
    v_mfma_f32_16x16x32_bf16 v[116:119], v[240:243], v[36:39], v[116:119]
    buffer_load_dwordx4 v[176:179], v12, s[48:51], s80 offen offset:2048 sc1
    v_mfma_f32_16x16x32_bf16 v[120:123], v[240:243], v[40:43], v[120:123]
    v_mfma_f32_16x16x32_bf16 v[124:127], v[240:243], v[44:47], v[124:127]
    buffer_load_dwordx4 v[180:183], v12, s[48:51], s80 offen offset:3072 sc1
    s_add_u32 s80, s80, 4096
    s_waitcnt lgkmcnt(4)
    s_nop 0
    v_mfma_f32_16x16x32_bf16 v[128:131], v[244:247], v[32:35], v[128:131]
    ds_read_b128 v[240:243], v4 offset:22528
    v_mfma_f32_16x16x32_bf16 v[132:135], v[244:247], v[36:39], v[132:135]
    v_mfma_f32_16x16x32_bf16 v[136:139], v[244:247], v[40:43], v[136:139]
    v_mfma_f32_16x16x32_bf16 v[140:143], v[244:247], v[44:47], v[140:143]
    s_waitcnt lgkmcnt(4)
    s_nop 0
    v_mfma_f32_16x16x32_bf16 v[144:147], v[224:227], v[32:35], v[144:147]
    ds_read_b128 v[244:247], v4 offset:23552
    v_mfma_f32_16x16x32_bf16 v[148:151], v[224:227], v[36:39], v[148:151]
    v_mfma_f32_16x16x32_bf16 v[152:155], v[224:227], v[40:43], v[152:155]
    v_mfma_f32_16x16x32_bf16 v[156:159], v[224:227], v[44:47], v[156:159]
    s_waitcnt lgkmcnt(4)
    s_nop 0
    v_mfma_f32_16x16x32_bf16 v[160:163], v[228:231], v[32:35], v[160:163]
    ds_read_b128 v[224:227], v4 offset:24576
    v_mfma_f32_16x16x32_bf16 v[164:167], v[228:231], v[36:39], v[164:167]
    v_mfma_f32_16x16x32_bf16 v[168:171], v[228:231], v[40:43], v[168:171]
    v_mfma_f32_16x16x32_bf16 v[172:175], v[228:231], v[44:47], v[172:175]
    s_add_u32 s60, s36, 0x1000000
    s_addc_u32 s61, s37, 0
    s_mov_b32 s62, 0x4000
    s_mov_b32 s63, 0x20000
    v_lshrrev_b32 v2, 2, v0
    v_lshlrev_b32 v3, 3, v2
    s_lshl_b32 s68, s42, 6
    s_lshl_b32 s69, s90, 4
    s_add_u32 s68, s68, s69
    s_lshl_b32 s81, s68, 3
    v_mov_b32 v186, v3
    buffer_load_dwordx2 v[184:185], v3, s[60:63], s81 offen sc1
    s_mov_b32 s84, s4
    s_mov_b32 s85, s5
    s_mov_b32 s86, 0x280000
    s_mov_b32 s87, 0x20000
    v_and_b32 v3, 3, v0
    v_lshlrev_b32 v3, 3, v3
    v_mul_u32_u24 v2, 1280, v2
    v_add_u32 v2, v2, v3
    s_mul_i32 s71, s68, 1280
    s_mul_i32 s69, s43, 160
    s_add_u32 s71, s71, s69
    buffer_load_dwordx2 v[188:189], v2, s[84:87], s71 offen offset:0
    buffer_load_dwordx2 v[32:33], v2, s[84:87], s71 offen offset:32
    buffer_load_dwordx2 v[36:37], v2, s[84:87], s71 offen offset:64
    buffer_load_dwordx2 v[40:41], v2, s[84:87], s71 offen offset:96
    buffer_load_dwordx2 v[44:45], v2, s[84:87], s71 offen offset:128
    s_mov_b32 s84, s20
    s_mov_b32 s85, s21
    s_mov_b32 s86, 0x500
    s_mov_b32 s87, 0x20000
    buffer_load_dwordx2 v[190:191], v3, s[84:87], s69 offen offset:0
    buffer_load_dwordx2 v[34:35], v3, s[84:87], s69 offen offset:32
    buffer_load_dwordx2 v[38:39], v3, s[84:87], s69 offen offset:64
    buffer_load_dwordx2 v[42:43], v3, s[84:87], s69 offen offset:96
    buffer_load_dwordx2 v[46:47], v3, s[84:87], s69 offen offset:128
    v_lshlrev_b32 v2, 1, v2
    s_lshl_b32 s71, s71, 1
    s_mov_b32 s84, s32
    s_mov_b32 s85, s33
    s_mov_b32 s86, 0x500000
    s_mov_b32 s87, 0x20000
    s_mul_i32 s68, s90, 30720
    v_add_u32_e64 v3, s68, v8
    v_add_u32 v5, 10240, v3
    s_waitcnt vmcnt(23)
    s_waitcnt lgkmcnt(4)
    v_mfma_f32_16x16x32_bf16 v[96:99], v[232:235], v[48:51], v[96:99]
    ds_read_b128 v[228:231], v4 offset:25600
    v_mfma_f32_16x16x32_bf16 v[100:103], v[232:235], v[192:195], v[100:103]
    v_mfma_f32_16x16x32_bf16 v[104:107], v[232:235], v[196:199], v[104:107]
    v_mfma_f32_16x16x32_bf16 v[108:111], v[232:235], v[200:203], v[108:111]
    s_waitcnt lgkmcnt(4)
    s_nop 0
    v_mfma_f32_16x16x32_bf16 v[112:115], v[236:239], v[48:51], v[112:115]
    ds_read_b128 v[232:235], v4 offset:26624
    v_mfma_f32_16x16x32_bf16 v[116:119], v[236:239], v[192:195], v[116:119]
    v_mfma_f32_16x16x32_bf16 v[120:123], v[236:239], v[196:199], v[120:123]
    v_mfma_f32_16x16x32_bf16 v[124:127], v[236:239], v[200:203], v[124:127]
    s_waitcnt lgkmcnt(4)
    s_nop 0
    v_mfma_f32_16x16x32_bf16 v[128:131], v[240:243], v[48:51], v[128:131]
    ds_read_b128 v[236:239], v4 offset:27648
    v_mfma_f32_16x16x32_bf16 v[132:135], v[240:243], v[192:195], v[132:135]
    v_mfma_f32_16x16x32_bf16 v[136:139], v[240:243], v[196:199], v[136:139]
    v_mfma_f32_16x16x32_bf16 v[140:143], v[240:243], v[200:203], v[140:143]
    s_waitcnt lgkmcnt(4)
    s_nop 0
    v_mfma_f32_16x16x32_bf16 v[144:147], v[244:247], v[48:51], v[144:147]
    ds_read_b128 v[240:243], v4 offset:28672
    v_mfma_f32_16x16x32_bf16 v[148:151], v[244:247], v[192:195], v[148:151]
    v_mfma_f32_16x16x32_bf16 v[152:155], v[244:247], v[196:199], v[152:155]
    v_mfma_f32_16x16x32_bf16 v[156:159], v[244:247], v[200:203], v[156:159]
    s_waitcnt lgkmcnt(4)
    s_nop 0
    v_mfma_f32_16x16x32_bf16 v[160:163], v[224:227], v[48:51], v[160:163]
    ds_read_b128 v[244:247], v4 offset:29696
    v_mfma_f32_16x16x32_bf16 v[164:167], v[224:227], v[192:195], v[164:167]
    v_mfma_f32_16x16x32_bf16 v[168:171], v[224:227], v[196:199], v[168:171]
    v_mfma_f32_16x16x32_bf16 v[172:175], v[224:227], v[200:203], v[172:175]
    s_waitcnt vmcnt(19)
    s_waitcnt lgkmcnt(4)
    v_mfma_f32_16x16x32_bf16 v[96:99], v[228:231], v[204:207], v[96:99]
    v_mfma_f32_16x16x32_bf16 v[100:103], v[228:231], v[52:55], v[100:103]
    v_mfma_f32_16x16x32_bf16 v[104:107], v[228:231], v[208:211], v[104:107]
    v_mfma_f32_16x16x32_bf16 v[108:111], v[228:231], v[212:215], v[108:111]
    s_waitcnt lgkmcnt(3)
    s_nop 0
    v_mfma_f32_16x16x32_bf16 v[112:115], v[232:235], v[204:207], v[112:115]
    v_mfma_f32_16x16x32_bf16 v[116:119], v[232:235], v[52:55], v[116:119]
    v_mfma_f32_16x16x32_bf16 v[120:123], v[232:235], v[208:211], v[120:123]
    v_mfma_f32_16x16x32_bf16 v[124:127], v[232:235], v[212:215], v[124:127]
    s_waitcnt lgkmcnt(2)
    s_nop 0
    v_mfma_f32_16x16x32_bf16 v[128:131], v[236:239], v[204:207], v[128:131]
    v_mfma_f32_16x16x32_bf16 v[132:135], v[236:239], v[52:55], v[132:135]
    v_mfma_f32_16x16x32_bf16 v[136:139], v[236:239], v[208:211], v[136:139]
    v_mfma_f32_16x16x32_bf16 v[140:143], v[236:239], v[212:215], v[140:143]
    s_waitcnt lgkmcnt(1)
    s_nop 0
    v_mfma_f32_16x16x32_bf16 v[144:147], v[240:243], v[204:207], v[144:147]
    v_mfma_f32_16x16x32_bf16 v[148:151], v[240:243], v[52:55], v[148:151]
    v_mfma_f32_16x16x32_bf16 v[152:155], v[240:243], v[208:211], v[152:155]
    v_mfma_f32_16x16x32_bf16 v[156:159], v[240:243], v[212:215], v[156:159]
    s_waitcnt lgkmcnt(0)
    s_nop 0
    v_mfma_f32_16x16x32_bf16 v[160:163], v[244:247], v[204:207], v[160:163]
    v_mfma_f32_16x16x32_bf16 v[164:167], v[244:247], v[52:55], v[164:167]
    v_mfma_f32_16x16x32_bf16 v[168:171], v[244:247], v[208:211], v[168:171]
    v_mfma_f32_16x16x32_bf16 v[172:175], v[244:247], v[212:215], v[172:175]
    s_waitcnt vmcnt(15)
    s_nop 0
    v_mfma_f32_16x16x32_bf16 v[96:99], v[56:59], v[216:219], v[96:99]
    v_mfma_f32_16x16x32_bf16 v[100:103], v[56:59], v[220:223], v[100:103]
    v_mfma_f32_16x16x32_bf16 v[104:107], v[56:59], v[16:19], v[104:107]
    v_mfma_f32_16x16x32_bf16 v[108:111], v[56:59], v[20:23], v[108:111]
    s_waitcnt vmcnt(11)
    s_nop 0
    v_mfma_f32_16x16x32_bf16 v[112:115], v[60:63], v[216:219], v[112:115]
    v_mfma_f32_16x16x32_bf16 v[116:119], v[60:63], v[220:223], v[116:119]
    v_mfma_f32_16x16x32_bf16 v[120:123], v[60:63], v[16:19], v[120:123]
    v_mfma_f32_16x16x32_bf16 v[124:127], v[60:63], v[20:23], v[124:127]
    v_mfma_f32_16x16x32_bf16 v[96:99], v[76:79], v[24:27], v[96:99]
    v_mfma_f32_16x16x32_bf16 v[100:103], v[76:79], v[28:31], v[100:103]
    v_mfma_f32_16x16x32_bf16 v[104:107], v[76:79], v[176:179], v[104:107]
    v_mfma_f32_16x16x32_bf16 v[108:111], v[76:79], v[180:183], v[108:111]
    v_mfma_f32_16x16x32_bf16 v[128:131], v[64:67], v[216:219], v[128:131]
    v_mfma_f32_16x16x32_bf16 v[132:135], v[64:67], v[220:223], v[132:135]
    v_mfma_f32_16x16x32_bf16 v[136:139], v[64:67], v[16:19], v[136:139]
    v_mfma_f32_16x16x32_bf16 v[140:143], v[64:67], v[20:23], v[140:143]
    v_mfma_f32_16x16x32_bf16 v[112:115], v[80:83], v[24:27], v[112:115]
    v_mfma_f32_16x16x32_bf16 v[116:119], v[80:83], v[28:31], v[116:119]
    v_mfma_f32_16x16x32_bf16 v[120:123], v[80:83], v[176:179], v[120:123]
    v_mfma_f32_16x16x32_bf16 v[124:127], v[80:83], v[180:183], v[124:127]
    ds_write_b128 v3, v[96:99] offset:0
    ds_write_b128 v3, v[100:103] offset:5120
    ds_write_b128 v5, v[104:107] offset:0
    ds_write_b128 v5, v[108:111] offset:5120
    v_mfma_f32_16x16x32_bf16 v[144:147], v[68:71], v[216:219], v[144:147]
    v_mfma_f32_16x16x32_bf16 v[148:151], v[68:71], v[220:223], v[148:151]
    v_mfma_f32_16x16x32_bf16 v[152:155], v[68:71], v[16:19], v[152:155]
    v_mfma_f32_16x16x32_bf16 v[156:159], v[68:71], v[20:23], v[156:159]
    v_mfma_f32_16x16x32_bf16 v[128:131], v[84:87], v[24:27], v[128:131]
    v_mfma_f32_16x16x32_bf16 v[132:135], v[84:87], v[28:31], v[132:135]
    v_mfma_f32_16x16x32_bf16 v[136:139], v[84:87], v[176:179], v[136:139]
    v_mfma_f32_16x16x32_bf16 v[140:143], v[84:87], v[180:183], v[140:143]
    ds_write_b128 v3, v[112:115] offset:1024
    ds_write_b128 v3, v[116:119] offset:6144
    ds_write_b128 v5, v[120:123] offset:1024
    ds_write_b128 v5, v[124:127] offset:6144
    v_mfma_f32_16x16x32_bf16 v[160:163], v[72:75], v[216:219], v[160:163]
    v_mfma_f32_16x16x32_bf16 v[164:167], v[72:75], v[220:223], v[164:167]
    v_mfma_f32_16x16x32_bf16 v[168:171], v[72:75], v[16:19], v[168:171]
    v_mfma_f32_16x16x32_bf16 v[172:175], v[72:75], v[20:23], v[172:175]
    v_mfma_f32_16x16x32_bf16 v[144:147], v[88:91], v[24:27], v[144:147]
    v_mfma_f32_16x16x32_bf16 v[148:151], v[88:91], v[28:31], v[148:151]
    v_mfma_f32_16x16x32_bf16 v[152:155], v[88:91], v[176:179], v[152:155]
    v_mfma_f32_16x16x32_bf16 v[156:159], v[88:91], v[180:183], v[156:159]
    ds_write_b128 v3, v[128:131] offset:2048
    ds_write_b128 v3, v[132:135] offset:7168
    ds_write_b128 v5, v[136:139] offset:2048
    ds_write_b128 v5, v[140:143] offset:7168
    v_mfma_f32_16x16x32_bf16 v[160:163], v[92:95], v[24:27], v[160:163]
    v_mfma_f32_16x16x32_bf16 v[164:167], v[92:95], v[28:31], v[164:167]
    v_mfma_f32_16x16x32_bf16 v[168:171], v[92:95], v[176:179], v[168:171]
    v_mfma_f32_16x16x32_bf16 v[172:175], v[92:95], v[180:183], v[172:175]
    s_nop 3
    s_nop 0
    ds_write_b128 v3, v[144:147] offset:3072
    ds_write_b128 v3, v[148:151] offset:8192
    ds_write_b128 v5, v[152:155] offset:3072
    ds_write_b128 v5, v[156:159] offset:8192
    s_nop 3
    s_nop 0
    ds_write_b128 v3, v[160:163] offset:4096
    ds_write_b128 v3, v[164:167] offset:9216
    ds_write_b128 v5, v[168:171] offset:4096
    ds_write_b128 v5, v[172:175] offset:9216
    s_waitcnt vmcnt(0)
    v_lshlrev_b32 v48, 16, v190
    v_and_b32 v49, 0xffff0000, v190
    v_lshlrev_b32 v50, 16, v191
    v_and_b32 v51, 0xffff0000, v191
    v_lshlrev_b32 v190, 16, v189
    v_and_b32 v191, 0xffff0000, v189
    v_and_b32 v189, 0xffff0000, v188
    v_lshlrev_b32 v188, 16, v188
    v_pk_mul_f32 v[188:189], v[188:189], v[48:49]
    v_cvt_pk_bf16_f32 v189, v188, v189
    v_lshlrev_b32 v188, 16, v189
    v_and_b32 v189, 0xffff0000, v189
    v_pk_mul_f32 v[190:191], v[190:191], v[50:51]
    v_cvt_pk_bf16_f32 v191, v190, v191
    v_lshlrev_b32 v190, 16, v191
    v_and_b32 v191, 0xffff0000, v191
    v_lshlrev_b32 v48, 16, v34
    v_and_b32 v49, 0xffff0000, v34
    v_lshlrev_b32 v50, 16, v35
    v_and_b32 v51, 0xffff0000, v35
    v_lshlrev_b32 v34, 16, v33
    v_and_b32 v35, 0xffff0000, v33
    v_and_b32 v33, 0xffff0000, v32
    v_lshlrev_b32 v32, 16, v32
    v_pk_mul_f32 v[32:33], v[32:33], v[48:49]
    v_cvt_pk_bf16_f32 v33, v32, v33
    v_lshlrev_b32 v32, 16, v33
    v_and_b32 v33, 0xffff0000, v33
    v_pk_mul_f32 v[34:35], v[34:35], v[50:51]
    v_cvt_pk_bf16_f32 v35, v34, v35
    v_lshlrev_b32 v34, 16, v35
    v_and_b32 v35, 0xffff0000, v35
    v_lshlrev_b32 v48, 16, v38
    v_and_b32 v49, 0xffff0000, v38
    v_lshlrev_b32 v50, 16, v39
    v_and_b32 v51, 0xffff0000, v39
    v_lshlrev_b32 v38, 16, v37
    v_and_b32 v39, 0xffff0000, v37
    v_and_b32 v37, 0xffff0000, v36
    v_lshlrev_b32 v36, 16, v36
    v_pk_mul_f32 v[36:37], v[36:37], v[48:49]
    v_cvt_pk_bf16_f32 v37, v36, v37
    v_lshlrev_b32 v36, 16, v37
    v_and_b32 v37, 0xffff0000, v37
    v_pk_mul_f32 v[38:39], v[38:39], v[50:51]
    v_cvt_pk_bf16_f32 v39, v38, v39
    v_lshlrev_b32 v38, 16, v39
    v_and_b32 v39, 0xffff0000, v39
    v_lshlrev_b32 v48, 16, v42
    v_and_b32 v49, 0xffff0000, v42
    v_lshlrev_b32 v50, 16, v43
    v_and_b32 v51, 0xffff0000, v43
    v_lshlrev_b32 v42, 16, v41
    v_and_b32 v43, 0xffff0000, v41
    v_and_b32 v41, 0xffff0000, v40
    v_lshlrev_b32 v40, 16, v40
    v_pk_mul_f32 v[40:41], v[40:41], v[48:49]
    v_cvt_pk_bf16_f32 v41, v40, v41
    v_lshlrev_b32 v40, 16, v41
    v_and_b32 v41, 0xffff0000, v41
    v_pk_mul_f32 v[42:43], v[42:43], v[50:51]
    v_cvt_pk_bf16_f32 v43, v42, v43
    v_lshlrev_b32 v42, 16, v43
    v_and_b32 v43, 0xffff0000, v43
    v_lshlrev_b32 v48, 16, v46
    v_and_b32 v49, 0xffff0000, v46
    v_lshlrev_b32 v50, 16, v47
    v_and_b32 v51, 0xffff0000, v47
    v_lshlrev_b32 v46, 16, v45
    v_and_b32 v47, 0xffff0000, v45
    v_and_b32 v45, 0xffff0000, v44
    v_lshlrev_b32 v44, 16, v44
    v_pk_mul_f32 v[44:45], v[44:45], v[48:49]
    v_cvt_pk_bf16_f32 v45, v44, v45
    v_lshlrev_b32 v44, 16, v45
    v_and_b32 v45, 0xffff0000, v45
    v_pk_mul_f32 v[46:47], v[46:47], v[50:51]
    v_cvt_pk_bf16_f32 v47, v46, v47
    v_lshlrev_b32 v46, 16, v47
    v_and_b32 v47, 0xffff0000, v47
    s_mov_b32 s72, 0
L2C_gpoll:
    v_cmp_ne_u32 vcc, s64, v185
    s_cmp_eq_u64 vcc, 0
    s_cbranch_scc1 L2C_ggot
    buffer_load_dwordx2 v[184:185], v186, s[60:63], s81 offen sc1
    s_waitcnt vmcnt(0)
    s_add_u32 s72, s72, 1
    s_cmp_lt_u32 s72, 0x40000
    s_cbranch_scc1 L2C_gpoll
L2C_ggot:
    v_sub_f32 v185, 1.0, v184
    v_cvt_pk_bf16_f32 v185, v185, v185
    v_lshlrev_b32 v185, 16, v185
    s_mul_i32 s68, s90, 5120
    v_add_u32 v3, s68, v9
    v_add_u32 v4, 61440, v3
    v_add_u32 v6, 122880, v3
    s_lshr_b32 s69, s90, 1
    s_mul_i32 s69, s69, 20480
    s_add_u32 s69, s69, 20480
    v_add_u32_e64 v5, s69, v3
    v_add_u32 v7, 61440, v5
    s_waitcnt lgkmcnt(0)
    s_barrier
    ds_read_b128 v[96:99], v3 offset:0
    ds_read_b128 v[100:103], v3 offset:30720
    ds_read_b128 v[104:107], v4 offset:0
    ds_read_b128 v[108:111], v4 offset:30720
    ds_read_b128 v[112:115], v3 offset:1024
    ds_read_b128 v[116:119], v3 offset:31744
    ds_read_b128 v[120:123], v4 offset:1024
    ds_read_b128 v[124:127], v4 offset:31744
    ds_read_b128 v[128:131], v3 offset:2048
    ds_read_b128 v[132:135], v3 offset:32768
    ds_read_b128 v[136:139], v4 offset:2048
    ds_read_b128 v[140:143], v4 offset:32768
    s_waitcnt lgkmcnt(8)
    s_nop 0
    v_pk_add_f32 v[96:97], v[96:97], v[100:101]
    v_pk_add_f32 v[104:105], v[104:105], v[108:109]
    v_pk_add_f32 v[192:193], v[96:97], v[104:105]
    v_pk_add_f32 v[98:99], v[98:99], v[102:103]
    v_pk_add_f32 v[106:107], v[106:107], v[110:111]
    v_pk_add_f32 v[194:195], v[98:99], v[106:107]
    ds_read_b128 v[144:147], v3 offset:3072
    ds_read_b128 v[148:151], v3 offset:33792
    ds_read_b128 v[152:155], v4 offset:3072
    ds_read_b128 v[156:159], v4 offset:33792
    s_waitcnt lgkmcnt(8)
    s_nop 0
    v_pk_add_f32 v[112:113], v[112:113], v[116:117]
    v_pk_add_f32 v[120:121], v[120:121], v[124:125]
    v_pk_add_f32 v[196:197], v[112:113], v[120:121]
    v_pk_add_f32 v[114:115], v[114:115], v[118:119]
    v_pk_add_f32 v[122:123], v[122:123], v[126:127]
    v_pk_add_f32 v[198:199], v[114:115], v[122:123]
    ds_read_b128 v[160:163], v3 offset:4096
    ds_read_b128 v[164:167], v3 offset:34816
    ds_read_b128 v[168:171], v4 offset:4096
    ds_read_b128 v[172:175], v4 offset:34816
    s_waitcnt lgkmcnt(8)
    s_nop 0
    v_pk_add_f32 v[128:129], v[128:129], v[132:133]
    v_pk_add_f32 v[136:137], v[136:137], v[140:141]
    v_pk_add_f32 v[200:201], v[128:129], v[136:137]
    v_pk_add_f32 v[130:131], v[130:131], v[134:135]
    v_pk_add_f32 v[138:139], v[138:139], v[142:143]
    v_pk_add_f32 v[202:203], v[130:131], v[138:139]
    s_waitcnt lgkmcnt(4)
    s_nop 0
    v_pk_add_f32 v[144:145], v[144:145], v[148:149]
    v_pk_add_f32 v[152:153], v[152:153], v[156:157]
    v_pk_add_f32 v[204:205], v[144:145], v[152:153]
    v_pk_add_f32 v[146:147], v[146:147], v[150:151]
    v_pk_add_f32 v[154:155], v[154:155], v[158:159]
    v_pk_add_f32 v[206:207], v[146:147], v[154:155]
    s_waitcnt lgkmcnt(0)
    s_nop 0
    v_pk_add_f32 v[160:161], v[160:161], v[164:165]
    v_pk_add_f32 v[168:169], v[168:169], v[172:173]
    v_pk_add_f32 v[52:53], v[160:161], v[168:169]
    v_pk_add_f32 v[162:163], v[162:163], v[166:167]
    v_pk_add_f32 v[170:171], v[170:171], v[174:175]
    v_pk_add_f32 v[54:55], v[162:163], v[170:171]
    s_barrier
    s_nop 0
    ds_read_b128 v[96:99], v5 offset:0
    ds_read_b128 v[100:103], v7 offset:0
    ds_read_b128 v[104:107], v6 offset:0
    ds_read_b128 v[108:111], v6 offset:20480
    ds_read_b128 v[112:115], v5 offset:1024
    ds_read_b128 v[116:119], v7 offset:1024
    ds_read_b128 v[120:123], v6 offset:1024
    ds_read_b128 v[124:127], v6 offset:21504
    ds_read_b128 v[128:131], v5 offset:2048
    ds_read_b128 v[132:135], v7 offset:2048
    ds_read_b128 v[136:139], v6 offset:2048
    ds_read_b128 v[140:143], v6 offset:22528
    s_waitcnt lgkmcnt(8)
    s_nop 0
    v_pk_add_f32 v[192:193], v[192:193], v[108:109]
    v_pk_add_f32 v[96:97], v[96:97], v[100:101]
    v_pk_add_f32 v[104:105], v[104:105], v[188:189]
    v_cvt_pk_bf16_f32 v193, v192, v193
    v_pk_add_f32 v[96:97], v[96:97], v[104:105]
    v_lshlrev_b32_e64 v192, 16, v193
    v_and_b32 v193, 0xffff0000, v193
    v_pk_mul_f32 v[192:193], v[184:185], v[192:193] op_sel:[1,0] op_sel_hi:[1,1]
    v_cvt_pk_bf16_f32 v193, v192, v193
    v_lshlrev_b32_e64 v192, 16, v193
    v_and_b32 v193, 0xffff0000, v193
    v_pk_fma_f32 v[188:189], v[184:185], v[96:97], v[192:193] op_sel_hi:[0,1,1]
    v_pk_add_f32 v[194:195], v[194:195], v[110:111]
    v_pk_add_f32 v[98:99], v[98:99], v[102:103]
    v_pk_add_f32 v[106:107], v[106:107], v[190:191]
    v_cvt_pk_bf16_f32 v195, v194, v195
    v_pk_add_f32 v[98:99], v[98:99], v[106:107]
    v_lshlrev_b32_e64 v194, 16, v195
    v_and_b32 v195, 0xffff0000, v195
    v_pk_mul_f32 v[194:195], v[184:185], v[194:195] op_sel:[1,0] op_sel_hi:[1,1]
    v_cvt_pk_bf16_f32 v195, v194, v195
    v_lshlrev_b32_e64 v194, 16, v195
    v_and_b32 v195, 0xffff0000, v195
    v_pk_fma_f32 v[190:191], v[184:185], v[98:99], v[194:195] op_sel_hi:[0,1,1]
    buffer_store_dwordx4 v[188:191], v2, s[84:87], s71 offen offset:0 nt
    ds_read_b128 v[144:147], v5 offset:3072
    ds_read_b128 v[148:151], v7 offset:3072
    ds_read_b128 v[152:155], v6 offset:3072
    ds_read_b128 v[156:159], v6 offset:23552
    s_waitcnt lgkmcnt(8)
    s_nop 0
    v_pk_add_f32 v[196:197], v[196:197], v[124:125]
    v_pk_add_f32 v[112:113], v[112:113], v[116:117]
    v_pk_add_f32 v[120:121], v[120:121], v[32:33]
    v_cvt_pk_bf16_f32 v197, v196, v197
    v_pk_add_f32 v[112:113], v[112:113], v[120:121]
    v_lshlrev_b32_e64 v196, 16, v197
    v_and_b32 v197, 0xffff0000, v197
    v_pk_mul_f32 v[196:197], v[184:185], v[196:197] op_sel:[1,0] op_sel_hi:[1,1]
    v_cvt_pk_bf16_f32 v197, v196, v197
    v_lshlrev_b32_e64 v196, 16, v197
    v_and_b32 v197, 0xffff0000, v197
    v_pk_fma_f32 v[32:33], v[184:185], v[112:113], v[196:197] op_sel_hi:[0,1,1]
    v_pk_add_f32 v[198:199], v[198:199], v[126:127]
    v_pk_add_f32 v[114:115], v[114:115], v[118:119]
    v_pk_add_f32 v[122:123], v[122:123], v[34:35]
    v_cvt_pk_bf16_f32 v199, v198, v199
    v_pk_add_f32 v[114:115], v[114:115], v[122:123]
    v_lshlrev_b32_e64 v198, 16, v199
    v_and_b32 v199, 0xffff0000, v199
    v_pk_mul_f32 v[198:199], v[184:185], v[198:199] op_sel:[1,0] op_sel_hi:[1,1]
    v_cvt_pk_bf16_f32 v199, v198, v199
    v_lshlrev_b32_e64 v198, 16, v199
    v_and_b32 v199, 0xffff0000, v199
    v_pk_fma_f32 v[34:35], v[184:185], v[114:115], v[198:199] op_sel_hi:[0,1,1]
    buffer_store_dwordx4 v[32:35], v2, s[84:87], s71 offen offset:64 nt
    ds_read_b128 v[160:163], v5 offset:4096
    ds_read_b128 v[164:167], v7 offset:4096
    ds_read_b128 v[168:171], v6 offset:4096
    ds_read_b128 v[172:175], v6 offset:24576
    s_waitcnt lgkmcnt(8)
    s_nop 0
    v_pk_add_f32 v[200:201], v[200:201], v[140:141]
    v_pk_add_f32 v[128:129], v[128:129], v[132:133]
    v_pk_add_f32 v[136:137], v[136:137], v[36:37]
    v_cvt_pk_bf16_f32 v201, v200, v201
    v_pk_add_f32 v[128:129], v[128:129], v[136:137]
    v_lshlrev_b32_e64 v200, 16, v201
    v_and_b32 v201, 0xffff0000, v201
    v_pk_mul_f32 v[200:201], v[184:185], v[200:201] op_sel:[1,0] op_sel_hi:[1,1]
    v_cvt_pk_bf16_f32 v201, v200, v201
    v_lshlrev_b32_e64 v200, 16, v201
    v_and_b32 v201, 0xffff0000, v201
    v_pk_fma_f32 v[36:37], v[184:185], v[128:129], v[200:201] op_sel_hi:[0,1,1]
    v_pk_add_f32 v[202:203], v[202:203], v[142:143]
    v_pk_add_f32 v[130:131], v[130:131], v[134:135]
    v_pk_add_f32 v[138:139], v[138:139], v[38:39]
    v_cvt_pk_bf16_f32 v203, v202, v203
    v_pk_add_f32 v[130:131], v[130:131], v[138:139]
    v_lshlrev_b32_e64 v202, 16, v203
    v_and_b32 v203, 0xffff0000, v203
    v_pk_mul_f32 v[202:203], v[184:185], v[202:203] op_sel:[1,0] op_sel_hi:[1,1]
    v_cvt_pk_bf16_f32 v203, v202, v203
    v_lshlrev_b32_e64 v202, 16, v203
    v_and_b32 v203, 0xffff0000, v203
    v_pk_fma_f32 v[38:39], v[184:185], v[130:131], v[202:203] op_sel_hi:[0,1,1]
    buffer_store_dwordx4 v[36:39], v2, s[84:87], s71 offen offset:128 nt
    s_waitcnt lgkmcnt(4)
    s_nop 0
    v_pk_add_f32 v[204:205], v[204:205], v[156:157]
    v_pk_add_f32 v[144:145], v[144:145], v[148:149]
    v_pk_add_f32 v[152:153], v[152:153], v[40:41]
    v_cvt_pk_bf16_f32 v205, v204, v205
    v_pk_add_f32 v[144:145], v[144:145], v[152:153]
    v_lshlrev_b32_e64 v204, 16, v205
    v_and_b32 v205, 0xffff0000, v205
    v_pk_mul_f32 v[204:205], v[184:185], v[204:205] op_sel:[1,0] op_sel_hi:[1,1]
    v_cvt_pk_bf16_f32 v205, v204, v205
    v_lshlrev_b32_e64 v204, 16, v205
    v_and_b32 v205, 0xffff0000, v205
    v_pk_fma_f32 v[40:41], v[184:185], v[144:145], v[204:205] op_sel_hi:[0,1,1]
    v_pk_add_f32 v[206:207], v[206:207], v[158:159]
    v_pk_add_f32 v[146:147], v[146:147], v[150:151]
    v_pk_add_f32 v[154:155], v[154:155], v[42:43]
    v_cvt_pk_bf16_f32 v207, v206, v207
    v_pk_add_f32 v[146:147], v[146:147], v[154:155]
    v_lshlrev_b32_e64 v206, 16, v207
    v_and_b32 v207, 0xffff0000, v207
    v_pk_mul_f32 v[206:207], v[184:185], v[206:207] op_sel:[1,0] op_sel_hi:[1,1]
    v_cvt_pk_bf16_f32 v207, v206, v207
    v_lshlrev_b32_e64 v206, 16, v207
    v_and_b32 v207, 0xffff0000, v207
    v_pk_fma_f32 v[42:43], v[184:185], v[146:147], v[206:207] op_sel_hi:[0,1,1]
    buffer_store_dwordx4 v[40:43], v2, s[84:87], s71 offen offset:192 nt
    s_waitcnt lgkmcnt(0)
    s_nop 0
    v_pk_add_f32 v[52:53], v[52:53], v[172:173]
    v_pk_add_f32 v[160:161], v[160:161], v[164:165]
    v_pk_add_f32 v[168:169], v[168:169], v[44:45]
    v_cvt_pk_bf16_f32 v53, v52, v53
    v_pk_add_f32 v[160:161], v[160:161], v[168:169]
    v_lshlrev_b32_e64 v52, 16, v53
    v_and_b32 v53, 0xffff0000, v53
    v_pk_mul_f32 v[52:53], v[184:185], v[52:53] op_sel:[1,0] op_sel_hi:[1,1]
    v_cvt_pk_bf16_f32 v53, v52, v53
    v_lshlrev_b32_e64 v52, 16, v53
    v_and_b32 v53, 0xffff0000, v53
    v_pk_fma_f32 v[44:45], v[184:185], v[160:161], v[52:53] op_sel_hi:[0,1,1]
    v_pk_add_f32 v[54:55], v[54:55], v[174:175]
    v_pk_add_f32 v[162:163], v[162:163], v[166:167]
    v_pk_add_f32 v[170:171], v[170:171], v[46:47]
    v_cvt_pk_bf16_f32 v55, v54, v55
    v_pk_add_f32 v[162:163], v[162:163], v[170:171]
    v_lshlrev_b32_e64 v54, 16, v55
    v_and_b32 v55, 0xffff0000, v55
    v_pk_mul_f32 v[54:55], v[184:185], v[54:55] op_sel:[1,0] op_sel_hi:[1,1]
    v_cvt_pk_bf16_f32 v55, v54, v55
    v_lshlrev_b32_e64 v54, 16, v55
    v_and_b32 v55, 0xffff0000, v55
    v_pk_fma_f32 v[46:47], v[184:185], v[162:163], v[54:55] op_sel_hi:[0,1,1]
    buffer_store_dwordx4 v[44:47], v2, s[84:87], s71 offen offset:256 nt
    s_endpgm
L_ssm:
    s_lshr_b32 s44, s38, 1
    s_and_b32 s45, s38, 1
    s_and_b32 s45, s38, 1
    s_mov_b32 s48, s6
    s_mov_b32 s49, s7
    s_mov_b32 s50, 0x500
    s_mov_b32 s51, 0x20000
    s_mov_b32 s52, s8
    s_mov_b32 s53, s9
    s_mov_b32 s54, 0x500
    s_mov_b32 s55, 0x20000
    s_mov_b32 s56, s18
    s_mov_b32 s57, s19
    s_mov_b32 s58, 0x500
    s_mov_b32 s59, 0x20000
    s_lshl_b32 s46, s40, 6
    s_lshl_b32 s47, s45, 5
    s_add_u32 s46, s46, s47
    v_and_b32 v1, 31, v0
    v_add_u32 v2, s46, v1
    v_lshlrev_b32 v2, 1, v2
    buffer_load_ushort v152, v2, s[48:51], 0 offen
    buffer_load_ushort v153, v2, s[52:55], 0 offen
    buffer_load_ushort v154, v2, s[56:59], 0 offen
    v_and_b32 v1, 31, v0
    v_bfe_u32 v2, v0, 2, 1
    v_lshlrev_b32 v2, 6, v2
    v_and_b32 v3, 1, v0
    v_lshl_add_u32 v2, v3, 5, v2
    v_bfe_u32 v4, v0, 1, 1
    v_add_u32 v2, v2, v4
    v_bfe_u32 v4, v0, 3, 2
    v_lshl_add_u32 v2, v4, 1, v2
    v_lshl_or_b32 v3, v3, 2, v4
    v_lshrrev_b32 v4, 5, v0
    v_xor_b32 v3, v3, v4
    v_lshlrev_b32 v3, 4, v3
    v_lshl_add_u32 v3, v2, 7, v3
    s_lshl_b32 s47, s44, 14
    s_add_u32 s47, s47, 65536
    v_add_u32 v4, s47, v3
    v_xor_b32 v5, 32, v4
    v_xor_b32 v6, 64, v4
    v_xor_b32 v7, 96, v4
    v_lshrrev_b32 v2, 5, v0
    v_bfe_u32 v3, v0, 1, 3
    v_xor_b32 v3, v3, v2
    v_lshlrev_b32 v3, 4, v3
    v_lshl_add_u32 v3, v1, 7, v3
    s_lshl_b32 s47, s45, 12
    s_add_u32 s47, s47, 131072
    v_add_u32 v8, s47, v3
    v_xor_b32 v9, 32, v8
    v_xor_b32 v10, 64, v8
    v_xor_b32 v11, 96, v8
    v_mov_b32 v15, 163832
    v_mov_b32 v16, 0
    v_mov_b32 v17, 0
    v_mov_b32 v18, 0
    v_mov_b32 v19, 0
    v_mov_b32 v20, 0
    v_mov_b32 v21, 0
    v_mov_b32 v22, 0
    v_mov_b32 v23, 0
    v_mov_b32 v24, 0
    v_mov_b32 v25, 0
    v_mov_b32 v26, 0
    v_mov_b32 v27, 0
    v_mov_b32 v28, 0
    v_mov_b32 v29, 0
    v_mov_b32 v30, 0
    v_mov_b32 v31, 0
    v_mov_b32 v32, 0
    v_mov_b32 v33, 0
    v_mov_b32 v34, 0
    v_mov_b32 v35, 0
    v_mov_b32 v36, 0
    v_mov_b32 v37, 0
    v_mov_b32 v38, 0
    v_mov_b32 v39, 0
    v_mov_b32 v40, 0
    v_mov_b32 v41, 0
    v_mov_b32 v42, 0
    v_mov_b32 v43, 0
    v_mov_b32 v44, 0
    v_mov_b32 v45, 0
    v_mov_b32 v46, 0
    v_mov_b32 v47, 0
    v_mov_b32 v48, 0
    v_mov_b32 v49, 0
    v_mov_b32 v50, 0
    v_mov_b32 v51, 0
    v_mov_b32 v52, 0
    v_mov_b32 v53, 0
    v_mov_b32 v54, 0
    v_mov_b32 v55, 0
    v_mov_b32 v56, 0
    v_mov_b32 v57, 0
    v_mov_b32 v58, 0
    v_mov_b32 v59, 0
    v_mov_b32 v60, 0
    v_mov_b32 v61, 0
    v_mov_b32 v62, 0
    v_mov_b32 v63, 0
    v_mov_b32 v64, 0
    v_mov_b32 v65, 0
    v_mov_b32 v66, 0
    v_mov_b32 v67, 0
    v_mov_b32 v68, 0
    v_mov_b32 v69, 0
    v_mov_b32 v70, 0
    v_mov_b32 v71, 0
    v_mov_b32 v72, 0
    v_mov_b32 v73, 0
    v_mov_b32 v74, 0
    v_mov_b32 v75, 0
    v_mov_b32 v76, 0
    v_mov_b32 v77, 0
    v_mov_b32 v78, 0
    v_mov_b32 v79, 0
    v_mov_b32 v80, 0
    v_mov_b32 v81, 0
    v_mov_b32 v82, 0
    v_mov_b32 v83, 0
    v_mov_b32 v84, 0
    v_mov_b32 v85, 0
    v_mov_b32 v86, 0
    v_mov_b32 v87, 0
    v_mov_b32 v88, 0
    v_mov_b32 v89, 0
    v_mov_b32 v90, 0
    v_mov_b32 v91, 0
    v_mov_b32 v92, 0
    v_mov_b32 v93, 0
    v_mov_b32 v94, 0
    v_mov_b32 v95, 0
    v_mov_b32 v96, 0
    v_mov_b32 v97, 0
    v_mov_b32 v98, 0
    v_mov_b32 v99, 0
    v_mov_b32 v100, 0
    v_mov_b32 v101, 0
    v_mov_b32 v102, 0
    v_mov_b32 v103, 0
    v_mov_b32 v104, 0
    v_mov_b32 v105, 0
    v_mov_b32 v106, 0
    v_mov_b32 v107, 0
    v_mov_b32 v108, 0
    v_mov_b32 v109, 0
    v_mov_b32 v110, 0
    v_mov_b32 v111, 0
    v_mov_b32 v112, 0
    v_mov_b32 v113, 0
    v_mov_b32 v114, 0
    v_mov_b32 v115, 0
    v_mov_b32 v116, 0
    v_mov_b32 v117, 0
    v_mov_b32 v118, 0
    v_mov_b32 v119, 0
    v_mov_b32 v120, 0
    v_mov_b32 v121, 0
    v_mov_b32 v122, 0
    v_mov_b32 v123, 0
    v_mov_b32 v124, 0
    v_mov_b32 v125, 0
    v_mov_b32 v126, 0
    v_mov_b32 v127, 0
    v_mov_b32 v128, 0
    v_mov_b32 v129, 0
    v_mov_b32 v130, 0
    v_mov_b32 v131, 0
    v_mov_b32 v132, 0
    v_mov_b32 v133, 0
    v_mov_b32 v134, 0
    v_mov_b32 v135, 0
    v_mov_b32 v136, 0
    v_mov_b32 v137, 0
    v_mov_b32 v138, 0
    v_mov_b32 v139, 0
    v_mov_b32 v140, 0
    v_mov_b32 v141, 0
    v_mov_b32 v142, 0
    v_mov_b32 v143, 0
    s_waitcnt vmcnt(0)
    v_lshlrev_b32 v152, 16, v152
    v_lshlrev_b32 v153, 16, v153
    v_lshlrev_b32 v154, 16, v154
    v_mul_f32 v154, 0x3fb8aa3b, v154
    v_exp_f32 v154, v154
    s_nop 0
    v_cvt_pk_bf16_f32 v154, v154, v154
    v_lshlrev_b32 v154, 16, v154
    v_mul_f32 v155, v154, v152
    v_mul_f32 v156, v154, v153
    v_mul_f32 v155, 0x3fb8aa3b, v155
    v_exp_f32 v155, v155
    v_mul_f32 v156, 0.15915494, v156
    v_rndne_f32 v157, v156
    v_sub_f32 v156, v156, v157
    v_cos_f32 v157, v156
    v_sin_f32 v158, v156
    s_nop 0
    v_mul_f32 v144, v155, v157
    v_mul_f32 v145, v155, v158
    v_mul_f32 v155, v152, v152
    v_fma_f32 v155, v153, v153, v155
    v_rcp_f32 v155, v155
    v_add_f32 v156, -1.0, v144
    v_mul_f32 v157, v156, v152
    v_fma_f32 v157, v145, v153, v157
    v_mul_f32 v158, v145, v152
    v_fma_f32 v158, -v156, v153, v158
    v_add_f32 v155, v155, v155
    v_mul_f32 v150, v157, v155
    v_mul_f32 v151, v158, v155
    v_mul_f32 v152, v144, v144
    v_mul_f32 v153, v144, v145
    v_fma_f32 v152, -v145, v145, v152
    v_fma_f32 v147, v145, v144, v153
    v_mov_b32 v146, v152
    v_mul_f32 v152, v146, v146
    v_mul_f32 v153, v146, v147
    v_fma_f32 v152, -v147, v147, v152
    v_fma_f32 v147, v147, v146, v153
    v_mov_b32 v146, v152
    v_mul_f32 v152, v146, v146
    v_mul_f32 v153, v146, v147
    v_fma_f32 v152, -v147, v147, v152
    v_fma_f32 v147, v147, v146, v153
    v_mov_b32 v146, v152
    v_mul_f32 v152, v146, v146
    v_mul_f32 v153, v146, v147
    v_fma_f32 v152, -v147, v147, v152
    v_fma_f32 v147, v147, v146, v153
    v_mov_b32 v146, v152
    v_mul_f32 v152, v146, v146
    v_mul_f32 v153, v146, v147
    v_fma_f32 v152, -v147, v147, v152
    v_fma_f32 v147, v147, v146, v153
    v_mov_b32 v146, v152
    v_mul_f32 v152, v146, v146
    v_mul_f32 v153, v146, v147
    v_fma_f32 v152, -v147, v147, v152
    v_fma_f32 v173, v147, v146, v153
    v_mov_b32 v172, v152
    v_mul_f32 v152, v172, v172
    v_mul_f32 v153, v172, v173
    v_fma_f32 v152, -v173, v173, v152
    v_fma_f32 v175, v173, v172, v153
    v_mov_b32 v174, v152
    v_mul_f32 v152, v174, v174
    v_mul_f32 v153, v174, v175
    v_fma_f32 v152, -v175, v175, v152
    v_fma_f32 v149, v175, v174, v153
    v_mov_b32 v148, v152
    s_mov_b32 s70, 0
    s_mov_b32 s71, -1
    v_mul_f32 v152, v150, v172
    v_mul_f32 v153, v150, v173
    v_fma_f32 v152, -v151, v173, v152
    v_fma_f32 v225, v151, v172, v153
    v_mov_b32 v224, v152
    v_cndmask_b32 v164, v150, v224, s[70:71]
    v_cndmask_b32 v166, v151, v225, s[70:71]
    v_mul_f32 v152, v164, v146
    v_mul_f32 v153, v164, v147
    v_fma_f32 v152, -v166, v147, v152
    v_fma_f32 v167, v166, v146, v153
    v_mov_b32 v165, v152
    s_lshl_b32 s47, s39, 1
    s_add_u32 s47, s47, s44
    s_lshl_b32 s47, s47, 9
    s_sub_u32 s47, s47, 8192
    v_lshlrev_b32 v3, 4, v0
    v_add_u32 v224, s47, v3
    s_add_u32 s47, s47, 1024
    v_ashrrev_i32 v232, 31, v224
    v_not_b32 v232, v232
    v_add_u32 v225, s47, v3
    s_add_u32 s47, s47, 1024
    v_ashrrev_i32 v233, 31, v225
    v_not_b32 v233, v233
    v_add_u32 v226, s47, v3
    s_add_u32 s47, s47, 1024
    v_ashrrev_i32 v234, 31, v226
    v_not_b32 v234, v234
    v_add_u32 v227, s47, v3
    s_add_u32 s47, s47, 1024
    v_ashrrev_i32 v235, 31, v227
    v_not_b32 v235, v235
    v_add_u32 v228, s47, v3
    s_add_u32 s47, s47, 1024
    v_ashrrev_i32 v236, 31, v228
    v_not_b32 v236, v236
    v_add_u32 v229, s47, v3
    s_add_u32 s47, s47, 1024
    v_ashrrev_i32 v237, 31, v229
    v_not_b32 v237, v237
    v_add_u32 v230, s47, v3
    s_add_u32 s47, s47, 1024
    v_ashrrev_i32 v238, 31, v230
    v_not_b32 v238, v238
    v_add_u32 v231, s47, v3
    s_add_u32 s47, s47, 1024
    v_ashrrev_i32 v239, 31, v231
    v_not_b32 v239, v239
    s_mov_b32 s52, 0
    s_mov_b32 s53, 2
    s_mov_b32 s55, 32768
    s_mov_b32 s57, 16384
    s_barrier
    s_nop 0
    ds_read_b128 v[208:211], v8
    ds_read_b128 v[176:179], v4
    ds_read_b128 v[212:215], v8 offset:8192
    ds_read_b128 v[180:183], v6 offset:1024
    ds_read_b128 v[184:187], v4 offset:2048
    ds_read_b128 v[188:191], v6 offset:3072
Ls_loop:
    s_waitcnt lgkmcnt(4)
    s_nop 0
    v_mfma_f32_32x32x16_bf16 v[16:31], v[176:179], v[208:211], v[16:31]
    ds_read_b128 v[216:219], v9
    ds_read_b128 v[192:195], v5
    s_waitcnt lgkmcnt(5)
    s_nop 0
    v_mfma_f32_32x32x16_bf16 v[32:47], v[176:179], v[212:215], v[32:47]
    ds_read_b128 v[220:223], v9 offset:8192
    ds_read_b128 v[196:199], v7 offset:1024
    s_waitcnt lgkmcnt(6)
    s_nop 0
    v_mfma_f32_32x32x16_bf16 v[48:63], v[180:183], v[208:211], v[48:63]
    ds_read_b128 v[200:203], v5 offset:2048
    ds_read_b128 v[204:207], v7 offset:3072
    v_mfma_f32_32x32x16_bf16 v[64:79], v[180:183], v[212:215], v[64:79]
    s_waitcnt lgkmcnt(7)
    v_mfma_f32_32x32x16_bf16 v[80:95], v[184:187], v[208:211], v[80:95]
    v_mfma_f32_32x32x16_bf16 v[96:111], v[184:187], v[212:215], v[96:111]
    s_waitcnt lgkmcnt(6)
    v_mfma_f32_32x32x16_bf16 v[112:127], v[188:191], v[208:211], v[112:127]
    v_mfma_f32_32x32x16_bf16 v[128:143], v[188:191], v[212:215], v[128:143]
    ds_read_b32 v14, v15
    s_waitcnt lgkmcnt(5)
    s_nop 0
    v_mfma_f32_32x32x16_bf16 v[16:31], v[192:195], v[216:219], v[16:31]
    ds_read_b128 v[208:211], v10
    ds_read_b128 v[176:179], v6
    s_waitcnt lgkmcnt(6)
    s_nop 0
    v_mfma_f32_32x32x16_bf16 v[32:47], v[192:195], v[220:223], v[32:47]
    ds_read_b128 v[212:215], v10 offset:8192
    ds_read_b128 v[180:183], v4 offset:1024
    s_waitcnt lgkmcnt(7)
    s_nop 0
    v_mfma_f32_32x32x16_bf16 v[48:63], v[196:199], v[216:219], v[48:63]
    ds_read_b128 v[184:187], v6 offset:2048
    ds_read_b128 v[188:191], v4 offset:3072
    v_mfma_f32_32x32x16_bf16 v[64:79], v[196:199], v[220:223], v[64:79]
    s_waitcnt lgkmcnt(8)
    v_mfma_f32_32x32x16_bf16 v[80:95], v[200:203], v[216:219], v[80:95]
    v_mfma_f32_32x32x16_bf16 v[96:111], v[200:203], v[220:223], v[96:111]
    s_waitcnt lgkmcnt(7)
    v_mfma_f32_32x32x16_bf16 v[112:127], v[204:207], v[216:219], v[112:127]
    v_mfma_f32_32x32x16_bf16 v[128:143], v[204:207], v[220:223], v[128:143]
    s_waitcnt lgkmcnt(4)
    s_nop 0
    v_mfma_f32_32x32x16_bf16 v[16:31], v[176:179], v[208:211], v[16:31]
    ds_read_b128 v[216:219], v11
    ds_read_b128 v[192:195], v7
    s_waitcnt lgkmcnt(5)
    s_nop 0
    v_mfma_f32_32x32x16_bf16 v[32:47], v[176:179], v[212:215], v[32:47]
    ds_read_b128 v[220:223], v11 offset:8192
    ds_read_b128 v[196:199], v5 offset:1024
    s_waitcnt lgkmcnt(6)
    s_nop 0
    v_mfma_f32_32x32x16_bf16 v[48:63], v[180:183], v[208:211], v[48:63]
    ds_read_b128 v[200:203], v7 offset:2048
    ds_read_b128 v[204:207], v5 offset:3072
    v_mfma_f32_32x32x16_bf16 v[64:79], v[180:183], v[212:215], v[64:79]
    s_waitcnt lgkmcnt(7)
    v_mfma_f32_32x32x16_bf16 v[80:95], v[184:187], v[208:211], v[80:95]
    v_mfma_f32_32x32x16_bf16 v[96:111], v[184:187], v[212:215], v[96:111]
    s_waitcnt lgkmcnt(6)
    v_mfma_f32_32x32x16_bf16 v[112:127], v[188:191], v[208:211], v[112:127]
    v_mfma_f32_32x32x16_bf16 v[128:143], v[188:191], v[212:215], v[128:143]
    s_waitcnt lgkmcnt(4)
    v_mfma_f32_32x32x16_bf16 v[16:31], v[192:195], v[216:219], v[16:31]
    s_add_u32 s52, s52, 1
    s_add_u32 s53, s53, 1
    s_cmp_eq_u32 s53, 3
    s_cselect_b32 s54, 0xffff0000, s55
    s_cselect_b32 s56, 0xffff8000, s57
    s_cselect_b32 s53, 0, s53
    v_add_u32 v4, s54, v4
    s_waitcnt lgkmcnt(3)
    v_mfma_f32_32x32x16_bf16 v[32:47], v[192:195], v[220:223], v[32:47]
    v_add_u32 v5, s54, v5
    v_add_u32 v6, s54, v6
    v_add_u32 v7, s54, v7
    v_add_u32 v8, s56, v8
    s_waitcnt lgkmcnt(2)
    v_mfma_f32_32x32x16_bf16 v[48:63], v[196:199], v[216:219], v[48:63]
    v_add_u32 v9, s56, v9
    v_add_u32 v10, s56, v10
    v_add_u32_e64 v11, s56, v11
    s_waitcnt lgkmcnt(0)
    s_barrier
    ds_read_b128 v[208:211], v8
    ds_read_b128 v[176:179], v4
    v_mfma_f32_32x32x16_bf16 v[64:79], v[196:199], v[220:223], v[64:79]
    ds_read_b128 v[212:215], v8 offset:8192
    ds_read_b128 v[180:183], v6 offset:1024
    v_mfma_f32_32x32x16_bf16 v[80:95], v[200:203], v[216:219], v[80:95]
    ds_read_b128 v[184:187], v4 offset:2048
    ds_read_b128 v[188:191], v6 offset:3072
    v_mfma_f32_32x32x16_bf16 v[96:111], v[200:203], v[220:223], v[96:111]
    v_mfma_f32_32x32x16_bf16 v[112:127], v[204:207], v[216:219], v[112:127]
    v_mfma_f32_32x32x16_bf16 v[128:143], v[204:207], v[220:223], v[128:143]
    s_cmp_lt_u32 s52, 10
    s_cbranch_scc1 Ls_loop
    s_waitcnt lgkmcnt(0)
    s_setprio 3
    v_readfirstlane_b32 s64, v14
    s_lshl_b32 s46, s40, 1
    s_add_u32 s46, s46, s45
    s_lshl_b32 s46, s46, 13
    s_add_u32 s46, s46, 0x1010000
    s_add_u32 s48, s36, s46
    s_addc_u32 s49, s37, 0
    s_movk_i32 s50, 8192
    s_mov_b32 s51, 0x20000
    s_lshl_b32 s46, s39, 1
    s_add_u32 s46, s46, s44
    s_lshl_b32 s47, s46, 9
    v_lshlrev_b32 v3, 4, v0
    s_nop 3
    v_pk_fma_f32 v[156:157], v[144:145], v[16:17], v[18:19] op_sel_hi:[0,1,1]
    v_pk_fma_f32 v[158:159], v[144:145], v[32:33], v[34:35] op_sel_hi:[0,1,1]
    v_pk_fma_f32 v[156:157], v[144:145], v[32:33], v[156:157] op_sel:[1,0,0] op_sel_hi:[1,1,1] neg_lo:[1,0,0] neg_hi:[1,0,0]
    v_pk_fma_f32 v[158:159], v[144:145], v[16:17], v[158:159] op_sel:[1,0,0] op_sel_hi:[1,1,1]
    v_pk_fma_f32 v[152:153], v[144:145], v[156:157], v[20:21] op_sel_hi:[0,1,1]
    v_pk_fma_f32 v[154:155], v[144:145], v[158:159], v[36:37] op_sel_hi:[0,1,1]
    v_pk_fma_f32 v[152:153], v[144:145], v[158:159], v[152:153] op_sel:[1,0,0] op_sel_hi:[1,1,1] neg_lo:[1,0,0] neg_hi:[1,0,0]
    v_pk_fma_f32 v[154:155], v[144:145], v[156:157], v[154:155] op_sel:[1,0,0] op_sel_hi:[1,1,1]
    v_pk_fma_f32 v[156:157], v[144:145], v[152:153], v[22:23] op_sel_hi:[0,1,1]
    v_pk_fma_f32 v[158:159], v[144:145], v[154:155], v[38:39] op_sel_hi:[0,1,1]
    v_pk_fma_f32 v[156:157], v[144:145], v[154:155], v[156:157] op_sel:[1,0,0] op_sel_hi:[1,1,1] neg_lo:[1,0,0] neg_hi:[1,0,0]
    v_pk_fma_f32 v[158:159], v[144:145], v[152:153], v[158:159] op_sel:[1,0,0] op_sel_hi:[1,1,1]
    v_pk_fma_f32 v[152:153], v[144:145], v[156:157], v[24:25] op_sel_hi:[0,1,1]
    v_pk_fma_f32 v[154:155], v[144:145], v[158:159], v[40:41] op_sel_hi:[0,1,1]
    v_pk_fma_f32 v[152:153], v[144:145], v[158:159], v[152:153] op_sel:[1,0,0] op_sel_hi:[1,1,1] neg_lo:[1,0,0] neg_hi:[1,0,0]
    v_pk_fma_f32 v[154:155], v[144:145], v[156:157], v[154:155] op_sel:[1,0,0] op_sel_hi:[1,1,1]
    v_pk_fma_f32 v[156:157], v[144:145], v[152:153], v[26:27] op_sel_hi:[0,1,1]
    v_pk_fma_f32 v[158:159], v[144:145], v[154:155], v[42:43] op_sel_hi:[0,1,1]
    v_pk_fma_f32 v[156:157], v[144:145], v[154:155], v[156:157] op_sel:[1,0,0] op_sel_hi:[1,1,1] neg_lo:[1,0,0] neg_hi:[1,0,0]
    v_pk_fma_f32 v[158:159], v[144:145], v[152:153], v[158:159] op_sel:[1,0,0] op_sel_hi:[1,1,1]
    v_pk_fma_f32 v[152:153], v[144:145], v[156:157], v[28:29] op_sel_hi:[0,1,1]
    v_pk_fma_f32 v[154:155], v[144:145], v[158:159], v[44:45] op_sel_hi:[0,1,1]
    v_pk_fma_f32 v[152:153], v[144:145], v[158:159], v[152:153] op_sel:[1,0,0] op_sel_hi:[1,1,1] neg_lo:[1,0,0] neg_hi:[1,0,0]
    v_pk_fma_f32 v[154:155], v[144:145], v[156:157], v[154:155] op_sel:[1,0,0] op_sel_hi:[1,1,1]
    v_pk_fma_f32 v[156:157], v[144:145], v[152:153], v[30:31] op_sel_hi:[0,1,1]
    v_pk_fma_f32 v[158:159], v[144:145], v[154:155], v[46:47] op_sel_hi:[0,1,1]
    v_pk_fma_f32 v[156:157], v[144:145], v[154:155], v[156:157] op_sel:[1,0,0] op_sel_hi:[1,1,1] neg_lo:[1,0,0] neg_hi:[1,0,0]
    v_pk_fma_f32 v[158:159], v[144:145], v[152:153], v[158:159] op_sel:[1,0,0] op_sel_hi:[1,1,1]
    v_pk_fma_f32 v[152:153], v[144:145], v[156:157], v[48:49] op_sel_hi:[0,1,1]
    v_pk_fma_f32 v[154:155], v[144:145], v[158:159], v[64:65] op_sel_hi:[0,1,1]
    v_pk_fma_f32 v[152:153], v[144:145], v[158:159], v[152:153] op_sel:[1,0,0] op_sel_hi:[1,1,1] neg_lo:[1,0,0] neg_hi:[1,0,0]
    v_pk_fma_f32 v[154:155], v[144:145], v[156:157], v[154:155] op_sel:[1,0,0] op_sel_hi:[1,1,1]
    v_pk_fma_f32 v[156:157], v[144:145], v[152:153], v[50:51] op_sel_hi:[0,1,1]
    v_pk_fma_f32 v[158:159], v[144:145], v[154:155], v[66:67] op_sel_hi:[0,1,1]
    v_pk_fma_f32 v[156:157], v[144:145], v[154:155], v[156:157] op_sel:[1,0,0] op_sel_hi:[1,1,1] neg_lo:[1,0,0] neg_hi:[1,0,0]
    v_pk_fma_f32 v[158:159], v[144:145], v[152:153], v[158:159] op_sel:[1,0,0] op_sel_hi:[1,1,1]
    v_pk_fma_f32 v[152:153], v[144:145], v[156:157], v[52:53] op_sel_hi:[0,1,1]
    v_pk_fma_f32 v[154:155], v[144:145], v[158:159], v[68:69] op_sel_hi:[0,1,1]
    v_pk_fma_f32 v[152:153], v[144:145], v[158:159], v[152:153] op_sel:[1,0,0] op_sel_hi:[1,1,1] neg_lo:[1,0,0] neg_hi:[1,0,0]
    v_pk_fma_f32 v[154:155], v[144:145], v[156:157], v[154:155] op_sel:[1,0,0] op_sel_hi:[1,1,1]
    v_pk_fma_f32 v[156:157], v[144:145], v[152:153], v[54:55] op_sel_hi:[0,1,1]
    v_pk_fma_f32 v[158:159], v[144:145], v[154:155], v[70:71] op_sel_hi:[0,1,1]
    v_pk_fma_f32 v[156:157], v[144:145], v[154:155], v[156:157] op_sel:[1,0,0] op_sel_hi:[1,1,1] neg_lo:[1,0,0] neg_hi:[1,0,0]
    v_pk_fma_f32 v[158:159], v[144:145], v[152:153], v[158:159] op_sel:[1,0,0] op_sel_hi:[1,1,1]
    v_pk_fma_f32 v[152:153], v[144:145], v[156:157], v[56:57] op_sel_hi:[0,1,1]
    v_pk_fma_f32 v[154:155], v[144:145], v[158:159], v[72:73] op_sel_hi:[0,1,1]
    v_pk_fma_f32 v[152:153], v[144:145], v[158:159], v[152:153] op_sel:[1,0,0] op_sel_hi:[1,1,1] neg_lo:[1,0,0] neg_hi:[1,0,0]
    v_pk_fma_f32 v[154:155], v[144:145], v[156:157], v[154:155] op_sel:[1,0,0] op_sel_hi:[1,1,1]
    v_pk_fma_f32 v[156:157], v[144:145], v[152:153], v[58:59] op_sel_hi:[0,1,1]
    v_pk_fma_f32 v[158:159], v[144:145], v[154:155], v[74:75] op_sel_hi:[0,1,1]
    v_pk_fma_f32 v[156:157], v[144:145], v[154:155], v[156:157] op_sel:[1,0,0] op_sel_hi:[1,1,1] neg_lo:[1,0,0] neg_hi:[1,0,0]
    v_pk_fma_f32 v[158:159], v[144:145], v[152:153], v[158:159] op_sel:[1,0,0] op_sel_hi:[1,1,1]
    v_pk_fma_f32 v[152:153], v[144:145], v[156:157], v[60:61] op_sel_hi:[0,1,1]
    v_pk_fma_f32 v[154:155], v[144:145], v[158:159], v[76:77] op_sel_hi:[0,1,1]
    v_pk_fma_f32 v[152:153], v[144:145], v[158:159], v[152:153] op_sel:[1,0,0] op_sel_hi:[1,1,1] neg_lo:[1,0,0] neg_hi:[1,0,0]
    v_pk_fma_f32 v[154:155], v[144:145], v[156:157], v[154:155] op_sel:[1,0,0] op_sel_hi:[1,1,1]
    v_pk_fma_f32 v[156:157], v[144:145], v[152:153], v[62:63] op_sel_hi:[0,1,1]
    v_pk_fma_f32 v[158:159], v[144:145], v[154:155], v[78:79] op_sel_hi:[0,1,1]
    v_pk_fma_f32 v[156:157], v[144:145], v[154:155], v[156:157] op_sel:[1,0,0] op_sel_hi:[1,1,1] neg_lo:[1,0,0] neg_hi:[1,0,0]
    v_pk_fma_f32 v[158:159], v[144:145], v[152:153], v[158:159] op_sel:[1,0,0] op_sel_hi:[1,1,1]
    v_pk_fma_f32 v[152:153], v[144:145], v[156:157], v[80:81] op_sel_hi:[0,1,1]
    v_pk_fma_f32 v[154:155], v[144:145], v[158:159], v[96:97] op_sel_hi:[0,1,1]
    v_pk_fma_f32 v[152:153], v[144:145], v[158:159], v[152:153] op_sel:[1,0,0] op_sel_hi:[1,1,1] neg_lo:[1,0,0] neg_hi:[1,0,0]
    v_pk_fma_f32 v[154:155], v[144:145], v[156:157], v[154:155] op_sel:[1,0,0] op_sel_hi:[1,1,1]
    v_pk_fma_f32 v[156:157], v[144:145], v[152:153], v[82:83] op_sel_hi:[0,1,1]
    v_pk_fma_f32 v[158:159], v[144:145], v[154:155], v[98:99] op_sel_hi:[0,1,1]
    v_pk_fma_f32 v[156:157], v[144:145], v[154:155], v[156:157] op_sel:[1,0,0] op_sel_hi:[1,1,1] neg_lo:[1,0,0] neg_hi:[1,0,0]
    v_pk_fma_f32 v[158:159], v[144:145], v[152:153], v[158:159] op_sel:[1,0,0] op_sel_hi:[1,1,1]
    v_pk_fma_f32 v[152:153], v[144:145], v[156:157], v[84:85] op_sel_hi:[0,1,1]
    v_pk_fma_f32 v[154:155], v[144:145], v[158:159], v[100:101] op_sel_hi:[0,1,1]
    v_pk_fma_f32 v[152:153], v[144:145], v[158:159], v[152:153] op_sel:[1,0,0] op_sel_hi:[1,1,1] neg_lo:[1,0,0] neg_hi:[1,0,0]
    v_pk_fma_f32 v[154:155], v[144:145], v[156:157], v[154:155] op_sel:[1,0,0] op_sel_hi:[1,1,1]
    v_pk_fma_f32 v[156:157], v[144:145], v[152:153], v[86:87] op_sel_hi:[0,1,1]
    v_pk_fma_f32 v[158:159], v[144:145], v[154:155], v[102:103] op_sel_hi:[0,1,1]
    v_pk_fma_f32 v[156:157], v[144:145], v[154:155], v[156:157] op_sel:[1,0,0] op_sel_hi:[1,1,1] neg_lo:[1,0,0] neg_hi:[1,0,0]
    v_pk_fma_f32 v[158:159], v[144:145], v[152:153], v[158:159] op_sel:[1,0,0] op_sel_hi:[1,1,1]
    v_pk_fma_f32 v[152:153], v[144:145], v[156:157], v[88:89] op_sel_hi:[0,1,1]
    v_pk_fma_f32 v[154:155], v[144:145], v[158:159], v[104:105] op_sel_hi:[0,1,1]
    v_pk_fma_f32 v[152:153], v[144:145], v[158:159], v[152:153] op_sel:[1,0,0] op_sel_hi:[1,1,1] neg_lo:[1,0,0] neg_hi:[1,0,0]
    v_pk_fma_f32 v[154:155], v[144:145], v[156:157], v[154:155] op_sel:[1,0,0] op_sel_hi:[1,1,1]
    v_pk_fma_f32 v[156:157], v[144:145], v[152:153], v[90:91] op_sel_hi:[0,1,1]
    v_pk_fma_f32 v[158:159], v[144:145], v[154:155], v[106:107] op_sel_hi:[0,1,1]
    v_pk_fma_f32 v[156:157], v[144:145], v[154:155], v[156:157] op_sel:[1,0,0] op_sel_hi:[1,1,1] neg_lo:[1,0,0] neg_hi:[1,0,0]
    v_pk_fma_f32 v[158:159], v[144:145], v[152:153], v[158:159] op_sel:[1,0,0] op_sel_hi:[1,1,1]
    v_pk_fma_f32 v[152:153], v[144:145], v[156:157], v[92:93] op_sel_hi:[0,1,1]
    v_pk_fma_f32 v[154:155], v[144:145], v[158:159], v[108:109] op_sel_hi:[0,1,1]
    v_pk_fma_f32 v[152:153], v[144:145], v[158:159], v[152:153] op_sel:[1,0,0] op_sel_hi:[1,1,1] neg_lo:[1,0,0] neg_hi:[1,0,0]
    v_pk_fma_f32 v[154:155], v[144:145], v[156:157], v[154:155] op_sel:[1,0,0] op_sel_hi:[1,1,1]
    v_pk_fma_f32 v[156:157], v[144:145], v[152:153], v[94:95] op_sel_hi:[0,1,1]
    v_pk_fma_f32 v[158:159], v[144:145], v[154:155], v[110:111] op_sel_hi:[0,1,1]
    v_pk_fma_f32 v[156:157], v[144:145], v[154:155], v[156:157] op_sel:[1,0,0] op_sel_hi:[1,1,1] neg_lo:[1,0,0] neg_hi:[1,0,0]
    v_pk_fma_f32 v[158:159], v[144:145], v[152:153], v[158:159] op_sel:[1,0,0] op_sel_hi:[1,1,1]
    v_pk_fma_f32 v[152:153], v[144:145], v[156:157], v[112:113] op_sel_hi:[0,1,1]
    v_pk_fma_f32 v[154:155], v[144:145], v[158:159], v[128:129] op_sel_hi:[0,1,1]
    v_pk_fma_f32 v[152:153], v[144:145], v[158:159], v[152:153] op_sel:[1,0,0] op_sel_hi:[1,1,1] neg_lo:[1,0,0] neg_hi:[1,0,0]
    v_pk_fma_f32 v[154:155], v[144:145], v[156:157], v[154:155] op_sel:[1,0,0] op_sel_hi:[1,1,1]
    v_pk_fma_f32 v[156:157], v[144:145], v[152:153], v[114:115] op_sel_hi:[0,1,1]
    v_pk_fma_f32 v[158:159], v[144:145], v[154:155], v[130:131] op_sel_hi:[0,1,1]
    v_pk_fma_f32 v[156:157], v[144:145], v[154:155], v[156:157] op_sel:[1,0,0] op_sel_hi:[1,1,1] neg_lo:[1,0,0] neg_hi:[1,0,0]
    v_pk_fma_f32 v[158:159], v[144:145], v[152:153], v[158:159] op_sel:[1,0,0] op_sel_hi:[1,1,1]
    v_pk_fma_f32 v[152:153], v[144:145], v[156:157], v[116:117] op_sel_hi:[0,1,1]
    v_pk_fma_f32 v[154:155], v[144:145], v[158:159], v[132:133] op_sel_hi:[0,1,1]
    v_pk_fma_f32 v[152:153], v[144:145], v[158:159], v[152:153] op_sel:[1,0,0] op_sel_hi:[1,1,1] neg_lo:[1,0,0] neg_hi:[1,0,0]
    v_pk_fma_f32 v[154:155], v[144:145], v[156:157], v[154:155] op_sel:[1,0,0] op_sel_hi:[1,1,1]
    v_pk_fma_f32 v[156:157], v[144:145], v[152:153], v[118:119] op_sel_hi:[0,1,1]
    v_pk_fma_f32 v[158:159], v[144:145], v[154:155], v[134:135] op_sel_hi:[0,1,1]
    v_pk_fma_f32 v[156:157], v[144:145], v[154:155], v[156:157] op_sel:[1,0,0] op_sel_hi:[1,1,1] neg_lo:[1,0,0] neg_hi:[1,0,0]
    v_pk_fma_f32 v[158:159], v[144:145], v[152:153], v[158:159] op_sel:[1,0,0] op_sel_hi:[1,1,1]
    v_pk_fma_f32 v[152:153], v[144:145], v[156:157], v[120:121] op_sel_hi:[0,1,1]
    v_pk_fma_f32 v[154:155], v[144:145], v[158:159], v[136:137] op_sel_hi:[0,1,1]
    v_pk_fma_f32 v[152:153], v[144:145], v[158:159], v[152:153] op_sel:[1,0,0] op_sel_hi:[1,1,1] neg_lo:[1,0,0] neg_hi:[1,0,0]
    v_pk_fma_f32 v[154:155], v[144:145], v[156:157], v[154:155] op_sel:[1,0,0] op_sel_hi:[1,1,1]
    v_pk_fma_f32 v[156:157], v[144:145], v[152:153], v[122:123] op_sel_hi:[0,1,1]
    v_pk_fma_f32 v[158:159], v[144:145], v[154:155], v[138:139] op_sel_hi:[0,1,1]
    v_pk_fma_f32 v[156:157], v[144:145], v[154:155], v[156:157] op_sel:[1,0,0] op_sel_hi:[1,1,1] neg_lo:[1,0,0] neg_hi:[1,0,0]
    v_pk_fma_f32 v[158:159], v[144:145], v[152:153], v[158:159] op_sel:[1,0,0] op_sel_hi:[1,1,1]
    v_pk_fma_f32 v[152:153], v[144:145], v[156:157], v[124:125] op_sel_hi:[0,1,1]
    v_pk_fma_f32 v[154:155], v[144:145], v[158:159], v[140:141] op_sel_hi:[0,1,1]
    v_pk_fma_f32 v[152:153], v[144:145], v[158:159], v[152:153] op_sel:[1,0,0] op_sel_hi:[1,1,1] neg_lo:[1,0,0] neg_hi:[1,0,0]
    v_pk_fma_f32 v[154:155], v[144:145], v[156:157], v[154:155] op_sel:[1,0,0] op_sel_hi:[1,1,1]
    v_pk_fma_f32 v[156:157], v[144:145], v[152:153], v[126:127] op_sel_hi:[0,1,1]
    v_pk_fma_f32 v[158:159], v[144:145], v[154:155], v[142:143] op_sel_hi:[0,1,1]
    v_pk_fma_f32 v[156:157], v[144:145], v[154:155], v[156:157] op_sel:[1,0,0] op_sel_hi:[1,1,1] neg_lo:[1,0,0] neg_hi:[1,0,0]
    v_pk_fma_f32 v[158:159], v[144:145], v[152:153], v[158:159] op_sel:[1,0,0] op_sel_hi:[1,1,1]
    v_fma_f32 v176, v146, v156, v157
    v_fma_f32 v177, v146, v158, v159
    v_fma_f32 v176, -v147, v158, v176
    v_fma_f32 v177, v147, v156, v177
    v_mov_b32 v178, v176
    v_mov_b32 v179, v177
    v_mov_b32 v153, s64
    v_mov_b32_e64 v155, s64
    v_permlane32_swap_b32 v176, v178
    v_permlane32_swap_b32 v177, v179
    s_nop 1
    v_fma_f32 v152, v172, v176, v178
    v_fma_f32 v154, v172, v177, v179
    v_fma_f32 v152, -v173, v177, v152
    v_fma_f32 v154, v173, v176, v154
    s_mov_b32 exec_hi, 0
    buffer_store_dwordx4 v[152:155], v3, s[48:51], s47 offen sc1
    s_mov_b64 exec, -1
    v_cndmask_b32 v160, 0, v176, s[70:71]
    v_cndmask_b32 v162, 0, v177, s[70:71]
    v_fma_f32 v161, v146, v160, v156
    v_fma_f32 v163, v146, v162, v158
    v_fma_f32 v161, -v147, v162, v161
    v_fma_f32 v163, v147, v160, v163
    v_and_b32 v232, s64, v232
    v_and_b32 v233, s64, v233
    v_and_b32 v234, s64, v234
    v_and_b32 v235, s64, v235
    v_and_b32 v236, s64, v236
    v_and_b32 v237, s64, v237
    v_and_b32 v238, s64, v238
    v_and_b32 v239, s64, v239
    v_pk_mul_f32 v[156:157], v[150:151], v[160:161] op_sel:[1,0] op_sel_hi:[1,1]
    v_pk_mul_f32 v[160:161], v[150:151], v[160:161] op_sel_hi:[0,1]
    v_pk_fma_f32 v[160:161], v[150:151], v[162:163], v[160:161] op_sel:[1,0,0] op_sel_hi:[1,1,1] neg_lo:[1,0,0] neg_hi:[1,0,0]
    v_pk_fma_f32 v[162:163], v[150:151], v[162:163], v[156:157] op_sel_hi:[0,1,1]
    v_pk_mul_f32 v[156:157], v[150:151], v[16:17] op_sel:[1,0] op_sel_hi:[1,1]
    v_pk_mul_f32 v[16:17], v[150:151], v[16:17] op_sel_hi:[0,1]
    v_pk_fma_f32 v[16:17], v[150:151], v[32:33], v[16:17] op_sel:[1,0,0] op_sel_hi:[1,1,1] neg_lo:[1,0,0] neg_hi:[1,0,0]
    v_pk_fma_f32 v[32:33], v[150:151], v[32:33], v[156:157] op_sel_hi:[0,1,1]
    v_pk_mul_f32 v[156:157], v[150:151], v[18:19] op_sel:[1,0] op_sel_hi:[1,1]
    v_pk_mul_f32 v[18:19], v[150:151], v[18:19] op_sel_hi:[0,1]
    v_pk_fma_f32 v[18:19], v[150:151], v[34:35], v[18:19] op_sel:[1,0,0] op_sel_hi:[1,1,1] neg_lo:[1,0,0] neg_hi:[1,0,0]
    v_pk_fma_f32 v[34:35], v[150:151], v[34:35], v[156:157] op_sel_hi:[0,1,1]
    v_pk_mul_f32 v[156:157], v[150:151], v[20:21] op_sel:[1,0] op_sel_hi:[1,1]
    v_pk_mul_f32 v[20:21], v[150:151], v[20:21] op_sel_hi:[0,1]
    v_pk_fma_f32 v[20:21], v[150:151], v[36:37], v[20:21] op_sel:[1,0,0] op_sel_hi:[1,1,1] neg_lo:[1,0,0] neg_hi:[1,0,0]
    v_pk_fma_f32 v[36:37], v[150:151], v[36:37], v[156:157] op_sel_hi:[0,1,1]
    v_pk_mul_f32 v[156:157], v[150:151], v[22:23] op_sel:[1,0] op_sel_hi:[1,1]
    v_pk_mul_f32 v[22:23], v[150:151], v[22:23] op_sel_hi:[0,1]
    v_pk_fma_f32 v[22:23], v[150:151], v[38:39], v[22:23] op_sel:[1,0,0] op_sel_hi:[1,1,1] neg_lo:[1,0,0] neg_hi:[1,0,0]
    v_pk_fma_f32 v[38:39], v[150:151], v[38:39], v[156:157] op_sel_hi:[0,1,1]
    v_pk_mul_f32 v[156:157], v[150:151], v[24:25] op_sel:[1,0] op_sel_hi:[1,1]
    v_pk_mul_f32 v[24:25], v[150:151], v[24:25] op_sel_hi:[0,1]
    v_pk_fma_f32 v[24:25], v[150:151], v[40:41], v[24:25] op_sel:[1,0,0] op_sel_hi:[1,1,1] neg_lo:[1,0,0] neg_hi:[1,0,0]
    v_pk_fma_f32 v[40:41], v[150:151], v[40:41], v[156:157] op_sel_hi:[0,1,1]
    v_pk_mul_f32 v[156:157], v[150:151], v[26:27] op_sel:[1,0] op_sel_hi:[1,1]
    v_pk_mul_f32 v[26:27], v[150:151], v[26:27] op_sel_hi:[0,1]
    v_pk_fma_f32 v[26:27], v[150:151], v[42:43], v[26:27] op_sel:[1,0,0] op_sel_hi:[1,1,1] neg_lo:[1,0,0] neg_hi:[1,0,0]
    v_pk_fma_f32 v[42:43], v[150:151], v[42:43], v[156:157] op_sel_hi:[0,1,1]
    v_pk_mul_f32 v[156:157], v[150:151], v[28:29] op_sel:[1,0] op_sel_hi:[1,1]
    v_pk_mul_f32 v[28:29], v[150:151], v[28:29] op_sel_hi:[0,1]
    v_pk_fma_f32 v[28:29], v[150:151], v[44:45], v[28:29] op_sel:[1,0,0] op_sel_hi:[1,1,1] neg_lo:[1,0,0] neg_hi:[1,0,0]
    v_pk_fma_f32 v[44:45], v[150:151], v[44:45], v[156:157] op_sel_hi:[0,1,1]
    v_pk_mul_f32 v[156:157], v[150:151], v[30:31] op_sel:[1,0] op_sel_hi:[1,1]
    v_pk_mul_f32 v[30:31], v[150:151], v[30:31] op_sel_hi:[0,1]
    v_pk_fma_f32 v[30:31], v[150:151], v[46:47], v[30:31] op_sel:[1,0,0] op_sel_hi:[1,1,1] neg_lo:[1,0,0] neg_hi:[1,0,0]
    v_pk_fma_f32 v[46:47], v[150:151], v[46:47], v[156:157] op_sel_hi:[0,1,1]
    v_pk_mul_f32 v[156:157], v[150:151], v[48:49] op_sel:[1,0] op_sel_hi:[1,1]
    v_pk_mul_f32 v[48:49], v[150:151], v[48:49] op_sel_hi:[0,1]
    v_pk_fma_f32 v[48:49], v[150:151], v[64:65], v[48:49] op_sel:[1,0,0] op_sel_hi:[1,1,1] neg_lo:[1,0,0] neg_hi:[1,0,0]
    v_pk_fma_f32 v[64:65], v[150:151], v[64:65], v[156:157] op_sel_hi:[0,1,1]
    v_pk_mul_f32 v[156:157], v[150:151], v[50:51] op_sel:[1,0] op_sel_hi:[1,1]
    v_pk_mul_f32 v[50:51], v[150:151], v[50:51] op_sel_hi:[0,1]
    v_pk_fma_f32 v[50:51], v[150:151], v[66:67], v[50:51] op_sel:[1,0,0] op_sel_hi:[1,1,1] neg_lo:[1,0,0] neg_hi:[1,0,0]
    v_pk_fma_f32 v[66:67], v[150:151], v[66:67], v[156:157] op_sel_hi:[0,1,1]
    v_pk_mul_f32 v[156:157], v[150:151], v[52:53] op_sel:[1,0] op_sel_hi:[1,1]
    v_pk_mul_f32 v[52:53], v[150:151], v[52:53] op_sel_hi:[0,1]
    v_pk_fma_f32 v[52:53], v[150:151], v[68:69], v[52:53] op_sel:[1,0,0] op_sel_hi:[1,1,1] neg_lo:[1,0,0] neg_hi:[1,0,0]
    v_pk_fma_f32 v[68:69], v[150:151], v[68:69], v[156:157] op_sel_hi:[0,1,1]
    v_pk_mul_f32 v[156:157], v[150:151], v[54:55] op_sel:[1,0] op_sel_hi:[1,1]
    v_pk_mul_f32 v[54:55], v[150:151], v[54:55] op_sel_hi:[0,1]
    v_pk_fma_f32 v[54:55], v[150:151], v[70:71], v[54:55] op_sel:[1,0,0] op_sel_hi:[1,1,1] neg_lo:[1,0,0] neg_hi:[1,0,0]
    v_pk_fma_f32 v[70:71], v[150:151], v[70:71], v[156:157] op_sel_hi:[0,1,1]
    v_pk_mul_f32 v[156:157], v[150:151], v[56:57] op_sel:[1,0] op_sel_hi:[1,1]
    v_pk_mul_f32 v[56:57], v[150:151], v[56:57] op_sel_hi:[0,1]
    v_pk_fma_f32 v[56:57], v[150:151], v[72:73], v[56:57] op_sel:[1,0,0] op_sel_hi:[1,1,1] neg_lo:[1,0,0] neg_hi:[1,0,0]
    v_pk_fma_f32 v[72:73], v[150:151], v[72:73], v[156:157] op_sel_hi:[0,1,1]
    v_pk_mul_f32 v[156:157], v[150:151], v[58:59] op_sel:[1,0] op_sel_hi:[1,1]
    v_pk_mul_f32 v[58:59], v[150:151], v[58:59] op_sel_hi:[0,1]
    v_pk_fma_f32 v[58:59], v[150:151], v[74:75], v[58:59] op_sel:[1,0,0] op_sel_hi:[1,1,1] neg_lo:[1,0,0] neg_hi:[1,0,0]
    v_pk_fma_f32 v[74:75], v[150:151], v[74:75], v[156:157] op_sel_hi:[0,1,1]
    v_pk_mul_f32 v[156:157], v[150:151], v[60:61] op_sel:[1,0] op_sel_hi:[1,1]
    v_pk_mul_f32 v[60:61], v[150:151], v[60:61] op_sel_hi:[0,1]
    v_pk_fma_f32 v[60:61], v[150:151], v[76:77], v[60:61] op_sel:[1,0,0] op_sel_hi:[1,1,1] neg_lo:[1,0,0] neg_hi:[1,0,0]
    v_pk_fma_f32 v[76:77], v[150:151], v[76:77], v[156:157] op_sel_hi:[0,1,1]
    v_pk_mul_f32 v[156:157], v[150:151], v[62:63] op_sel:[1,0] op_sel_hi:[1,1]
    v_pk_mul_f32 v[62:63], v[150:151], v[62:63] op_sel_hi:[0,1]
    v_pk_fma_f32 v[62:63], v[150:151], v[78:79], v[62:63] op_sel:[1,0,0] op_sel_hi:[1,1,1] neg_lo:[1,0,0] neg_hi:[1,0,0]
    v_pk_fma_f32 v[78:79], v[150:151], v[78:79], v[156:157] op_sel_hi:[0,1,1]
    v_pk_mul_f32 v[156:157], v[150:151], v[80:81] op_sel:[1,0] op_sel_hi:[1,1]
    v_pk_mul_f32 v[80:81], v[150:151], v[80:81] op_sel_hi:[0,1]
    v_pk_fma_f32 v[80:81], v[150:151], v[96:97], v[80:81] op_sel:[1,0,0] op_sel_hi:[1,1,1] neg_lo:[1,0,0] neg_hi:[1,0,0]
    v_pk_fma_f32 v[96:97], v[150:151], v[96:97], v[156:157] op_sel_hi:[0,1,1]
    v_pk_mul_f32 v[156:157], v[150:151], v[82:83] op_sel:[1,0] op_sel_hi:[1,1]
    v_pk_mul_f32 v[82:83], v[150:151], v[82:83] op_sel_hi:[0,1]
    v_pk_fma_f32 v[82:83], v[150:151], v[98:99], v[82:83] op_sel:[1,0,0] op_sel_hi:[1,1,1] neg_lo:[1,0,0] neg_hi:[1,0,0]
    v_pk_fma_f32 v[98:99], v[150:151], v[98:99], v[156:157] op_sel_hi:[0,1,1]
    v_pk_mul_f32 v[156:157], v[150:151], v[84:85] op_sel:[1,0] op_sel_hi:[1,1]
    v_pk_mul_f32 v[84:85], v[150:151], v[84:85] op_sel_hi:[0,1]
    v_pk_fma_f32 v[84:85], v[150:151], v[100:101], v[84:85] op_sel:[1,0,0] op_sel_hi:[1,1,1] neg_lo:[1,0,0] neg_hi:[1,0,0]
    v_pk_fma_f32 v[100:101], v[150:151], v[100:101], v[156:157] op_sel_hi:[0,1,1]
    v_pk_mul_f32 v[156:157], v[150:151], v[86:87] op_sel:[1,0] op_sel_hi:[1,1]
    v_pk_mul_f32 v[86:87], v[150:151], v[86:87] op_sel_hi:[0,1]
    v_pk_fma_f32 v[86:87], v[150:151], v[102:103], v[86:87] op_sel:[1,0,0] op_sel_hi:[1,1,1] neg_lo:[1,0,0] neg_hi:[1,0,0]
    v_pk_fma_f32 v[102:103], v[150:151], v[102:103], v[156:157] op_sel_hi:[0,1,1]
    buffer_load_dwordx4 v[180:183], v224, s[48:51], 0 offen sc1
    buffer_load_dwordx4 v[184:187], v225, s[48:51], 0 offen sc1
    buffer_load_dwordx4 v[188:191], v226, s[48:51], 0 offen sc1
    buffer_load_dwordx4 v[192:195], v227, s[48:51], 0 offen sc1
    buffer_load_dwordx4 v[196:199], v228, s[48:51], 0 offen sc1
    buffer_load_dwordx4 v[200:203], v229, s[48:51], 0 offen sc1
    buffer_load_dwordx4 v[204:207], v230, s[48:51], 0 offen sc1
    buffer_load_dwordx4 v[208:211], v231, s[48:51], 0 offen sc1
    v_pk_mul_f32 v[156:157], v[150:151], v[88:89] op_sel:[1,0] op_sel_hi:[1,1]
    v_pk_mul_f32 v[88:89], v[150:151], v[88:89] op_sel_hi:[0,1]
    v_pk_fma_f32 v[88:89], v[150:151], v[104:105], v[88:89] op_sel:[1,0,0] op_sel_hi:[1,1,1] neg_lo:[1,0,0] neg_hi:[1,0,0]
    v_pk_fma_f32 v[104:105], v[150:151], v[104:105], v[156:157] op_sel_hi:[0,1,1]
    v_pk_mul_f32 v[156:157], v[150:151], v[90:91] op_sel:[1,0] op_sel_hi:[1,1]
    v_pk_mul_f32 v[90:91], v[150:151], v[90:91] op_sel_hi:[0,1]
    v_pk_fma_f32 v[90:91], v[150:151], v[106:107], v[90:91] op_sel:[1,0,0] op_sel_hi:[1,1,1] neg_lo:[1,0,0] neg_hi:[1,0,0]
    v_pk_fma_f32 v[106:107], v[150:151], v[106:107], v[156:157] op_sel_hi:[0,1,1]
    v_pk_mul_f32 v[156:157], v[150:151], v[92:93] op_sel:[1,0] op_sel_hi:[1,1]
    v_pk_mul_f32 v[92:93], v[150:151], v[92:93] op_sel_hi:[0,1]
    v_pk_fma_f32 v[92:93], v[150:151], v[108:109], v[92:93] op_sel:[1,0,0] op_sel_hi:[1,1,1] neg_lo:[1,0,0] neg_hi:[1,0,0]
    v_pk_fma_f32 v[108:109], v[150:151], v[108:109], v[156:157] op_sel_hi:[0,1,1]
    v_pk_mul_f32 v[156:157], v[150:151], v[94:95] op_sel:[1,0] op_sel_hi:[1,1]
    v_pk_mul_f32 v[94:95], v[150:151], v[94:95] op_sel_hi:[0,1]
    v_pk_fma_f32 v[94:95], v[150:151], v[110:111], v[94:95] op_sel:[1,0,0] op_sel_hi:[1,1,1] neg_lo:[1,0,0] neg_hi:[1,0,0]
    v_pk_fma_f32 v[110:111], v[150:151], v[110:111], v[156:157] op_sel_hi:[0,1,1]
    v_pk_mul_f32 v[156:157], v[150:151], v[112:113] op_sel:[1,0] op_sel_hi:[1,1]
    v_pk_mul_f32 v[112:113], v[150:151], v[112:113] op_sel_hi:[0,1]
    v_pk_fma_f32 v[112:113], v[150:151], v[128:129], v[112:113] op_sel:[1,0,0] op_sel_hi:[1,1,1] neg_lo:[1,0,0] neg_hi:[1,0,0]
    v_pk_fma_f32 v[128:129], v[150:151], v[128:129], v[156:157] op_sel_hi:[0,1,1]
    v_pk_mul_f32 v[156:157], v[150:151], v[114:115] op_sel:[1,0] op_sel_hi:[1,1]
    v_pk_mul_f32 v[114:115], v[150:151], v[114:115] op_sel_hi:[0,1]
    v_pk_fma_f32 v[114:115], v[150:151], v[130:131], v[114:115] op_sel:[1,0,0] op_sel_hi:[1,1,1] neg_lo:[1,0,0] neg_hi:[1,0,0]
    v_pk_fma_f32 v[130:131], v[150:151], v[130:131], v[156:157] op_sel_hi:[0,1,1]
    v_pk_mul_f32 v[156:157], v[150:151], v[116:117] op_sel:[1,0] op_sel_hi:[1,1]
    v_pk_mul_f32 v[116:117], v[150:151], v[116:117] op_sel_hi:[0,1]
    v_pk_fma_f32 v[116:117], v[150:151], v[132:133], v[116:117] op_sel:[1,0,0] op_sel_hi:[1,1,1] neg_lo:[1,0,0] neg_hi:[1,0,0]
    v_pk_fma_f32 v[132:133], v[150:151], v[132:133], v[156:157] op_sel_hi:[0,1,1]
    v_pk_mul_f32 v[156:157], v[150:151], v[118:119] op_sel:[1,0] op_sel_hi:[1,1]
    v_pk_mul_f32 v[118:119], v[150:151], v[118:119] op_sel_hi:[0,1]
    v_pk_fma_f32 v[118:119], v[150:151], v[134:135], v[118:119] op_sel:[1,0,0] op_sel_hi:[1,1,1] neg_lo:[1,0,0] neg_hi:[1,0,0]
    v_pk_fma_f32 v[134:135], v[150:151], v[134:135], v[156:157] op_sel_hi:[0,1,1]
    v_pk_mul_f32 v[156:157], v[150:151], v[120:121] op_sel:[1,0] op_sel_hi:[1,1]
    v_pk_mul_f32 v[120:121], v[150:151], v[120:121] op_sel_hi:[0,1]
    v_pk_fma_f32 v[120:121], v[150:151], v[136:137], v[120:121] op_sel:[1,0,0] op_sel_hi:[1,1,1] neg_lo:[1,0,0] neg_hi:[1,0,0]
    v_pk_fma_f32 v[136:137], v[150:151], v[136:137], v[156:157] op_sel_hi:[0,1,1]
    v_pk_mul_f32 v[156:157], v[150:151], v[122:123] op_sel:[1,0] op_sel_hi:[1,1]
    v_pk_mul_f32 v[122:123], v[150:151], v[122:123] op_sel_hi:[0,1]
    v_pk_fma_f32 v[122:123], v[150:151], v[138:139], v[122:123] op_sel:[1,0,0] op_sel_hi:[1,1,1] neg_lo:[1,0,0] neg_hi:[1,0,0]
    v_pk_fma_f32 v[138:139], v[150:151], v[138:139], v[156:157] op_sel_hi:[0,1,1]
    v_pk_mul_f32 v[156:157], v[150:151], v[124:125] op_sel:[1,0] op_sel_hi:[1,1]
    v_pk_mul_f32 v[124:125], v[150:151], v[124:125] op_sel_hi:[0,1]
    v_pk_fma_f32 v[124:125], v[150:151], v[140:141], v[124:125] op_sel:[1,0,0] op_sel_hi:[1,1,1] neg_lo:[1,0,0] neg_hi:[1,0,0]
    v_pk_fma_f32 v[140:141], v[150:151], v[140:141], v[156:157] op_sel_hi:[0,1,1]
    v_pk_mul_f32 v[156:157], v[150:151], v[126:127] op_sel:[1,0] op_sel_hi:[1,1]
    v_pk_mul_f32 v[126:127], v[150:151], v[126:127] op_sel_hi:[0,1]
    v_pk_fma_f32 v[126:127], v[150:151], v[142:143], v[126:127] op_sel:[1,0,0] op_sel_hi:[1,1,1] neg_lo:[1,0,0] neg_hi:[1,0,0]
    v_pk_fma_f32 v[142:143], v[150:151], v[142:143], v[156:157] op_sel_hi:[0,1,1]
    s_mov_b32 s72, 0
    s_branch Ls_chk
Ls_poll:
    buffer_load_dwordx4 v[180:183], v224, s[48:51], 0 offen sc1
    buffer_load_dwordx4 v[184:187], v225, s[48:51], 0 offen sc1
    buffer_load_dwordx4 v[188:191], v226, s[48:51], 0 offen sc1
    buffer_load_dwordx4 v[192:195], v227, s[48:51], 0 offen sc1
    buffer_load_dwordx4 v[196:199], v228, s[48:51], 0 offen sc1
    buffer_load_dwordx4 v[200:203], v229, s[48:51], 0 offen sc1
    buffer_load_dwordx4 v[204:207], v230, s[48:51], 0 offen sc1
    buffer_load_dwordx4 v[208:211], v231, s[48:51], 0 offen sc1
Ls_chk:
    s_waitcnt vmcnt(0)
    v_xor_b32 v181, v181, v232
    v_xor_b32 v183, v183, v232
    v_or3_b32 v181, v181, v181, v183
    v_xor_b32 v185, v185, v233
    v_xor_b32 v187, v187, v233
    v_or3_b32 v181, v181, v185, v187
    v_xor_b32 v189, v189, v234
    v_xor_b32 v191, v191, v234
    v_or3_b32 v181, v181, v189, v191
    v_xor_b32 v193, v193, v235
    v_xor_b32 v195, v195, v235
    v_or3_b32 v181, v181, v193, v195
    v_xor_b32 v197, v197, v236
    v_xor_b32 v199, v199, v236
    v_or3_b32 v181, v181, v197, v199
    v_xor_b32 v201, v201, v237
    v_xor_b32 v203, v203, v237
    v_or3_b32 v181, v181, v201, v203
    v_xor_b32 v205, v205, v238
    v_xor_b32 v207, v207, v238
    v_or3_b32 v181, v181, v205, v207
    v_xor_b32 v209, v209, v239
    v_xor_b32_e64 v211, v211, v239
    v_or3_b32 v181, v181, v209, v211
    v_cmp_ne_u32 vcc, 0, v181
    s_cmp_eq_u64 vcc, 0
    s_cbranch_scc1 Ls_gotcarry
    s_sleep 1
    s_add_u32 s72, s72, 1
    s_cmp_lt_u32 s72, 0x40000
    s_cbranch_scc1 Ls_poll
Ls_gotcarry:
    v_fma_f32 v170, v148, v180, v184
    v_fma_f32 v171, v148, v182, v186
    v_fma_f32 v170, -v149, v182, v170
    v_fma_f32 v171, v149, v180, v171
    v_fma_f32 v168, v148, v170, v188
    v_fma_f32 v169, v148, v171, v190
    v_fma_f32 v168, -v149, v171, v168
    v_fma_f32 v169, v149, v170, v169
    v_fma_f32 v170, v148, v168, v192
    v_fma_f32 v171, v148, v169, v194
    v_fma_f32 v170, -v149, v169, v170
    v_fma_f32 v171, v149, v168, v171
    v_fma_f32 v168, v148, v170, v196
    v_fma_f32 v169, v148, v171, v198
    v_fma_f32 v168, -v149, v171, v168
    v_fma_f32 v169, v149, v170, v169
    v_fma_f32 v170, v148, v168, v200
    v_fma_f32 v171, v148, v169, v202
    v_fma_f32 v170, -v149, v169, v170
    v_fma_f32 v171, v149, v168, v171
    v_fma_f32 v168, v148, v170, v204
    v_fma_f32 v169, v148, v171, v206
    v_fma_f32 v168, -v149, v171, v168
    v_fma_f32 v169, v149, v170, v169
    v_fma_f32 v170, v148, v168, v208
    v_fma_f32 v171, v148, v169, v210
    v_fma_f32 v170, -v149, v169, v170
    v_fma_f32 v171, v149, v168, v171
    v_mov_b32 v168, v170
    v_mov_b32 v169, v171
    s_nop 1
    v_permlane32_swap_b32 v168, v170
    v_permlane32_swap_b32 v169, v171
    s_nop 1
    v_fma_f32 v170, v174, v168, v170
    v_fma_f32 v171, v174, v169, v171
    v_fma_f32 v170, -v175, v169, v170
    v_fma_f32 v171, v175, v168, v171
    v_pk_fma_f32 v[160:161], v[170:171], v[164:165], v[160:161] op_sel_hi:[0,1,1]
    v_pk_fma_f32 v[162:163], v[170:171], v[166:167], v[162:163] op_sel_hi:[0,1,1]
    v_pk_fma_f32 v[160:161], v[170:171], v[166:167], v[160:161] op_sel:[1,0,0] op_sel_hi:[1,1,1] neg_lo:[1,0,0] neg_hi:[1,0,0]
    v_pk_fma_f32 v[162:163], v[170:171], v[164:165], v[162:163] op_sel:[1,0,0] op_sel_hi:[1,1,1]
Ls_nocarry:
    s_mul_i32 s47, s38, 9216
    s_add_u32 s47, s47, 122880
    v_and_b32 v1, 31, v0
    v_mul_u32_u24 v1, 144, v1
    v_lshrrev_b32 v2, 5, v0
    v_lshl_add_u32 v1, v2, 6, v1
    v_add_u32 v1, s47, v1
    v_lshrrev_b32 v2, 4, v0
    v_lshlrev_b32 v2, 3, v2
    v_bfe_u32 v3, v0, 2, 2
    v_add_u32 v2, v2, v3
    v_mul_u32_u24 v2, 144, v2
    v_and_b32 v3, 3, v0
    v_lshl_add_u32 v2, v3, 3, v2
    v_add_u32 v2, s47, v2
    v_lshlrev_b32 v3, 4, v0
    s_mov_b32 s48, s36
    s_mov_b32 s49, s37
    s_mov_b32 s50, 0xbc0000
    s_mov_b32 s51, 0x20000
    s_lshl_b32 s46, s40, 1
    s_add_u32 s73, s46, s45
    s_lshl_b32 s46, s73, 13
    s_lshl_b32 s47, s39, 2
    s_lshl_b32 s56, s44, 1
    s_add_u32 s47, s47, s56
    s_mul_i32 s47, s47, 385024
    s_add_u32 s46, s46, s47
    s_add_u32 s47, s46, 385024
    s_add_u32 s56, s46, 4096
    s_add_u32 s57, s47, 4096
    s_add_u32 s52, s36, 0xc00000
    s_addc_u32 s53, s37, 0
    s_mov_b32 s54, 0x3ac000
    s_mov_b32 s55, 0x20000
    s_mul_i32 s74, s90, 10
    s_add_u32 s74, s74, 54
    s_mul_i32 s76, s74, 5120
    s_mul_i32 s77, s43, 481280
    s_add_u32 s76, s76, s77
    s_mul_i32 s77, s101, 25600
    s_add_u32 s76, s76, s77
    s_nop 0
    s_mul_i32 s75, s101, -51200
    s_add_u32 s75, s75, 35840
    s_add_u32 s77, s76, 4096
    v_lshlrev_b32_e64 v12, 4, v0
    v_pk_fma_f32 v[16:17], v[144:145], v[160:161], v[16:17] op_sel_hi:[0,1,1]
    v_pk_fma_f32 v[32:33], v[144:145], v[162:163], v[32:33] op_sel_hi:[0,1,1]
    v_pk_fma_f32 v[16:17], v[144:145], v[162:163], v[16:17] op_sel:[1,0,0] op_sel_hi:[1,1,1] neg_lo:[1,0,0] neg_hi:[1,0,0]
    v_pk_fma_f32 v[32:33], v[144:145], v[160:161], v[32:33] op_sel:[1,0,0] op_sel_hi:[1,1,1]
    v_pk_fma_f32 v[18:19], v[144:145], v[16:17], v[18:19] op_sel_hi:[0,1,1]
    v_pk_fma_f32 v[34:35], v[144:145], v[32:33], v[34:35] op_sel_hi:[0,1,1]
    v_pk_fma_f32 v[18:19], v[144:145], v[32:33], v[18:19] op_sel:[1,0,0] op_sel_hi:[1,1,1] neg_lo:[1,0,0] neg_hi:[1,0,0]
    v_pk_fma_f32 v[34:35], v[144:145], v[16:17], v[34:35] op_sel:[1,0,0] op_sel_hi:[1,1,1]
    v_pk_fma_f32 v[20:21], v[144:145], v[18:19], v[20:21] op_sel_hi:[0,1,1]
    v_pk_fma_f32 v[36:37], v[144:145], v[34:35], v[36:37] op_sel_hi:[0,1,1]
    v_pk_fma_f32 v[20:21], v[144:145], v[34:35], v[20:21] op_sel:[1,0,0] op_sel_hi:[1,1,1] neg_lo:[1,0,0] neg_hi:[1,0,0]
    v_pk_fma_f32 v[36:37], v[144:145], v[18:19], v[36:37] op_sel:[1,0,0] op_sel_hi:[1,1,1]
    v_pk_fma_f32 v[22:23], v[144:145], v[20:21], v[22:23] op_sel_hi:[0,1,1]
    v_pk_fma_f32 v[38:39], v[144:145], v[36:37], v[38:39] op_sel_hi:[0,1,1]
    v_pk_fma_f32 v[22:23], v[144:145], v[36:37], v[22:23] op_sel:[1,0,0] op_sel_hi:[1,1,1] neg_lo:[1,0,0] neg_hi:[1,0,0]
    v_pk_fma_f32 v[38:39], v[144:145], v[20:21], v[38:39] op_sel:[1,0,0] op_sel_hi:[1,1,1]
    v_pk_fma_f32 v[24:25], v[144:145], v[22:23], v[24:25] op_sel_hi:[0,1,1]
    v_pk_fma_f32 v[40:41], v[144:145], v[38:39], v[40:41] op_sel_hi:[0,1,1]
    v_pk_fma_f32 v[24:25], v[144:145], v[38:39], v[24:25] op_sel:[1,0,0] op_sel_hi:[1,1,1] neg_lo:[1,0,0] neg_hi:[1,0,0]
    v_pk_fma_f32 v[40:41], v[144:145], v[22:23], v[40:41] op_sel:[1,0,0] op_sel_hi:[1,1,1]
    v_pk_fma_f32 v[26:27], v[144:145], v[24:25], v[26:27] op_sel_hi:[0,1,1]
    v_pk_fma_f32 v[42:43], v[144:145], v[40:41], v[42:43] op_sel_hi:[0,1,1]
    v_pk_fma_f32 v[26:27], v[144:145], v[40:41], v[26:27] op_sel:[1,0,0] op_sel_hi:[1,1,1] neg_lo:[1,0,0] neg_hi:[1,0,0]
    v_pk_fma_f32 v[42:43], v[144:145], v[24:25], v[42:43] op_sel:[1,0,0] op_sel_hi:[1,1,1]
    v_pk_fma_f32 v[28:29], v[144:145], v[26:27], v[28:29] op_sel_hi:[0,1,1]
    v_pk_fma_f32 v[44:45], v[144:145], v[42:43], v[44:45] op_sel_hi:[0,1,1]
    v_pk_fma_f32 v[28:29], v[144:145], v[42:43], v[28:29] op_sel:[1,0,0] op_sel_hi:[1,1,1] neg_lo:[1,0,0] neg_hi:[1,0,0]
    v_pk_fma_f32 v[44:45], v[144:145], v[26:27], v[44:45] op_sel:[1,0,0] op_sel_hi:[1,1,1]
    v_pk_fma_f32 v[30:31], v[144:145], v[28:29], v[30:31] op_sel_hi:[0,1,1]
    v_pk_fma_f32 v[46:47], v[144:145], v[44:45], v[46:47] op_sel_hi:[0,1,1]
    v_pk_fma_f32 v[30:31], v[144:145], v[44:45], v[30:31] op_sel:[1,0,0] op_sel_hi:[1,1,1] neg_lo:[1,0,0] neg_hi:[1,0,0]
    v_pk_fma_f32 v[46:47], v[144:145], v[28:29], v[46:47] op_sel:[1,0,0] op_sel_hi:[1,1,1]
    v_cvt_pk_bf16_f32 v176, v16, v18
    v_cvt_pk_bf16_f32 v177, v20, v22
    v_cvt_pk_bf16_f32 v178, v24, v26
    v_cvt_pk_bf16_f32 v179, v28, v30
    ds_write_b128 v1, v[176:179] offset:0
    v_cvt_pk_bf16_f32 v180, v17, v19
    v_cvt_pk_bf16_f32 v181, v21, v23
    v_cvt_pk_bf16_f32 v182, v25, v27
    v_cvt_pk_bf16_f32 v183, v29, v31
    ds_write_b128 v1, v[180:183] offset:32
    v_cvt_pk_bf16_f32 v184, -v32, -v34
    v_cvt_pk_bf16_f32 v185, -v36, -v38
    v_cvt_pk_bf16_f32 v186, -v40, -v42
    v_cvt_pk_bf16_f32 v187, -v44, -v46
    ds_write_b128 v1, v[184:187] offset:4608
    v_cvt_pk_bf16_f32 v188, -v33, -v35
    v_cvt_pk_bf16_f32 v189, -v37, -v39
    v_cvt_pk_bf16_f32 v190, -v41, -v43
    v_cvt_pk_bf16_f32 v191, -v45, -v47
    ds_write_b128 v1, v[188:191] offset:4640
    v_pk_fma_f32 v[48:49], v[144:145], v[30:31], v[48:49] op_sel_hi:[0,1,1]
    v_pk_fma_f32 v[64:65], v[144:145], v[46:47], v[64:65] op_sel_hi:[0,1,1]
    v_pk_fma_f32 v[48:49], v[144:145], v[46:47], v[48:49] op_sel:[1,0,0] op_sel_hi:[1,1,1] neg_lo:[1,0,0] neg_hi:[1,0,0]
    v_pk_fma_f32 v[64:65], v[144:145], v[30:31], v[64:65] op_sel:[1,0,0] op_sel_hi:[1,1,1]
    v_pk_fma_f32 v[50:51], v[144:145], v[48:49], v[50:51] op_sel_hi:[0,1,1]
    v_pk_fma_f32 v[66:67], v[144:145], v[64:65], v[66:67] op_sel_hi:[0,1,1]
    v_pk_fma_f32 v[50:51], v[144:145], v[64:65], v[50:51] op_sel:[1,0,0] op_sel_hi:[1,1,1] neg_lo:[1,0,0] neg_hi:[1,0,0]
    v_pk_fma_f32 v[66:67], v[144:145], v[48:49], v[66:67] op_sel:[1,0,0] op_sel_hi:[1,1,1]
    v_pk_fma_f32 v[52:53], v[144:145], v[50:51], v[52:53] op_sel_hi:[0,1,1]
    v_pk_fma_f32 v[68:69], v[144:145], v[66:67], v[68:69] op_sel_hi:[0,1,1]
    v_pk_fma_f32 v[52:53], v[144:145], v[66:67], v[52:53] op_sel:[1,0,0] op_sel_hi:[1,1,1] neg_lo:[1,0,0] neg_hi:[1,0,0]
    v_pk_fma_f32 v[68:69], v[144:145], v[50:51], v[68:69] op_sel:[1,0,0] op_sel_hi:[1,1,1]
    v_pk_fma_f32 v[54:55], v[144:145], v[52:53], v[54:55] op_sel_hi:[0,1,1]
    v_pk_fma_f32 v[70:71], v[144:145], v[68:69], v[70:71] op_sel_hi:[0,1,1]
    v_pk_fma_f32 v[54:55], v[144:145], v[68:69], v[54:55] op_sel:[1,0,0] op_sel_hi:[1,1,1] neg_lo:[1,0,0] neg_hi:[1,0,0]
    v_pk_fma_f32 v[70:71], v[144:145], v[52:53], v[70:71] op_sel:[1,0,0] op_sel_hi:[1,1,1]
    v_pk_fma_f32 v[56:57], v[144:145], v[54:55], v[56:57] op_sel_hi:[0,1,1]
    v_pk_fma_f32 v[72:73], v[144:145], v[70:71], v[72:73] op_sel_hi:[0,1,1]
    v_pk_fma_f32 v[56:57], v[144:145], v[70:71], v[56:57] op_sel:[1,0,0] op_sel_hi:[1,1,1] neg_lo:[1,0,0] neg_hi:[1,0,0]
    v_pk_fma_f32 v[72:73], v[144:145], v[54:55], v[72:73] op_sel:[1,0,0] op_sel_hi:[1,1,1]
    v_pk_fma_f32 v[58:59], v[144:145], v[56:57], v[58:59] op_sel_hi:[0,1,1]
    v_pk_fma_f32 v[74:75], v[144:145], v[72:73], v[74:75] op_sel_hi:[0,1,1]
    v_pk_fma_f32 v[58:59], v[144:145], v[72:73], v[58:59] op_sel:[1,0,0] op_sel_hi:[1,1,1] neg_lo:[1,0,0] neg_hi:[1,0,0]
    v_pk_fma_f32 v[74:75], v[144:145], v[56:57], v[74:75] op_sel:[1,0,0] op_sel_hi:[1,1,1]
    v_pk_fma_f32 v[60:61], v[144:145], v[58:59], v[60:61] op_sel_hi:[0,1,1]
    v_pk_fma_f32 v[76:77], v[144:145], v[74:75], v[76:77] op_sel_hi:[0,1,1]
    v_pk_fma_f32 v[60:61], v[144:145], v[74:75], v[60:61] op_sel:[1,0,0] op_sel_hi:[1,1,1] neg_lo:[1,0,0] neg_hi:[1,0,0]
    v_pk_fma_f32 v[76:77], v[144:145], v[58:59], v[76:77] op_sel:[1,0,0] op_sel_hi:[1,1,1]
    v_pk_fma_f32 v[62:63], v[144:145], v[60:61], v[62:63] op_sel_hi:[0,1,1]
    v_pk_fma_f32 v[78:79], v[144:145], v[76:77], v[78:79] op_sel_hi:[0,1,1]
    v_pk_fma_f32 v[62:63], v[144:145], v[76:77], v[62:63] op_sel:[1,0,0] op_sel_hi:[1,1,1] neg_lo:[1,0,0] neg_hi:[1,0,0]
    v_pk_fma_f32 v[78:79], v[144:145], v[60:61], v[78:79] op_sel:[1,0,0] op_sel_hi:[1,1,1]
    v_cvt_pk_bf16_f32 v192, v48, v50
    v_cvt_pk_bf16_f32 v193, v52, v54
    v_cvt_pk_bf16_f32 v194, v56, v58
    v_cvt_pk_bf16_f32 v195, v60, v62
    ds_write_b128 v1, v[192:195] offset:16
    v_cvt_pk_bf16_f32 v196, v49, v51
    v_cvt_pk_bf16_f32 v197, v53, v55
    v_cvt_pk_bf16_f32 v198, v57, v59
    v_cvt_pk_bf16_f32 v199, v61, v63
    ds_write_b128 v1, v[196:199] offset:48
    v_cvt_pk_bf16_f32 v200, -v64, -v66
    v_cvt_pk_bf16_f32 v201, -v68, -v70
    v_cvt_pk_bf16_f32 v202, -v72, -v74
    v_cvt_pk_bf16_f32 v203, -v76, -v78
    ds_write_b128 v1, v[200:203] offset:4624
    v_cvt_pk_bf16_f32 v204, -v65, -v67
    v_cvt_pk_bf16_f32 v205, -v69, -v71
    v_cvt_pk_bf16_f32 v206, -v73, -v75
    v_cvt_pk_bf16_f32 v207, -v77, -v79
    ds_write_b128 v1, v[204:207] offset:4656
    v_pk_fma_f32 v[80:81], v[144:145], v[62:63], v[80:81] op_sel_hi:[0,1,1]
    v_pk_fma_f32 v[96:97], v[144:145], v[78:79], v[96:97] op_sel_hi:[0,1,1]
    v_pk_fma_f32 v[80:81], v[144:145], v[78:79], v[80:81] op_sel:[1,0,0] op_sel_hi:[1,1,1] neg_lo:[1,0,0] neg_hi:[1,0,0]
    v_pk_fma_f32 v[96:97], v[144:145], v[62:63], v[96:97] op_sel:[1,0,0] op_sel_hi:[1,1,1]
    v_pk_fma_f32 v[82:83], v[144:145], v[80:81], v[82:83] op_sel_hi:[0,1,1]
    v_pk_fma_f32 v[98:99], v[144:145], v[96:97], v[98:99] op_sel_hi:[0,1,1]
    v_pk_fma_f32 v[82:83], v[144:145], v[96:97], v[82:83] op_sel:[1,0,0] op_sel_hi:[1,1,1] neg_lo:[1,0,0] neg_hi:[1,0,0]
    v_pk_fma_f32 v[98:99], v[144:145], v[80:81], v[98:99] op_sel:[1,0,0] op_sel_hi:[1,1,1]
    s_waitcnt lgkmcnt(0)
    s_nop 0
    ds_read_b64_tr_b16 v[208:209], v2 offset:0
    ds_read_b64_tr_b16 v[210:211], v2 offset:576
    ds_read_b64_tr_b16 v[212:213], v2 offset:32
    ds_read_b64_tr_b16 v[214:215], v2 offset:608
    ds_read_b64_tr_b16 v[216:217], v2 offset:64
    ds_read_b64_tr_b16 v[218:219], v2 offset:640
    ds_read_b64_tr_b16 v[220:221], v2 offset:96
    ds_read_b64_tr_b16 v[222:223], v2 offset:672
    ds_read_b64_tr_b16 v[224:225], v2 offset:4608
    ds_read_b64_tr_b16 v[226:227], v2 offset:5184
    ds_read_b64_tr_b16 v[228:229], v2 offset:4640
    ds_read_b64_tr_b16 v[230:231], v2 offset:5216
    ds_read_b64_tr_b16 v[232:233], v2 offset:4672
    ds_read_b64_tr_b16 v[234:235], v2 offset:5248
    ds_read_b64_tr_b16 v[236:237], v2 offset:4704
    ds_read_b64_tr_b16 v[238:239], v2 offset:5280
    v_pk_fma_f32 v[84:85], v[144:145], v[82:83], v[84:85] op_sel_hi:[0,1,1]
    v_pk_fma_f32 v[100:101], v[144:145], v[98:99], v[100:101] op_sel_hi:[0,1,1]
    v_pk_fma_f32 v[84:85], v[144:145], v[98:99], v[84:85] op_sel:[1,0,0] op_sel_hi:[1,1,1] neg_lo:[1,0,0] neg_hi:[1,0,0]
    v_pk_fma_f32 v[100:101], v[144:145], v[82:83], v[100:101] op_sel:[1,0,0] op_sel_hi:[1,1,1]
    v_pk_fma_f32 v[86:87], v[144:145], v[84:85], v[86:87] op_sel_hi:[0,1,1]
    v_pk_fma_f32 v[102:103], v[144:145], v[100:101], v[102:103] op_sel_hi:[0,1,1]
    v_pk_fma_f32 v[86:87], v[144:145], v[100:101], v[86:87] op_sel:[1,0,0] op_sel_hi:[1,1,1] neg_lo:[1,0,0] neg_hi:[1,0,0]
    v_pk_fma_f32 v[102:103], v[144:145], v[84:85], v[102:103] op_sel:[1,0,0] op_sel_hi:[1,1,1]
    v_pk_fma_f32 v[88:89], v[144:145], v[86:87], v[88:89] op_sel_hi:[0,1,1]
    v_pk_fma_f32 v[104:105], v[144:145], v[102:103], v[104:105] op_sel_hi:[0,1,1]
    v_pk_fma_f32 v[88:89], v[144:145], v[102:103], v[88:89] op_sel:[1,0,0] op_sel_hi:[1,1,1] neg_lo:[1,0,0] neg_hi:[1,0,0]
    v_pk_fma_f32 v[104:105], v[144:145], v[86:87], v[104:105] op_sel:[1,0,0] op_sel_hi:[1,1,1]
    v_pk_fma_f32 v[90:91], v[144:145], v[88:89], v[90:91] op_sel_hi:[0,1,1]
    v_pk_fma_f32 v[106:107], v[144:145], v[104:105], v[106:107] op_sel_hi:[0,1,1]
    v_pk_fma_f32 v[90:91], v[144:145], v[104:105], v[90:91] op_sel:[1,0,0] op_sel_hi:[1,1,1] neg_lo:[1,0,0] neg_hi:[1,0,0]
    v_pk_fma_f32 v[106:107], v[144:145], v[88:89], v[106:107] op_sel:[1,0,0] op_sel_hi:[1,1,1]
    s_waitcnt lgkmcnt(0)
    s_nop 0
    buffer_store_dwordx4 v[208:211], v3, s[48:51], s46 offen offset:0 sc1
    buffer_store_dwordx4 v[212:215], v3, s[48:51], s46 offen offset:2048 sc1
    buffer_store_dwordx4 v[216:219], v3, s[48:51], s47 offen offset:0 sc1
    buffer_store_dwordx4 v[220:223], v3, s[48:51], s47 offen offset:2048 sc1
    buffer_store_dwordx4 v[224:227], v3, s[48:51], s56 offen offset:0 sc1
    buffer_store_dwordx4 v[228:231], v3, s[48:51], s56 offen offset:2048 sc1
    buffer_store_dwordx4 v[232:235], v3, s[48:51], s57 offen offset:0 sc1
    buffer_store_dwordx4 v[236:239], v3, s[48:51], s57 offen offset:2048 sc1
    v_pk_fma_f32 v[92:93], v[144:145], v[90:91], v[92:93] op_sel_hi:[0,1,1]
    v_pk_fma_f32 v[108:109], v[144:145], v[106:107], v[108:109] op_sel_hi:[0,1,1]
    v_pk_fma_f32 v[92:93], v[144:145], v[106:107], v[92:93] op_sel:[1,0,0] op_sel_hi:[1,1,1] neg_lo:[1,0,0] neg_hi:[1,0,0]
    v_pk_fma_f32 v[108:109], v[144:145], v[90:91], v[108:109] op_sel:[1,0,0] op_sel_hi:[1,1,1]
    v_pk_fma_f32 v[94:95], v[144:145], v[92:93], v[94:95] op_sel_hi:[0,1,1]
    v_pk_fma_f32 v[110:111], v[144:145], v[108:109], v[110:111] op_sel_hi:[0,1,1]
    v_pk_fma_f32 v[94:95], v[144:145], v[108:109], v[94:95] op_sel:[1,0,0] op_sel_hi:[1,1,1] neg_lo:[1,0,0] neg_hi:[1,0,0]
    v_pk_fma_f32 v[110:111], v[144:145], v[92:93], v[110:111] op_sel:[1,0,0] op_sel_hi:[1,1,1]
    v_cvt_pk_bf16_f32 v176, v80, v82
    v_cvt_pk_bf16_f32 v177, v84, v86
    v_cvt_pk_bf16_f32 v178, v88, v90
    v_cvt_pk_bf16_f32 v179, v92, v94
    ds_write_b128 v1, v[176:179] offset:0
    v_cvt_pk_bf16_f32 v180, v81, v83
    v_cvt_pk_bf16_f32 v181, v85, v87
    v_cvt_pk_bf16_f32 v182, v89, v91
    v_cvt_pk_bf16_f32 v183, v93, v95
    ds_write_b128 v1, v[180:183] offset:32
    v_cvt_pk_bf16_f32 v184, -v96, -v98
    v_cvt_pk_bf16_f32 v185, -v100, -v102
    v_cvt_pk_bf16_f32 v186, -v104, -v106
    v_cvt_pk_bf16_f32 v187, -v108, -v110
    ds_write_b128 v1, v[184:187] offset:4608
    v_cvt_pk_bf16_f32 v188, -v97, -v99
    v_cvt_pk_bf16_f32 v189, -v101, -v103
    v_cvt_pk_bf16_f32 v190, -v105, -v107
    v_cvt_pk_bf16_f32 v191, -v109, -v111
    ds_write_b128 v1, v[188:191] offset:4640
    v_pk_fma_f32 v[112:113], v[144:145], v[94:95], v[112:113] op_sel_hi:[0,1,1]
    v_pk_fma_f32 v[128:129], v[144:145], v[110:111], v[128:129] op_sel_hi:[0,1,1]
    v_pk_fma_f32 v[112:113], v[144:145], v[110:111], v[112:113] op_sel:[1,0,0] op_sel_hi:[1,1,1] neg_lo:[1,0,0] neg_hi:[1,0,0]
    v_pk_fma_f32 v[128:129], v[144:145], v[94:95], v[128:129] op_sel:[1,0,0] op_sel_hi:[1,1,1]
    v_pk_fma_f32 v[114:115], v[144:145], v[112:113], v[114:115] op_sel_hi:[0,1,1]
    v_pk_fma_f32 v[130:131], v[144:145], v[128:129], v[130:131] op_sel_hi:[0,1,1]
    v_pk_fma_f32 v[114:115], v[144:145], v[128:129], v[114:115] op_sel:[1,0,0] op_sel_hi:[1,1,1] neg_lo:[1,0,0] neg_hi:[1,0,0]
    v_pk_fma_f32 v[130:131], v[144:145], v[112:113], v[130:131] op_sel:[1,0,0] op_sel_hi:[1,1,1]
    v_pk_fma_f32 v[116:117], v[144:145], v[114:115], v[116:117] op_sel_hi:[0,1,1]
    v_pk_fma_f32 v[132:133], v[144:145], v[130:131], v[132:133] op_sel_hi:[0,1,1]
    v_pk_fma_f32 v[116:117], v[144:145], v[130:131], v[116:117] op_sel:[1,0,0] op_sel_hi:[1,1,1] neg_lo:[1,0,0] neg_hi:[1,0,0]
    v_pk_fma_f32 v[132:133], v[144:145], v[114:115], v[132:133] op_sel:[1,0,0] op_sel_hi:[1,1,1]
    v_pk_fma_f32 v[118:119], v[144:145], v[116:117], v[118:119] op_sel_hi:[0,1,1]
    v_pk_fma_f32 v[134:135], v[144:145], v[132:133], v[134:135] op_sel_hi:[0,1,1]
    v_pk_fma_f32 v[118:119], v[144:145], v[132:133], v[118:119] op_sel:[1,0,0] op_sel_hi:[1,1,1] neg_lo:[1,0,0] neg_hi:[1,0,0]
    v_pk_fma_f32 v[134:135], v[144:145], v[116:117], v[134:135] op_sel:[1,0,0] op_sel_hi:[1,1,1]
    v_pk_fma_f32 v[120:121], v[144:145], v[118:119], v[120:121] op_sel_hi:[0,1,1]
    v_pk_fma_f32 v[136:137], v[144:145], v[134:135], v[136:137] op_sel_hi:[0,1,1]
    v_pk_fma_f32 v[120:121], v[144:145], v[134:135], v[120:121] op_sel:[1,0,0] op_sel_hi:[1,1,1] neg_lo:[1,0,0] neg_hi:[1,0,0]
    v_pk_fma_f32 v[136:137], v[144:145], v[118:119], v[136:137] op_sel:[1,0,0] op_sel_hi:[1,1,1]
    v_pk_fma_f32 v[122:123], v[144:145], v[120:121], v[122:123] op_sel_hi:[0,1,1]
    v_pk_fma_f32 v[138:139], v[144:145], v[136:137], v[138:139] op_sel_hi:[0,1,1]
    v_pk_fma_f32 v[122:123], v[144:145], v[136:137], v[122:123] op_sel:[1,0,0] op_sel_hi:[1,1,1] neg_lo:[1,0,0] neg_hi:[1,0,0]
    v_pk_fma_f32 v[138:139], v[144:145], v[120:121], v[138:139] op_sel:[1,0,0] op_sel_hi:[1,1,1]
    v_pk_fma_f32 v[124:125], v[144:145], v[122:123], v[124:125] op_sel_hi:[0,1,1]
    v_pk_fma_f32 v[140:141], v[144:145], v[138:139], v[140:141] op_sel_hi:[0,1,1]
    v_pk_fma_f32 v[124:125], v[144:145], v[138:139], v[124:125] op_sel:[1,0,0] op_sel_hi:[1,1,1] neg_lo:[1,0,0] neg_hi:[1,0,0]
    v_pk_fma_f32 v[140:141], v[144:145], v[122:123], v[140:141] op_sel:[1,0,0] op_sel_hi:[1,1,1]
    v_pk_fma_f32 v[126:127], v[144:145], v[124:125], v[126:127] op_sel_hi:[0,1,1]
    v_pk_fma_f32 v[142:143], v[144:145], v[140:141], v[142:143] op_sel_hi:[0,1,1]
    v_pk_fma_f32 v[126:127], v[144:145], v[140:141], v[126:127] op_sel:[1,0,0] op_sel_hi:[1,1,1] neg_lo:[1,0,0] neg_hi:[1,0,0]
    v_pk_fma_f32 v[142:143], v[144:145], v[124:125], v[142:143] op_sel:[1,0,0] op_sel_hi:[1,1,1]
    v_cvt_pk_bf16_f32 v192, v112, v114
    v_cvt_pk_bf16_f32 v193, v116, v118
    v_cvt_pk_bf16_f32 v194, v120, v122
    v_cvt_pk_bf16_f32 v195, v124, v126
    ds_write_b128 v1, v[192:195] offset:16
    v_cvt_pk_bf16_f32 v196, v113, v115
    v_cvt_pk_bf16_f32 v197, v117, v119
    v_cvt_pk_bf16_f32 v198, v121, v123
    v_cvt_pk_bf16_f32 v199, v125, v127
    ds_write_b128 v1, v[196:199] offset:48
    v_cvt_pk_bf16_f32 v200, -v128, -v130
    v_cvt_pk_bf16_f32 v201, -v132, -v134
    v_cvt_pk_bf16_f32 v202, -v136, -v138
    v_cvt_pk_bf16_f32 v203, -v140, -v142
    ds_write_b128 v1, v[200:203] offset:4624
    v_cvt_pk_bf16_f32 v204, -v129, -v131
    v_cvt_pk_bf16_f32 v205, -v133, -v135
    v_cvt_pk_bf16_f32 v206, -v137, -v139
    v_cvt_pk_bf16_f32 v207, -v141, -v143
    ds_write_b128 v1, v[204:207] offset:4656
    s_waitcnt lgkmcnt(0)
    s_nop 0
    ds_read_b64_tr_b16 v[208:209], v2 offset:0
    ds_read_b64_tr_b16 v[210:211], v2 offset:576
    ds_read_b64_tr_b16 v[212:213], v2 offset:32
    ds_read_b64_tr_b16 v[214:215], v2 offset:608
    ds_read_b64_tr_b16 v[216:217], v2 offset:64
    ds_read_b64_tr_b16 v[218:219], v2 offset:640
    ds_read_b64_tr_b16 v[220:221], v2 offset:96
    ds_read_b64_tr_b16 v[222:223], v2 offset:672
    ds_read_b64_tr_b16 v[224:225], v2 offset:4608
    ds_read_b64_tr_b16 v[226:227], v2 offset:5184
    ds_read_b64_tr_b16 v[228:229], v2 offset:4640
    ds_read_b64_tr_b16 v[230:231], v2 offset:5216
    ds_read_b64_tr_b16 v[232:233], v2 offset:4672
    ds_read_b64_tr_b16 v[234:235], v2 offset:5248
    ds_read_b64_tr_b16 v[236:237], v2 offset:4704
    ds_read_b64_tr_b16 v[238:239], v2 offset:5280
    s_waitcnt lgkmcnt(0)
    s_nop 0
    buffer_store_dwordx4 v[208:211], v3, s[48:51], s46 offen offset:1024 sc1
    buffer_store_dwordx4 v[212:215], v3, s[48:51], s46 offen offset:3072 sc1
    buffer_store_dwordx4 v[216:219], v3, s[48:51], s47 offen offset:1024 sc1
    buffer_store_dwordx4 v[220:223], v3, s[48:51], s47 offen offset:3072 sc1
    buffer_store_dwordx4 v[224:227], v3, s[48:51], s56 offen offset:1024 sc1
    buffer_store_dwordx4 v[228:231], v3, s[48:51], s56 offen offset:3072 sc1
    buffer_store_dwordx4 v[232:235], v3, s[48:51], s57 offen offset:1024 sc1
    buffer_store_dwordx4 v[236:239], v3, s[48:51], s57 offen offset:3072 sc1
    s_lshl_b32 s65, s39, 2
    s_lshl_b32 s66, s44, 1
    s_add_u32 s65, s65, s66
    s_lshl_b32 s65, s65, 13
    s_lshl_b32 s66, s73, 7
    s_add_u32 s65, s65, s66
    s_add_u32 s65, s65, 2816
    s_mov_b32 s66, -1
    s_mov_b32 s67, s66
    v_lshrrev_b32 v2, 5, v0
    v_lshlrev_b32 v2, 13, v2
    v_and_b32 v1, 31, v0
    v_lshl_add_u32 v2, v1, 2, v2
    s_branch L_p2c
L_end:
    s_endpgm
L_codeend:
.section .rodata,"a"
.p2align 6
.amdhsa_kernel gated_mix__ssm_conv_s5__glu_gated_swiglu__prompt_kernel
  .amdhsa_next_free_vgpr 256
  .amdhsa_next_free_sgpr 102
  .amdhsa_accum_offset 256
  .amdhsa_group_segment_fixed_size 0
  .amdhsa_kernarg_size 136
  .amdhsa_user_sgpr_count 2
  .amdhsa_user_sgpr_kernarg_segment_ptr 1
  .amdhsa_system_sgpr_workgroup_id_x 1
.end_amdhsa_kernel
```
